```python
import torch

def _softmax(x, axis=-1):
    return torch.softmax(x, dim=axis)
def _gelu(x):
    return torch.nn.functional.gelu(x, approximate="tanh")
def _silu(x):
    return torch.nn.functional.silu(x)
def _sigmoid(x):
    return torch.sigmoid(x)
def _layernorm(x, axis=-1, eps=1e-5):
    m = x.mean(dim=axis, keepdim=True)
    v = x.var(dim=axis, keepdim=True, unbiased=False)
    return (x - m) / torch.sqrt(v + eps)
def _scatter_add(tgt, idx, src, axis=0):
    return tgt.clone().index_add_(axis, idx, src)
def _segment_sum(src, seg, n):
    out = torch.zeros((n,) + src.shape[1:], dtype=src.dtype)
    return out.index_add_(0, seg, src)
def _pad(x, pw):
    flat = tuple(v for pair in reversed(pw) for v in pair)
    return torch.nn.functional.pad(x, flat)

kernel_name = 'standalone__mha_block_cached__near_ridge'

def setup_inputs():

    _w = (lambda a: (lambda t: t.to(torch.bfloat16) if t.is_floating_point() else t)(torch.as_tensor(a)))
    B, Sq, D = 16, 128, 640
    H, Sk, Dh = 32, 1024, 128
    return {
        "x": _w((lambda *s: torch.randn(*s, dtype=torch.bfloat16) * 0.8)(B, Sq, D)),
        "k_cache": _w((lambda *s: torch.randn(*s, dtype=torch.bfloat16) * 0.8)(B, H, Sk, Dh)),
        "v_cache": _w((lambda *s: torch.randn(*s, dtype=torch.bfloat16) * 0.05)(B, H, Sk, Dh)),
        "wq": _w((lambda *s: torch.randn(*s, dtype=torch.bfloat16) * 0.8)(D, H * Dh) * (D ** -0.5)),
        "wo": _w((lambda *s: torch.randn(*s, dtype=torch.bfloat16) * 0.05)(H * Dh, D) * ((H * Dh) ** -0.5)),
    }

def reference(x, k_cache, v_cache, wq, wo):
    B, Sq, D = x.shape
    H, Dh = 32, 128
    q = (lambda x, *d: x.permute(*d))((x @ wq).reshape(B, Sq, H, Dh), 0, 2, 1, 3)
    scores = torch.einsum("bhqd,bhkd->bhqk", q, k_cache) * (Dh ** -0.5)
    p = _softmax(scores, axis=-1)
    o = torch.einsum("bhqk,bhkd->bhqd", p, v_cache)
    return (lambda x, *d: x.permute(*d))(o, 0, 2, 1, 3).reshape(B, Sq, H * Dh) @ wo
```

```asm
; @launch grid=(256,1,1) block=(512,1,1) lds=163840
.amdgcn_target "amdgcn-amd-amdhsa--gfx950"
.text
.globl standalone__mha_block_cached__near_ridge_kernel
.p2align 8
.type standalone__mha_block_cached__near_ridge_kernel,@function
standalone__mha_block_cached__near_ridge_kernel:

    s_cmp_ge_u32 s2, 256
    s_cbranch_scc1 L_end
    s_load_dwordx4 s[48:51], s[0:1], 0
    s_load_dwordx4 s[52:55], s[0:1], 16
    s_load_dwordx2 s[56:57], s[0:1], 56
    s_load_dwordx4 s[60:63], s[0:1], 32
    s_load_dwordx2 s[98:99], s[0:1], 48

    v_lshrrev_b32 v2, 6, v0
    v_and_b32 v1, 63, v0
    v_readfirstlane_b32 s3, v2
    s_and_b32 s34, s2, 7
    s_lshr_b32 s35, s2, 3
    s_and_b32 s36, s34, 1
    s_lshl_b32 s36, s36, 3
    s_and_b32 s37, s35, 7
    s_add_u32 s36, s36, s37
    s_lshr_b32 s34, s34, 1
    s_lshl_b32 s34, s34, 2
    s_lshr_b32 s35, s35, 3
    s_add_u32 s34, s34, s35
    s_lshl_b32 s37, s36, 5
    s_add_u32 s37, s37, s34
    s_lshl_b32 s28, s37, 18
    s_lshl_b32 s42, s37, 15
    s_mul_i32 s29, s36, 163840
    s_lshl_b32 s30, s34, 8
    s_lshr_b32 s4, s3, 2
    s_and_b32 s5, s3, 3
    s_lshl_b32 s38, s5, 12
    s_waitcnt lgkmcnt(0)
    s_mov_b32 s16, s48
    s_mov_b32 s17, s49
    s_mov_b32 s18, 2621440
    s_mov_b32 s19, 0x20000
    s_mov_b32 s8, s50
    s_mov_b32 s9, s51
    s_mov_b32 s10, 0x8000000
    s_mov_b32 s11, 0x20000
    s_mov_b32 s12, s52
    s_mov_b32 s13, s53
    s_mov_b32 s14, 0x8000000
    s_mov_b32 s15, 0x20000
    s_mov_b32 s20, s54
    s_mov_b32 s21, s55
    s_mov_b32 s22, 5242880
    s_mov_b32 s23, 0x20000
    s_mov_b32 s24, s56
    s_mov_b32 s25, s57
    s_mov_b32 s26, 0x20000000
    s_mov_b32 s27, 0x20000
    s_mov_b32 s33, 0x3e0293ee
    s_mov_b32 s76, s60
    s_mov_b32 s77, s61
    s_mov_b32 s78, 5242880
    s_mov_b32 s79, 0x20000
    s_mov_b32 s80, s62
    s_mov_b32 s81, s63
    s_mov_b32 s82, 2621440
    s_mov_b32 s83, 0x20000
    s_mov_b32 s84, s98
    s_mov_b32 s85, s99
    s_mov_b32 s86, 256
    s_mov_b32 s87, 0x20000
    s_and_b32 s34, s2, 7
    s_lshr_b32 s35, s2, 3
    s_lshr_b32 s36, s34, 1
    s_lshl_b32 s36, s36, 3
    s_and_b32 s37, s35, 7
    s_add_u32 s90, s36, s37
    s_and_b32 s34, s34, 1
    s_lshl_b32 s34, s34, 2
    s_lshr_b32 s35, s35, 3
    s_add_u32 s91, s34, s35
    s_lshr_b32 s97, s42, 15

    s_cmp_eq_u32 s4, 0
    s_cbranch_scc0 L_g1
    s_setprio 1

    v_and_b32 v32, 15, v1
    v_lshrrev_b32 v33, 4, v1
    v_and_b32 v34, 31, v1
    v_lshrrev_b32 v35, 5, v1

    v_lshlrev_b32 v36, 8, v33
    v_add_u32 v36, s38, v36

    v_add_u32 v37, 0, v33
    v_xor_b32 v37, v32, v37
    v_lshl_add_u32 v2, v37, 4, v36

    v_add_u32 v37, 4, v33
    v_xor_b32 v37, v32, v37
    v_lshl_add_u32 v3, v37, 4, v36

    v_add_u32 v37, 8, v33
    v_xor_b32 v37, v32, v37
    v_lshl_add_u32 v4, v37, 4, v36

    v_add_u32 v37, 12, v33
    v_xor_b32 v37, v32, v37
    v_lshl_add_u32 v5, v37, 4, v36

    v_lshlrev_b32 v37, 2, v33
    v_xor_b32 v37, v32, v37
    v_lshl_add_u32 v6, v37, 4, v36

    v_xor_b32 v37, v35, v32
    v_lshlrev_b32 v37, 4, v37
    v_lshl_add_u32 v10, v34, 8, v37
    v_lshrrev_b32 v36, 2, v32
    v_and_b32 v37, 3, v32
    v_and_b32 v38, 1, v33
    v_lshlrev_b32 v38, 5, v38
    v_lshl_add_u32 v39, v37, 3, v38
    v_lshl_add_u32 v30, v35, 2, v36
    v_lshl_add_u32 v39, v30, 8, v39
    v_and_b32 v31, 1, v37
    v_lshlrev_b32 v31, 1, v31
    v_lshrrev_b32 v37, 1, v37
    v_or_b32 v37, v37, v31
    v_lshl_add_u32 v38, v37, 3, v38
    v_lshl_add_u32 v30, v35, 3, v36
    v_lshl_add_u32 v38, v30, 8, v38

    v_xor_b32 v37, 0, v36
    v_lshl_add_u32 v11, v37, 6, v39
    v_lshl_add_u32 v15, v37, 6, v38

    v_xor_b32 v37, 1, v36
    v_lshl_add_u32 v12, v37, 6, v39
    v_lshl_add_u32 v16, v37, 6, v38

    v_xor_b32 v37, 2, v36
    v_lshl_add_u32 v13, v37, 6, v39
    v_lshl_add_u32 v17, v37, 6, v38

    v_xor_b32 v37, 3, v36
    v_lshl_add_u32 v14, v37, 6, v39
    v_lshl_add_u32 v18, v37, 6, v38

    v_lshrrev_b32 v36, 1, v34
    v_and_b32 v36, 7, v36
    v_xor_b32 v36, v35, v36
    v_lshlrev_b32 v36, 4, v36
    v_lshl_add_u32 v36, v34, 7, v36
    v_add_u32 v19, s38, v36
    v_lshrrev_b32 v36, 4, v34
    v_lshlrev_b32 v36, 10, v36
    v_lshl_add_u32 v36, v35, 8, v36
    v_lshl_add_u32 v36, v32, 4, v36
    s_lshl_b32 s34, s5, 11
    v_add_u32 v26, s34, v36
    s_lshl_b32 s34, s5, 13
    s_add_u32 s34, s34, 131072
    v_lshlrev_b32 v36, 4, v1
    v_add_u32 v27, s34, v36

    v_mov_b64 v[72:73], 0
    v_mov_b64 v[74:75], 0
    v_mov_b64 v[76:77], 0
    v_mov_b64 v[78:79], 0
    v_mov_b64 v[80:81], 0
    v_mov_b64 v[82:83], 0
    v_mov_b64 v[84:85], 0
    v_mov_b64 v[86:87], 0
    v_mov_b64 v[88:89], 0
    v_mov_b64 v[90:91], 0
    v_mov_b64 v[92:93], 0
    v_mov_b64 v[94:95], 0
    v_mov_b64 v[96:97], 0
    v_mov_b64 v[98:99], 0
    v_mov_b64 v[100:101], 0
    v_mov_b64 v[102:103], 0
    v_mov_b64 v[104:105], 0
    v_mov_b64 v[106:107], 0
    v_mov_b64 v[108:109], 0
    v_mov_b64 v[110:111], 0
    v_mov_b64 v[112:113], 0
    v_mov_b64 v[114:115], 0
    v_mov_b64 v[116:117], 0
    v_mov_b64 v[118:119], 0
    v_mov_b64 v[120:121], 0
    v_mov_b64 v[122:123], 0
    v_mov_b64 v[124:125], 0
    v_mov_b64 v[126:127], 0
    v_mov_b64 v[128:129], 0
    v_mov_b64 v[130:131], 0
    v_mov_b64 v[132:133], 0
    v_mov_b64 v[134:135], 0
    s_mov_b32 s40, 131072
    s_mov_b32 s41, 147456
    s_mov_b32 s60, 32768
    s_mov_b32 s61, 81920
    s_mov_b32 s62, 98304
    s_mov_b32 s63, 114688
    s_mov_b32 s39, 0
L_p0:
    s_barrier
    v_add_u32 v32, s40, v19
    v_add_u32 v36, s41, v15
    v_add_u32 v37, s41, v16
    v_add_u32 v38, s41, v17
    v_add_u32 v39, s41, v18
    v_xor_b32 v33, 32, v32
    v_xor_b32 v34, 64, v32
    v_xor_b32 v35, 96, v32
    ds_read_b128 v[200:203], v32
    ds_read_b128 v[204:207], v33
    ds_read_b128 v[208:211], v34
    ds_read_b128 v[212:215], v35
    ds_read_b64_tr_b16 v[216:217], v36 offset:0
    ds_read_b64_tr_b16 v[218:219], v36 offset:1024
    ds_read_b64_tr_b16 v[220:221], v37 offset:0
    ds_read_b64_tr_b16 v[222:223], v37 offset:1024
    ds_read_b64_tr_b16 v[224:225], v38 offset:0
    ds_read_b64_tr_b16 v[226:227], v38 offset:1024
    ds_read_b64_tr_b16 v[228:229], v39 offset:0
    ds_read_b64_tr_b16 v[230:231], v39 offset:1024
    ds_read_b64_tr_b16 v[232:233], v36 offset:4096
    ds_read_b64_tr_b16 v[234:235], v36 offset:5120
    ds_read_b64_tr_b16 v[236:237], v37 offset:4096
    ds_read_b64_tr_b16 v[238:239], v37 offset:5120
    s_waitcnt lgkmcnt(10)
    v_mfma_f32_32x32x16_bf16 v[72:87], v[216:219], v[200:203], v[72:87]
    ds_read_b64_tr_b16 v[240:241], v38 offset:4096
    ds_read_b64_tr_b16 v[242:243], v38 offset:5120
    s_waitcnt lgkmcnt(10)
    v_mfma_f32_32x32x16_bf16 v[88:103], v[220:223], v[200:203], v[88:103]
    ds_read_b64_tr_b16 v[244:245], v39 offset:4096
    ds_read_b64_tr_b16 v[246:247], v39 offset:5120
    s_waitcnt lgkmcnt(10)
    v_mfma_f32_32x32x16_bf16 v[104:119], v[224:227], v[200:203], v[104:119]
    ds_read_b64_tr_b16 v[216:217], v36 offset:8192
    ds_read_b64_tr_b16 v[218:219], v36 offset:9216
    s_waitcnt lgkmcnt(10)
    v_mfma_f32_32x32x16_bf16 v[120:135], v[228:231], v[200:203], v[120:135]
    ds_read_b64_tr_b16 v[220:221], v37 offset:8192
    ds_read_b64_tr_b16 v[222:223], v37 offset:9216
    s_waitcnt lgkmcnt(10)
    v_mfma_f32_32x32x16_bf16 v[72:87], v[232:235], v[204:207], v[72:87]
    ds_read_b64_tr_b16 v[224:225], v38 offset:8192
    ds_read_b64_tr_b16 v[226:227], v38 offset:9216
    s_waitcnt lgkmcnt(10)
    v_mfma_f32_32x32x16_bf16 v[88:103], v[236:239], v[204:207], v[88:103]
    ds_read_b64_tr_b16 v[228:229], v39 offset:8192
    ds_read_b64_tr_b16 v[230:231], v39 offset:9216
    s_waitcnt lgkmcnt(10)
    v_mfma_f32_32x32x16_bf16 v[104:119], v[240:243], v[204:207], v[104:119]
    ds_read_b64_tr_b16 v[232:233], v36 offset:12288
    ds_read_b64_tr_b16 v[234:235], v36 offset:13312
    s_waitcnt lgkmcnt(10)
    v_mfma_f32_32x32x16_bf16 v[120:135], v[244:247], v[204:207], v[120:135]
    ds_read_b64_tr_b16 v[236:237], v37 offset:12288
    ds_read_b64_tr_b16 v[238:239], v37 offset:13312
    s_waitcnt lgkmcnt(10)
    v_mfma_f32_32x32x16_bf16 v[72:87], v[216:219], v[208:211], v[72:87]
    ds_read_b64_tr_b16 v[240:241], v38 offset:12288
    ds_read_b64_tr_b16 v[242:243], v38 offset:13312
    s_waitcnt lgkmcnt(10)
    v_mfma_f32_32x32x16_bf16 v[88:103], v[220:223], v[208:211], v[88:103]
    ds_read_b64_tr_b16 v[244:245], v39 offset:12288
    ds_read_b64_tr_b16 v[246:247], v39 offset:13312
    s_waitcnt lgkmcnt(10)
    v_mfma_f32_32x32x16_bf16 v[104:119], v[224:227], v[208:211], v[104:119]
    s_waitcnt lgkmcnt(8)
    v_mfma_f32_32x32x16_bf16 v[120:135], v[228:231], v[208:211], v[120:135]
    s_waitcnt lgkmcnt(6)
    v_mfma_f32_32x32x16_bf16 v[72:87], v[232:235], v[212:215], v[72:87]
    s_waitcnt lgkmcnt(4)
    v_mfma_f32_32x32x16_bf16 v[88:103], v[236:239], v[212:215], v[88:103]
    s_waitcnt lgkmcnt(2)
    v_mfma_f32_32x32x16_bf16 v[104:119], v[240:243], v[212:215], v[104:119]
    s_waitcnt lgkmcnt(0)
    v_mfma_f32_32x32x16_bf16 v[120:135], v[244:247], v[212:215], v[120:135]
    s_mov_b32 s34, s40
    s_mov_b32 s35, s41
    s_mov_b32 s40, s60
    s_mov_b32 s41, s61
    s_mov_b32 s60, s62
    s_mov_b32 s61, s63
    s_mov_b32 s62, s34
    s_mov_b32 s63, s35
    s_add_u32 s39, s39, 1
    s_cmp_lt_u32 s39, 10
    s_cbranch_scc1 L_p0
    s_waitcnt vmcnt(0)
    s_nop 15
    v_mul_f32 v72, s33, v72
    v_mul_f32 v73, s33, v73
    v_cvt_pk_bf16_f32 v40, v72, v73
    v_mul_f32 v74, s33, v74
    v_mul_f32 v75, s33, v75
    v_cvt_pk_bf16_f32 v41, v74, v75
    v_mul_f32 v76, s33, v76
    v_mul_f32 v77, s33, v77
    v_cvt_pk_bf16_f32 v42, v76, v77
    v_mul_f32 v78, s33, v78
    v_mul_f32 v79, s33, v79
    v_cvt_pk_bf16_f32 v43, v78, v79
    v_mul_f32 v80, s33, v80
    v_mul_f32 v81, s33, v81
    v_cvt_pk_bf16_f32 v44, v80, v81
    v_mul_f32 v82, s33, v82
    v_mul_f32 v83, s33, v83
    v_cvt_pk_bf16_f32 v45, v82, v83
    v_mul_f32 v84, s33, v84
    v_mul_f32 v85, s33, v85
    v_cvt_pk_bf16_f32 v46, v84, v85
    v_mul_f32 v86, s33, v86
    v_mul_f32 v87, s33, v87
    v_cvt_pk_bf16_f32 v47, v86, v87
    v_mul_f32 v88, s33, v88
    v_mul_f32 v89, s33, v89
    v_cvt_pk_bf16_f32 v48, v88, v89
    v_mul_f32 v90, s33, v90
    v_mul_f32 v91, s33, v91
    v_cvt_pk_bf16_f32 v49, v90, v91
    v_mul_f32 v92, s33, v92
    v_mul_f32 v93, s33, v93
    v_cvt_pk_bf16_f32 v50, v92, v93
    v_mul_f32 v94, s33, v94
    v_mul_f32 v95, s33, v95
    v_cvt_pk_bf16_f32 v51, v94, v95
    v_mul_f32 v96, s33, v96
    v_mul_f32 v97, s33, v97
    v_cvt_pk_bf16_f32 v52, v96, v97
    v_mul_f32 v98, s33, v98
    v_mul_f32 v99, s33, v99
    v_cvt_pk_bf16_f32 v53, v98, v99
    v_mul_f32 v100, s33, v100
    v_mul_f32 v101, s33, v101
    v_cvt_pk_bf16_f32 v54, v100, v101
    v_mul_f32 v102, s33, v102
    v_mul_f32 v103, s33, v103
    v_cvt_pk_bf16_f32 v55, v102, v103
    v_mul_f32 v104, s33, v104
    v_mul_f32 v105, s33, v105
    v_cvt_pk_bf16_f32 v56, v104, v105
    v_mul_f32 v106, s33, v106
    v_mul_f32 v107, s33, v107
    v_cvt_pk_bf16_f32 v57, v106, v107
    v_mul_f32 v108, s33, v108
    v_mul_f32 v109, s33, v109
    v_cvt_pk_bf16_f32 v58, v108, v109
    v_mul_f32 v110, s33, v110
    v_mul_f32 v111, s33, v111
    v_cvt_pk_bf16_f32 v59, v110, v111
    v_mul_f32 v112, s33, v112
    v_mul_f32 v113, s33, v113
    v_cvt_pk_bf16_f32 v60, v112, v113
    v_mul_f32 v114, s33, v114
    v_mul_f32 v115, s33, v115
    v_cvt_pk_bf16_f32 v61, v114, v115
    v_mul_f32 v116, s33, v116
    v_mul_f32 v117, s33, v117
    v_cvt_pk_bf16_f32 v62, v116, v117
    v_mul_f32 v118, s33, v118
    v_mul_f32 v119, s33, v119
    v_cvt_pk_bf16_f32 v63, v118, v119
    v_mul_f32 v120, s33, v120
    v_mul_f32 v121, s33, v121
    v_cvt_pk_bf16_f32 v64, v120, v121
    v_mul_f32 v122, s33, v122
    v_mul_f32 v123, s33, v123
    v_cvt_pk_bf16_f32 v65, v122, v123
    v_mul_f32 v124, s33, v124
    v_mul_f32 v125, s33, v125
    v_cvt_pk_bf16_f32 v66, v124, v125
    v_mul_f32 v126, s33, v126
    v_mul_f32 v127, s33, v127
    v_cvt_pk_bf16_f32 v67, v126, v127
    v_mul_f32 v128, s33, v128
    v_mul_f32 v129, s33, v129
    v_cvt_pk_bf16_f32 v68, v128, v129
    v_mul_f32 v130, s33, v130
    v_mul_f32 v131, s33, v131
    v_cvt_pk_bf16_f32 v69, v130, v131
    v_mul_f32 v132, s33, v132
    v_mul_f32 v133, s33, v133
    v_cvt_pk_bf16_f32 v70, v132, v133
    v_mul_f32 v134, s33, v134
    v_mul_f32 v135, s33, v135
    v_cvt_pk_bf16_f32 v71, v134, v135
    s_barrier
    v_mov_b64 v[72:73], 0
    v_mov_b64 v[74:75], 0
    v_mov_b64 v[76:77], 0
    v_mov_b64 v[78:79], 0
    v_mov_b64 v[80:81], 0
    v_mov_b64 v[82:83], 0
    v_mov_b64 v[84:85], 0
    v_mov_b64 v[86:87], 0
    v_mov_b64 v[88:89], 0
    v_mov_b64 v[90:91], 0
    v_mov_b64 v[92:93], 0
    v_mov_b64 v[94:95], 0
    v_mov_b64 v[96:97], 0
    v_mov_b64 v[98:99], 0
    v_mov_b64 v[100:101], 0
    v_mov_b64 v[102:103], 0
    v_mov_b64 v[104:105], 0
    v_mov_b64 v[106:107], 0
    v_mov_b64 v[108:109], 0
    v_mov_b64 v[110:111], 0
    v_mov_b64 v[112:113], 0
    v_mov_b64 v[114:115], 0
    v_mov_b64 v[116:117], 0
    v_mov_b64 v[118:119], 0
    v_mov_b64 v[120:121], 0
    v_mov_b64 v[122:123], 0
    v_mov_b64 v[124:125], 0
    v_mov_b64 v[126:127], 0
    v_mov_b64 v[128:129], 0
    v_mov_b64 v[130:131], 0
    v_mov_b64 v[132:133], 0
    v_mov_b64 v[134:135], 0
    v_mov_b64 v[240:241], 0
    v_mov_b64 v[242:243], 0
    v_mov_b64 v[244:245], 0
    v_mov_b64 v[246:247], 0
    v_mov_b64 v[248:249], 0
    v_mov_b64 v[250:251], 0
    v_mov_b64 v[252:253], 0
    v_mov_b64 v[254:255], 0
    v_mov_b32 v20, 0
    v_mov_b32 v21, 0
    s_mov_b32 s46, 0xff800000
    s_mov_b32 s43, 0x41000000
    s_waitcnt lgkmcnt(0)
    s_mov_b32 s45, 0
    v_add_u32 v32, s45, v10
    v_xor_b32 v33, 32, v32
    v_xor_b32 v34, 64, v32
    v_xor_b32 v35, 96, v32
    v_xor_b32 v36, 128, v32
    v_xor_b32 v37, 160, v32
    v_xor_b32 v38, 192, v32
    v_xor_b32 v39, 224, v32
    ds_read_b128 v[216:219], v32 offset:0
    ds_read_b128 v[220:223], v33 offset:0
    ds_read_b128 v[224:227], v34 offset:0
    ds_read_b128 v[228:231], v35 offset:0
    ds_read_b128 v[232:235], v36 offset:0
    ds_read_b128 v[236:239], v37 offset:0
    ds_read_b128 v[184:187], v38 offset:0
    ds_read_b128 v[188:191], v39 offset:0
    s_mov_b32 s44, 49152
    v_add_u32 v28, s44, v11
    v_add_u32 v29, s44, v12
    v_add_u32 v30, s44, v13
    v_add_u32 v31, s44, v14
    s_waitcnt lgkmcnt(7)
    v_mfma_f32_32x32x16_bf16 v[136:151], v[216:219], v[40:43], v[240:255]
    s_waitcnt lgkmcnt(6)
    v_mfma_f32_32x32x16_bf16 v[136:151], v[220:223], v[44:47], v[136:151]
    s_waitcnt lgkmcnt(5)
    v_mfma_f32_32x32x16_bf16 v[136:151], v[224:227], v[48:51], v[136:151]
    s_waitcnt lgkmcnt(4)
    v_mfma_f32_32x32x16_bf16 v[136:151], v[228:231], v[52:55], v[136:151]
    s_waitcnt lgkmcnt(3)
    v_mfma_f32_32x32x16_bf16 v[136:151], v[232:235], v[56:59], v[136:151]
    s_waitcnt lgkmcnt(2)
    v_mfma_f32_32x32x16_bf16 v[136:151], v[236:239], v[60:63], v[136:151]
    s_waitcnt lgkmcnt(1)
    v_mfma_f32_32x32x16_bf16 v[136:151], v[184:187], v[64:67], v[136:151]
    s_waitcnt lgkmcnt(0)
    v_mfma_f32_32x32x16_bf16 v[136:151], v[188:191], v[68:71], v[136:151]
    ds_read_b128 v[192:195], v32 offset:8192
    ds_read_b128 v[196:199], v33 offset:8192
    ds_read_b128 v[216:219], v34 offset:8192
    ds_read_b128 v[220:223], v35 offset:8192
    ds_read_b128 v[224:227], v36 offset:8192
    ds_read_b128 v[228:231], v37 offset:8192
    ds_read_b128 v[232:235], v38 offset:8192
    ds_read_b128 v[236:239], v39 offset:8192
    s_nop 7
    s_nop 3
    v_max3_f32 v22, v136, v137, v138
    v_max3_f32 v23, v139, v140, v141
    v_max3_f32 v22, v22, v142, v143
    v_max3_f32 v23, v23, v144, v145
    v_max3_f32 v22, v22, v146, v147
    v_max3_f32 v23, v23, v148, v149
    v_max3_f32 v23, v23, v150, v151
    v_max_f32 v22, v22, v23
    v_cmp_lt_f32 vcc, s46, v22
    s_nop 0
    s_cbranch_vccnz L_slow0_pa
L_fast0_pa:
    s_waitcnt lgkmcnt(0)
    v_mfma_f32_32x32x16_bf16 v[152:167], v[192:195], v[40:43], v[240:255]
    v_exp_f32 v136, v136
    v_exp_f32 v137, v137
    v_exp_f32 v138, v138
    v_exp_f32 v139, v139
    v_add_f32 v20, v20, v136
    ds_read_b64_tr_b16 v[200:201], v28 offset:4096
    v_mfma_f32_32x32x16_bf16 v[152:167], v[196:199], v[44:47], v[152:167]
    v_add_f32 v21, v21, v137
    v_cvt_pk_bf16_f32 v168, v136, v137
    v_exp_f32 v140, v140
    v_exp_f32 v141, v141
    v_add_f32 v20, v20, v138
    ds_read_b64_tr_b16 v[202:203], v28 offset:6144
    v_mfma_f32_32x32x16_bf16 v[152:167], v[216:219], v[48:51], v[152:167]
    v_add_f32 v21, v21, v139
    v_cvt_pk_bf16_f32 v169, v138, v139
    v_exp_f32 v142, v142
    v_exp_f32 v143, v143
    v_add_f32 v20, v20, v140
    ds_read_b64_tr_b16 v[204:205], v29 offset:4096
    v_mfma_f32_32x32x16_bf16 v[152:167], v[220:223], v[52:55], v[152:167]
    v_add_f32 v21, v21, v141
    v_cvt_pk_bf16_f32 v170, v140, v141
    v_add_f32 v20, v20, v142
    v_add_f32 v21, v21, v143
    v_cvt_pk_bf16_f32 v171, v142, v143
    ds_read_b64_tr_b16 v[206:207], v29 offset:6144
    v_mfma_f32_32x32x16_bf16 v[152:167], v[224:227], v[56:59], v[152:167]
    v_exp_f32 v144, v144
    v_exp_f32 v145, v145
    v_exp_f32 v146, v146
    v_exp_f32 v147, v147
    v_add_f32 v20, v20, v144
    ds_read_b64_tr_b16 v[208:209], v30 offset:4096
    v_mfma_f32_32x32x16_bf16 v[152:167], v[228:231], v[60:63], v[152:167]
    v_add_f32 v21, v21, v145
    v_cvt_pk_bf16_f32 v172, v144, v145
    v_exp_f32 v148, v148
    v_exp_f32 v149, v149
    v_add_f32 v20, v20, v146
    ds_read_b64_tr_b16 v[210:211], v30 offset:6144
    v_mfma_f32_32x32x16_bf16 v[152:167], v[232:235], v[64:67], v[152:167]
    v_add_f32 v21, v21, v147
    v_cvt_pk_bf16_f32 v173, v146, v147
    v_exp_f32 v150, v150
    v_exp_f32 v151, v151
    v_add_f32 v20, v20, v148
    ds_read_b64_tr_b16 v[212:213], v31 offset:4096
    v_mfma_f32_32x32x16_bf16 v[152:167], v[236:239], v[68:71], v[152:167]
    v_add_f32 v21, v21, v149
    v_cvt_pk_bf16_f32 v174, v148, v149
    v_add_f32 v20, v20, v150
    v_add_f32 v21, v21, v151
    v_cvt_pk_bf16_f32 v175, v150, v151
    ds_read_b64_tr_b16 v[214:215], v31 offset:6144
    ds_read_b64_tr_b16 v[184:185], v28 offset:0
    ds_read_b64_tr_b16 v[186:187], v28 offset:2048
    ds_read_b64_tr_b16 v[188:189], v29 offset:0
    ds_read_b64_tr_b16 v[190:191], v29 offset:2048
    ds_read_b64_tr_b16 v[192:193], v30 offset:0
    ds_read_b64_tr_b16 v[194:195], v30 offset:2048
    ds_read_b64_tr_b16 v[196:197], v31 offset:0
    ds_read_b64_tr_b16 v[198:199], v31 offset:2048
    s_mov_b32 s31, 0
    s_mov_b32 s45, 16384
    s_mov_b32 s59, 98304
    v_add_u32 v32, s45, v10
    v_xor_b32 v33, 32, v32
    v_xor_b32 v34, 64, v32
    v_xor_b32 v35, 96, v32
    v_xor_b32 v36, 128, v32
    v_xor_b32 v37, 160, v32
    v_xor_b32 v38, 192, v32
    v_xor_b32 v39, 224, v32
    s_mov_b32 s32, 0
L_att_r1:
    s_barrier
    s_waitcnt lgkmcnt(6)
    v_mfma_f32_32x32x16_bf16 v[72:87], v[184:187], v[168:171], v[72:87]
    v_max3_f32 v22, v152, v153, v154
    v_max3_f32 v23, v155, v156, v157
    v_max3_f32 v22, v22, v158, v159
    v_max3_f32 v23, v23, v160, v161
    v_max3_f32 v22, v22, v162, v163
    v_max3_f32 v23, v23, v164, v165
    s_waitcnt lgkmcnt(4)
    v_mfma_f32_32x32x16_bf16 v[88:103], v[188:191], v[168:171], v[88:103]
    v_max3_f32 v23, v23, v166, v167
    v_max_f32 v22, v22, v23
    v_cmp_lt_f32 vcc, s43, v22
    s_nop 0
    s_cbranch_vccnz L_slow1_r1
L_fast1_r1:
    ds_read_b128 v[216:219], v32 offset:0
    s_waitcnt lgkmcnt(3)
    v_mfma_f32_32x32x16_bf16 v[104:119], v[192:195], v[168:171], v[104:119]
    ds_read_b128 v[220:223], v33 offset:0
    v_exp_f32 v152, v152
    v_exp_f32 v153, v153
    ds_read_b128 v[224:227], v34 offset:0
    s_waitcnt lgkmcnt(3)
    v_mfma_f32_32x32x16_bf16 v[120:135], v[196:199], v[168:171], v[120:135]
    ds_read_b64_tr_b16 v[184:185], v28 offset:8192
    ds_read_b64_tr_b16 v[186:187], v28 offset:10240
    ds_read_b64_tr_b16 v[188:189], v29 offset:8192
    v_exp_f32 v154, v154
    v_mfma_f32_32x32x16_bf16 v[72:87], v[200:203], v[172:175], v[72:87]
    ds_read_b64_tr_b16 v[190:191], v29 offset:10240
    ds_read_b64_tr_b16 v[192:193], v30 offset:8192
    ds_read_b64_tr_b16 v[194:195], v30 offset:10240
    v_exp_f32 v155, v155
    v_add_f32 v20, v20, v152
    v_mfma_f32_32x32x16_bf16 v[88:103], v[204:207], v[172:175], v[88:103]
    v_add_f32 v21, v21, v153
    v_cvt_pk_bf16_f32 v176, v152, v153
    v_exp_f32 v156, v156
    v_exp_f32 v157, v157
    v_mfma_f32_32x32x16_bf16 v[104:119], v[208:211], v[172:175], v[104:119]
    v_add_f32 v20, v20, v154
    v_add_f32 v21, v21, v155
    v_cvt_pk_bf16_f32 v177, v154, v155
    v_exp_f32 v158, v158
    v_exp_f32 v159, v159
    v_add_f32 v20, v20, v156
    v_add_f32 v21, v21, v157
    v_cvt_pk_bf16_f32 v178, v156, v157
    v_add_f32 v20, v20, v158
    v_add_f32 v21, v21, v159
    v_cvt_pk_bf16_f32 v179, v158, v159
    ds_read_b64_tr_b16 v[196:197], v31 offset:8192
    ds_read_b64_tr_b16 v[198:199], v31 offset:10240
    v_mfma_f32_32x32x16_bf16 v[120:135], v[212:215], v[172:175], v[120:135]
    ds_read_b128 v[228:231], v35 offset:0
    ds_read_b128 v[232:235], v36 offset:0
    v_exp_f32 v160, v160
    v_exp_f32 v161, v161
L_j8_r1:
    s_waitcnt lgkmcnt(8)
    v_mfma_f32_32x32x16_bf16 v[72:87], v[184:187], v[176:179], v[72:87]
    ds_read_b64_tr_b16 v[200:201], v28 offset:12288
    ds_read_b64_tr_b16 v[202:203], v28 offset:14336
    ds_read_b128 v[236:239], v37 offset:0
    v_exp_f32 v162, v162
    s_waitcnt lgkmcnt(9)
    v_mfma_f32_32x32x16_bf16 v[88:103], v[188:191], v[176:179], v[88:103]
    ds_read_b64_tr_b16 v[204:205], v29 offset:12288
    ds_read_b64_tr_b16 v[206:207], v29 offset:14336
    ds_read_b64_tr_b16 v[208:209], v30 offset:12288
    v_exp_f32 v163, v163
    v_add_f32 v20, v20, v160
    s_waitcnt lgkmcnt(10)
    v_mfma_f32_32x32x16_bf16 v[104:119], v[192:195], v[176:179], v[104:119]
    ds_read_b64_tr_b16 v[210:211], v30 offset:14336
    ds_read_b64_tr_b16 v[212:213], v31 offset:12288
    ds_read_b64_tr_b16 v[214:215], v31 offset:14336
    v_add_f32 v21, v21, v161
    v_cvt_pk_bf16_f32 v180, v160, v161
    s_waitcnt lgkmcnt(11)
    v_mfma_f32_32x32x16_bf16 v[120:135], v[196:199], v[176:179], v[120:135]
    ds_read_b128 v[184:187], v38 offset:0
    ds_read_b128 v[188:191], v39 offset:0
    v_exp_f32 v164, v164
    v_exp_f32 v165, v165
    v_mfma_f32_32x32x16_bf16 v[136:151], v[216:219], v[40:43], v[240:255]
    ds_read_b128 v[192:195], v32 offset:8192
    ds_read_b128 v[196:199], v33 offset:8192
    v_add_f32 v20, v20, v162
    v_add_f32 v21, v21, v163
    v_cvt_pk_bf16_f32 v181, v162, v163
    v_mfma_f32_32x32x16_bf16 v[136:151], v[220:223], v[44:47], v[136:151]
    ds_read_b128 v[216:219], v34 offset:8192
    ds_read_b128 v[220:223], v35 offset:8192
    v_exp_f32 v166, v166
    v_exp_f32 v167, v167
    v_mfma_f32_32x32x16_bf16 v[136:151], v[224:227], v[48:51], v[136:151]
    v_add_f32 v20, v20, v164
    v_add_f32 v21, v21, v165
    v_cvt_pk_bf16_f32 v182, v164, v165
    v_add_f32 v20, v20, v166
    v_add_f32 v21, v21, v167
    v_cvt_pk_bf16_f32 v183, v166, v167
    s_waitcnt lgkmcnt(15)
    v_mfma_f32_32x32x16_bf16 v[136:151], v[228:231], v[52:55], v[136:151]
    ds_read_b128 v[224:227], v36 offset:8192
    ds_read_b128 v[228:231], v37 offset:8192
    s_add_u32 s36, s44, 16384
    s_cmp_ge_u32 s36, 114688
    s_cselect_b32 s36, 49152, s36
    s_waitcnt lgkmcnt(15)
    v_mfma_f32_32x32x16_bf16 v[136:151], v[232:235], v[56:59], v[136:151]
    ds_read_b128 v[232:235], v38 offset:8192
    s_waitcnt lgkmcnt(15)
    v_mfma_f32_32x32x16_bf16 v[136:151], v[236:239], v[60:63], v[136:151]
    ds_read_b128 v[236:239], v39 offset:8192
    s_add_u32 s37, s45, 16384
    s_cmp_ge_u32 s37, 49152
    s_cselect_b32 s37, 0, s37
    s_waitcnt lgkmcnt(9)
    v_mfma_f32_32x32x16_bf16 v[136:151], v[184:187], v[64:67], v[136:151]
    s_waitcnt lgkmcnt(8)
    v_mfma_f32_32x32x16_bf16 v[136:151], v[188:191], v[68:71], v[136:151]
    v_add_u32 v28, s36, v11
    v_add_u32 v29, s36, v12
    v_add_u32 v30, s36, v13
    v_add_u32 v31, s36, v14
    v_add_u32 v32, s37, v10
    v_xor_b32 v33, 32, v32
    v_mfma_f32_32x32x16_bf16 v[72:87], v[200:203], v[180:183], v[72:87]
    v_xor_b32 v34, 64, v32
    v_xor_b32 v35, 96, v32
    v_xor_b32 v36, 128, v32
    v_xor_b32 v37, 160, v32
    v_xor_b32 v38, 192, v32
    v_xor_b32 v39, 224, v32
    v_mfma_f32_32x32x16_bf16 v[88:103], v[204:207], v[180:183], v[88:103]
    s_mov_b32 s59, s44
    s_mov_b32 s31, s45
    v_mfma_f32_32x32x16_bf16 v[104:119], v[208:211], v[180:183], v[104:119]
    v_max3_f32 v22, v136, v137, v138
    v_max3_f32 v23, v139, v140, v141
    v_max3_f32 v22, v22, v142, v143
    v_max3_f32 v23, v23, v144, v145
    v_max3_f32 v22, v22, v146, v147
    v_max3_f32 v23, v23, v148, v149
    v_mfma_f32_32x32x16_bf16 v[120:135], v[212:215], v[180:183], v[120:135]
    v_max3_f32 v23, v23, v150, v151
    v_max_f32 v22, v22, v23
    v_cmp_lt_f32 vcc, s46, v22
    s_nop 0
    s_cbranch_vccnz L_slow0_r1
L_fast0_r1:
    ds_read_b64_tr_b16 v[200:201], v28 offset:4096
    s_waitcnt lgkmcnt(8)
    v_mfma_f32_32x32x16_bf16 v[152:167], v[192:195], v[40:43], v[240:255]
    ds_read_b64_tr_b16 v[202:203], v28 offset:6144
    ds_read_b64_tr_b16 v[204:205], v29 offset:4096
    ds_read_b64_tr_b16 v[206:207], v29 offset:6144
    v_exp_f32 v136, v136
    s_waitcnt lgkmcnt(10)
    v_mfma_f32_32x32x16_bf16 v[152:167], v[196:199], v[44:47], v[152:167]
    ds_read_b64_tr_b16 v[208:209], v30 offset:4096
    ds_read_b64_tr_b16 v[210:211], v30 offset:6144
    ds_read_b64_tr_b16 v[212:213], v31 offset:4096
    v_exp_f32 v137, v137
    s_waitcnt lgkmcnt(12)
    v_mfma_f32_32x32x16_bf16 v[152:167], v[216:219], v[48:51], v[152:167]
    ds_read_b64_tr_b16 v[214:215], v31 offset:6144
    ds_read_b64_tr_b16 v[184:185], v28 offset:0
    ds_read_b64_tr_b16 v[186:187], v28 offset:2048
    v_exp_f32 v138, v138
    s_waitcnt lgkmcnt(14)
    v_mfma_f32_32x32x16_bf16 v[152:167], v[220:223], v[52:55], v[152:167]
    ds_read_b64_tr_b16 v[188:189], v29 offset:0
    ds_read_b64_tr_b16 v[190:191], v29 offset:2048
    ds_read_b64_tr_b16 v[192:193], v30 offset:0
    v_exp_f32 v139, v139
    v_add_f32 v20, v20, v136
    s_waitcnt lgkmcnt(15)
    v_mfma_f32_32x32x16_bf16 v[152:167], v[224:227], v[56:59], v[152:167]
    ds_read_b64_tr_b16 v[194:195], v30 offset:2048
    ds_read_b64_tr_b16 v[196:197], v31 offset:0
    ds_read_b64_tr_b16 v[198:199], v31 offset:2048
    v_add_f32 v21, v21, v137
    v_cvt_pk_bf16_f32 v168, v136, v137
    s_waitcnt lgkmcnt(15)
    v_mfma_f32_32x32x16_bf16 v[152:167], v[228:231], v[60:63], v[152:167]
    v_exp_f32 v140, v140
    v_exp_f32 v141, v141
    v_add_f32 v20, v20, v138
    v_add_f32 v21, v21, v139
    s_waitcnt lgkmcnt(15)
    v_mfma_f32_32x32x16_bf16 v[152:167], v[232:235], v[64:67], v[152:167]
    v_cvt_pk_bf16_f32 v169, v138, v139
    v_exp_f32 v142, v142
    v_exp_f32 v143, v143
    v_add_f32 v20, v20, v140
    s_waitcnt lgkmcnt(15)
    v_mfma_f32_32x32x16_bf16 v[152:167], v[236:239], v[68:71], v[152:167]
    v_add_f32 v21, v21, v141
    v_cvt_pk_bf16_f32 v170, v140, v141
    v_add_f32 v20, v20, v142
    v_add_f32 v21, v21, v143
    v_cvt_pk_bf16_f32 v171, v142, v143
    v_exp_f32 v144, v144
    v_exp_f32 v145, v145
    v_exp_f32 v146, v146
    v_exp_f32 v147, v147
    v_add_f32 v20, v20, v144
    v_add_f32 v21, v21, v145
    v_cvt_pk_bf16_f32 v172, v144, v145
    v_exp_f32 v148, v148
    v_exp_f32 v149, v149
    v_add_f32 v20, v20, v146
    v_add_f32 v21, v21, v147
    v_cvt_pk_bf16_f32 v173, v146, v147
    v_exp_f32 v150, v150
    v_exp_f32 v151, v151
    v_add_f32 v20, v20, v148
    v_add_f32 v21, v21, v149
    v_cvt_pk_bf16_f32 v174, v148, v149
    v_add_f32 v20, v20, v150
    v_add_f32 v21, v21, v151
    v_cvt_pk_bf16_f32 v175, v150, v151
    s_mov_b32 s44, s36
    s_mov_b32 s45, s37
    s_add_u32 s32, s32, 1
    s_cmp_lt_u32 s32, 15
    s_cbranch_scc1 L_att_r1
    s_barrier
    v_max3_f32 v22, v152, v153, v154
    v_max3_f32 v23, v155, v156, v157
    v_max3_f32 v22, v22, v158, v159
    v_max3_f32 v23, v23, v160, v161
    v_max3_f32 v22, v22, v162, v163
    v_max3_f32 v23, v23, v164, v165
    v_max3_f32 v23, v23, v166, v167
    v_max_f32 v22, v22, v23
    v_cmp_lt_f32 vcc, s43, v22
    s_waitcnt lgkmcnt(0)
    s_cbranch_vccnz L_slowL_r1
    v_mfma_f32_32x32x16_bf16 v[72:87], v[184:187], v[168:171], v[72:87]
    v_exp_f32 v152, v152
    v_exp_f32 v153, v153
    v_exp_f32 v154, v154
    v_exp_f32 v155, v155
    v_add_f32 v20, v20, v152
    v_mfma_f32_32x32x16_bf16 v[88:103], v[188:191], v[168:171], v[88:103]
    v_add_f32 v21, v21, v153
    v_cvt_pk_bf16_f32 v176, v152, v153
    v_exp_f32 v156, v156
    v_exp_f32 v157, v157
    v_add_f32 v20, v20, v154
    v_mfma_f32_32x32x16_bf16 v[104:119], v[192:195], v[168:171], v[104:119]
    v_add_f32 v21, v21, v155
    v_cvt_pk_bf16_f32 v177, v154, v155
    v_exp_f32 v158, v158
    v_exp_f32 v159, v159
    v_add_f32 v20, v20, v156
    v_mfma_f32_32x32x16_bf16 v[120:135], v[196:199], v[168:171], v[120:135]
    v_add_f32 v21, v21, v157
    v_cvt_pk_bf16_f32 v178, v156, v157
    v_add_f32 v20, v20, v158
    v_add_f32 v21, v21, v159
    v_cvt_pk_bf16_f32 v179, v158, v159
    ds_read_b64_tr_b16 v[184:185], v28 offset:8192
    ds_read_b64_tr_b16 v[186:187], v28 offset:10240
    ds_read_b64_tr_b16 v[188:189], v29 offset:8192
    ds_read_b64_tr_b16 v[190:191], v29 offset:10240
    ds_read_b64_tr_b16 v[192:193], v30 offset:8192
    ds_read_b64_tr_b16 v[194:195], v30 offset:10240
    ds_read_b64_tr_b16 v[196:197], v31 offset:8192
    ds_read_b64_tr_b16 v[198:199], v31 offset:10240
    v_mfma_f32_32x32x16_bf16 v[72:87], v[200:203], v[172:175], v[72:87]
    v_exp_f32 v160, v160
    v_exp_f32 v161, v161
    v_exp_f32 v162, v162
    v_exp_f32 v163, v163
    v_add_f32 v20, v20, v160
    v_mfma_f32_32x32x16_bf16 v[88:103], v[204:207], v[172:175], v[88:103]
    v_add_f32 v21, v21, v161
    v_cvt_pk_bf16_f32 v180, v160, v161
    v_exp_f32 v164, v164
    v_exp_f32 v165, v165
    v_add_f32 v20, v20, v162
    v_mfma_f32_32x32x16_bf16 v[104:119], v[208:211], v[172:175], v[104:119]
    v_add_f32 v21, v21, v163
    v_cvt_pk_bf16_f32 v181, v162, v163
    v_exp_f32 v166, v166
    v_exp_f32 v167, v167
    v_add_f32 v20, v20, v164
    v_mfma_f32_32x32x16_bf16 v[120:135], v[212:215], v[172:175], v[120:135]
    v_add_f32 v21, v21, v165
    v_cvt_pk_bf16_f32 v182, v164, v165
    v_add_f32 v20, v20, v166
    v_add_f32 v21, v21, v167
    v_cvt_pk_bf16_f32 v183, v166, v167
    ds_read_b64_tr_b16 v[200:201], v28 offset:12288
    ds_read_b64_tr_b16 v[202:203], v28 offset:14336
    ds_read_b64_tr_b16 v[204:205], v29 offset:12288
    ds_read_b64_tr_b16 v[206:207], v29 offset:14336
    ds_read_b64_tr_b16 v[208:209], v30 offset:12288
    ds_read_b64_tr_b16 v[210:211], v30 offset:14336
    ds_read_b64_tr_b16 v[212:213], v31 offset:12288
    ds_read_b64_tr_b16 v[214:215], v31 offset:14336
L_joinL_r1:
    s_waitcnt lgkmcnt(8)
    v_mfma_f32_32x32x16_bf16 v[72:87], v[184:187], v[176:179], v[72:87]
    v_mfma_f32_32x32x16_bf16 v[88:103], v[188:191], v[176:179], v[88:103]
    v_mfma_f32_32x32x16_bf16 v[104:119], v[192:195], v[176:179], v[104:119]
    v_mfma_f32_32x32x16_bf16 v[120:135], v[196:199], v[176:179], v[120:135]
    s_waitcnt lgkmcnt(0)
    v_mfma_f32_32x32x16_bf16 v[72:87], v[200:203], v[180:183], v[72:87]
    v_mfma_f32_32x32x16_bf16 v[88:103], v[204:207], v[180:183], v[88:103]
    v_mfma_f32_32x32x16_bf16 v[104:119], v[208:211], v[180:183], v[104:119]
    v_mfma_f32_32x32x16_bf16 v[120:135], v[212:215], v[180:183], v[120:135]
    v_add_f32 v22, v20, v21
    v_mov_b32 v23, v22
    s_nop 1
    v_permlane32_swap_b32 v22, v23
    v_add_f32 v22, v22, v23
    v_rcp_f32 v22, v22
    s_nop 7
    s_add_u32 s34, s42, 0
    v_mul_f32 v72, v72, v22
    v_mul_f32 v73, v73, v22
    v_mul_f32 v74, v74, v22
    v_mul_f32 v75, v75, v22
    v_mul_f32 v80, v80, v22
    v_mul_f32 v81, v81, v22
    v_mul_f32 v82, v82, v22
    v_mul_f32 v83, v83, v22
    v_cvt_pk_bf16_f32 v184, v72, v73
    v_cvt_pk_bf16_f32 v185, v74, v75
    v_cvt_pk_bf16_f32 v186, v80, v81
    v_cvt_pk_bf16_f32 v187, v82, v83
    buffer_store_dwordx4 v[184:187], v26, s[24:27], s34 offen offset:0 sc1
    v_mul_f32 v76, v76, v22
    v_mul_f32 v77, v77, v22
    v_mul_f32 v78, v78, v22
    v_mul_f32 v79, v79, v22
    v_mul_f32 v84, v84, v22
    v_mul_f32 v85, v85, v22
    v_mul_f32 v86, v86, v22
    v_mul_f32 v87, v87, v22
    v_cvt_pk_bf16_f32 v188, v76, v77
    v_cvt_pk_bf16_f32 v189, v78, v79
    v_cvt_pk_bf16_f32 v190, v84, v85
    v_cvt_pk_bf16_f32 v191, v86, v87
    buffer_store_dwordx4 v[188:191], v26, s[24:27], s34 offen offset:512 sc1
    s_add_u32 s34, s42, 8192
    v_mul_f32 v88, v88, v22
    v_mul_f32 v89, v89, v22
    v_mul_f32 v90, v90, v22
    v_mul_f32 v91, v91, v22
    v_mul_f32 v96, v96, v22
    v_mul_f32 v97, v97, v22
    v_mul_f32 v98, v98, v22
    v_mul_f32 v99, v99, v22
    v_cvt_pk_bf16_f32 v192, v88, v89
    v_cvt_pk_bf16_f32 v193, v90, v91
    v_cvt_pk_bf16_f32 v194, v96, v97
    v_cvt_pk_bf16_f32 v195, v98, v99
    buffer_store_dwordx4 v[192:195], v26, s[24:27], s34 offen offset:0 sc1
    v_mul_f32 v92, v92, v22
    v_mul_f32 v93, v93, v22
    v_mul_f32 v94, v94, v22
    v_mul_f32 v95, v95, v22
    v_mul_f32 v100, v100, v22
    v_mul_f32 v101, v101, v22
    v_mul_f32 v102, v102, v22
    v_mul_f32 v103, v103, v22
    v_cvt_pk_bf16_f32 v196, v92, v93
    v_cvt_pk_bf16_f32 v197, v94, v95
    v_cvt_pk_bf16_f32 v198, v100, v101
    v_cvt_pk_bf16_f32 v199, v102, v103
    buffer_store_dwordx4 v[196:199], v26, s[24:27], s34 offen offset:512 sc1
    s_add_u32 s34, s42, 16384
    v_mul_f32 v104, v104, v22
    v_mul_f32 v105, v105, v22
    v_mul_f32 v106, v106, v22
    v_mul_f32 v107, v107, v22
    v_mul_f32 v112, v112, v22
    v_mul_f32 v113, v113, v22
    v_mul_f32 v114, v114, v22
    v_mul_f32 v115, v115, v22
    v_cvt_pk_bf16_f32 v200, v104, v105
    v_cvt_pk_bf16_f32 v201, v106, v107
    v_cvt_pk_bf16_f32 v202, v112, v113
    v_cvt_pk_bf16_f32 v203, v114, v115
    buffer_store_dwordx4 v[200:203], v26, s[24:27], s34 offen offset:0 sc1
    v_mul_f32 v108, v108, v22
    v_mul_f32 v109, v109, v22
    v_mul_f32 v110, v110, v22
    v_mul_f32 v111, v111, v22
    v_mul_f32 v116, v116, v22
    v_mul_f32 v117, v117, v22
    v_mul_f32 v118, v118, v22
    v_mul_f32 v119, v119, v22
    v_cvt_pk_bf16_f32 v204, v108, v109
    v_cvt_pk_bf16_f32 v205, v110, v111
    v_cvt_pk_bf16_f32 v206, v116, v117
    v_cvt_pk_bf16_f32 v207, v118, v119
    buffer_store_dwordx4 v[204:207], v26, s[24:27], s34 offen offset:512 sc1
    s_add_u32 s34, s42, 24576
    v_mul_f32 v120, v120, v22
    v_mul_f32 v121, v121, v22
    v_mul_f32 v122, v122, v22
    v_mul_f32 v123, v123, v22
    v_mul_f32 v128, v128, v22
    v_mul_f32 v129, v129, v22
    v_mul_f32 v130, v130, v22
    v_mul_f32 v131, v131, v22
    v_cvt_pk_bf16_f32 v208, v120, v121
    v_cvt_pk_bf16_f32 v209, v122, v123
    v_cvt_pk_bf16_f32 v210, v128, v129
    v_cvt_pk_bf16_f32 v211, v130, v131
    buffer_store_dwordx4 v[208:211], v26, s[24:27], s34 offen offset:0 sc1
    v_mul_f32 v124, v124, v22
    v_mul_f32 v125, v125, v22
    v_mul_f32 v126, v126, v22
    v_mul_f32 v127, v127, v22
    v_mul_f32 v132, v132, v22
    v_mul_f32 v133, v133, v22
    v_mul_f32 v134, v134, v22
    v_mul_f32 v135, v135, v22
    v_cvt_pk_bf16_f32 v212, v124, v125
    v_cvt_pk_bf16_f32 v213, v126, v127
    v_cvt_pk_bf16_f32 v214, v132, v133
    v_cvt_pk_bf16_f32 v215, v134, v135
    buffer_store_dwordx4 v[212:215], v26, s[24:27], s34 offen offset:512 sc1
    ds_read_b128 v[40:43], v27 offset:0
    ds_read_b128 v[44:47], v27 offset:1024
    ds_read_b128 v[48:51], v27 offset:2048
    ds_read_b128 v[52:55], v27 offset:3072
    ds_read_b128 v[56:59], v27 offset:4096
    ds_read_b128 v[60:63], v27 offset:5120
    ds_read_b128 v[64:67], v27 offset:6144
    ds_read_b128 v[68:71], v27 offset:7168
    v_mov_b64 v[72:73], 0
    v_mov_b64 v[74:75], 0
    v_mov_b64 v[76:77], 0
    v_mov_b64 v[78:79], 0
    v_mov_b64 v[80:81], 0
    v_mov_b64 v[82:83], 0
    v_mov_b64 v[84:85], 0
    v_mov_b64 v[86:87], 0
    v_mov_b64 v[88:89], 0
    v_mov_b64 v[90:91], 0
    v_mov_b64 v[92:93], 0
    v_mov_b64 v[94:95], 0
    v_mov_b64 v[96:97], 0
    v_mov_b64 v[98:99], 0
    v_mov_b64 v[100:101], 0
    v_mov_b64 v[102:103], 0
    v_mov_b64 v[104:105], 0
    v_mov_b64 v[106:107], 0
    v_mov_b64 v[108:109], 0
    v_mov_b64 v[110:111], 0
    v_mov_b64 v[112:113], 0
    v_mov_b64 v[114:115], 0
    v_mov_b64 v[116:117], 0
    v_mov_b64 v[118:119], 0
    v_mov_b64 v[120:121], 0
    v_mov_b64 v[122:123], 0
    v_mov_b64 v[124:125], 0
    v_mov_b64 v[126:127], 0
    v_mov_b64 v[128:129], 0
    v_mov_b64 v[130:131], 0
    v_mov_b64 v[132:133], 0
    v_mov_b64 v[134:135], 0
    v_mov_b64 v[240:241], 0
    v_mov_b64 v[242:243], 0
    v_mov_b64 v[244:245], 0
    v_mov_b64 v[246:247], 0
    v_mov_b64 v[248:249], 0
    v_mov_b64 v[250:251], 0
    v_mov_b64 v[252:253], 0
    v_mov_b64 v[254:255], 0
    v_mov_b32 v20, 0
    v_mov_b32 v21, 0
    s_mov_b32 s46, 0xff800000
    s_waitcnt lgkmcnt(0)
    s_mov_b32 s45, 16384
    v_add_u32 v32, s45, v10
    v_xor_b32 v33, 32, v32
    v_xor_b32 v34, 64, v32
    v_xor_b32 v35, 96, v32
    v_xor_b32 v36, 128, v32
    v_xor_b32 v37, 160, v32
    v_xor_b32 v38, 192, v32
    v_xor_b32 v39, 224, v32
    ds_read_b128 v[216:219], v32 offset:0
    ds_read_b128 v[220:223], v33 offset:0
    ds_read_b128 v[224:227], v34 offset:0
    ds_read_b128 v[228:231], v35 offset:0
    ds_read_b128 v[232:235], v36 offset:0
    ds_read_b128 v[236:239], v37 offset:0
    ds_read_b128 v[184:187], v38 offset:0
    ds_read_b128 v[188:191], v39 offset:0
    s_mov_b32 s44, 49152
    v_add_u32 v28, s44, v11
    v_add_u32 v29, s44, v12
    v_add_u32 v30, s44, v13
    v_add_u32 v31, s44, v14
    s_waitcnt lgkmcnt(7)
    v_mfma_f32_32x32x16_bf16 v[136:151], v[216:219], v[40:43], v[240:255]
    s_waitcnt lgkmcnt(6)
    v_mfma_f32_32x32x16_bf16 v[136:151], v[220:223], v[44:47], v[136:151]
    s_waitcnt lgkmcnt(5)
    v_mfma_f32_32x32x16_bf16 v[136:151], v[224:227], v[48:51], v[136:151]
    s_waitcnt lgkmcnt(4)
    v_mfma_f32_32x32x16_bf16 v[136:151], v[228:231], v[52:55], v[136:151]
    s_waitcnt lgkmcnt(3)
    v_mfma_f32_32x32x16_bf16 v[136:151], v[232:235], v[56:59], v[136:151]
    s_waitcnt lgkmcnt(2)
    v_mfma_f32_32x32x16_bf16 v[136:151], v[236:239], v[60:63], v[136:151]
    s_waitcnt lgkmcnt(1)
    v_mfma_f32_32x32x16_bf16 v[136:151], v[184:187], v[64:67], v[136:151]
    s_waitcnt lgkmcnt(0)
    v_mfma_f32_32x32x16_bf16 v[136:151], v[188:191], v[68:71], v[136:151]
    ds_read_b128 v[192:195], v32 offset:8192
    ds_read_b128 v[196:199], v33 offset:8192
    ds_read_b128 v[216:219], v34 offset:8192
    ds_read_b128 v[220:223], v35 offset:8192
    ds_read_b128 v[224:227], v36 offset:8192
    ds_read_b128 v[228:231], v37 offset:8192
    ds_read_b128 v[232:235], v38 offset:8192
    ds_read_b128 v[236:239], v39 offset:8192
    s_nop 7
    s_nop 3
    v_max3_f32 v22, v136, v137, v138
    v_max3_f32 v23, v139, v140, v141
    v_max3_f32 v22, v22, v142, v143
    v_max3_f32 v23, v23, v144, v145
    v_max3_f32 v22, v22, v146, v147
    v_max3_f32 v23, v23, v148, v149
    v_max3_f32 v23, v23, v150, v151
    v_max_f32 v22, v22, v23
    v_cmp_lt_f32 vcc, s46, v22
    s_nop 0
    s_cbranch_vccnz L_slow0_pb
L_fast0_pb:
    s_waitcnt lgkmcnt(0)
    v_mfma_f32_32x32x16_bf16 v[152:167], v[192:195], v[40:43], v[240:255]
    v_exp_f32 v136, v136
    v_exp_f32 v137, v137
    v_exp_f32 v138, v138
    v_exp_f32 v139, v139
    v_add_f32 v20, v20, v136
    ds_read_b64_tr_b16 v[200:201], v28 offset:4096
    v_mfma_f32_32x32x16_bf16 v[152:167], v[196:199], v[44:47], v[152:167]
    v_add_f32 v21, v21, v137
    v_cvt_pk_bf16_f32 v168, v136, v137
    v_exp_f32 v140, v140
    v_exp_f32 v141, v141
    v_add_f32 v20, v20, v138
    ds_read_b64_tr_b16 v[202:203], v28 offset:6144
    v_mfma_f32_32x32x16_bf16 v[152:167], v[216:219], v[48:51], v[152:167]
    v_add_f32 v21, v21, v139
    v_cvt_pk_bf16_f32 v169, v138, v139
    v_exp_f32 v142, v142
    v_exp_f32 v143, v143
    v_add_f32 v20, v20, v140
    ds_read_b64_tr_b16 v[204:205], v29 offset:4096
    v_mfma_f32_32x32x16_bf16 v[152:167], v[220:223], v[52:55], v[152:167]
    v_add_f32 v21, v21, v141
    v_cvt_pk_bf16_f32 v170, v140, v141
    v_add_f32 v20, v20, v142
    v_add_f32 v21, v21, v143
    v_cvt_pk_bf16_f32 v171, v142, v143
    ds_read_b64_tr_b16 v[206:207], v29 offset:6144
    v_mfma_f32_32x32x16_bf16 v[152:167], v[224:227], v[56:59], v[152:167]
    v_exp_f32 v144, v144
    v_exp_f32 v145, v145
    v_exp_f32 v146, v146
    v_exp_f32 v147, v147
    v_add_f32 v20, v20, v144
    ds_read_b64_tr_b16 v[208:209], v30 offset:4096
    v_mfma_f32_32x32x16_bf16 v[152:167], v[228:231], v[60:63], v[152:167]
    v_add_f32 v21, v21, v145
    v_cvt_pk_bf16_f32 v172, v144, v145
    v_exp_f32 v148, v148
    v_exp_f32 v149, v149
    v_add_f32 v20, v20, v146
    ds_read_b64_tr_b16 v[210:211], v30 offset:6144
    v_mfma_f32_32x32x16_bf16 v[152:167], v[232:235], v[64:67], v[152:167]
    v_add_f32 v21, v21, v147
    v_cvt_pk_bf16_f32 v173, v146, v147
    v_exp_f32 v150, v150
    v_exp_f32 v151, v151
    v_add_f32 v20, v20, v148
    ds_read_b64_tr_b16 v[212:213], v31 offset:4096
    v_mfma_f32_32x32x16_bf16 v[152:167], v[236:239], v[68:71], v[152:167]
    v_add_f32 v21, v21, v149
    v_cvt_pk_bf16_f32 v174, v148, v149
    v_add_f32 v20, v20, v150
    v_add_f32 v21, v21, v151
    v_cvt_pk_bf16_f32 v175, v150, v151
    ds_read_b64_tr_b16 v[214:215], v31 offset:6144
    ds_read_b64_tr_b16 v[184:185], v28 offset:0
    ds_read_b64_tr_b16 v[186:187], v28 offset:2048
    ds_read_b64_tr_b16 v[188:189], v29 offset:0
    ds_read_b64_tr_b16 v[190:191], v29 offset:2048
    ds_read_b64_tr_b16 v[192:193], v30 offset:0
    ds_read_b64_tr_b16 v[194:195], v30 offset:2048
    ds_read_b64_tr_b16 v[196:197], v31 offset:0
    ds_read_b64_tr_b16 v[198:199], v31 offset:2048
    s_mov_b32 s31, 16384
    s_mov_b32 s45, 32768
    s_mov_b32 s59, 98304
    v_add_u32 v32, s45, v10
    v_xor_b32 v33, 32, v32
    v_xor_b32 v34, 64, v32
    v_xor_b32 v35, 96, v32
    v_xor_b32 v36, 128, v32
    v_xor_b32 v37, 160, v32
    v_xor_b32 v38, 192, v32
    v_xor_b32 v39, 224, v32
    s_mov_b32 s32, 0
L_att_r2:
    s_barrier
    s_waitcnt lgkmcnt(6)
    v_mfma_f32_32x32x16_bf16 v[72:87], v[184:187], v[168:171], v[72:87]
    v_max3_f32 v22, v152, v153, v154
    v_max3_f32 v23, v155, v156, v157
    v_max3_f32 v22, v22, v158, v159
    v_max3_f32 v23, v23, v160, v161
    v_max3_f32 v22, v22, v162, v163
    v_max3_f32 v23, v23, v164, v165
    s_waitcnt lgkmcnt(4)
    v_mfma_f32_32x32x16_bf16 v[88:103], v[188:191], v[168:171], v[88:103]
    v_max3_f32 v23, v23, v166, v167
    v_max_f32 v22, v22, v23
    v_cmp_lt_f32 vcc, s43, v22
    s_nop 0
    s_cbranch_vccnz L_slow1_r2
L_fast1_r2:
    ds_read_b128 v[216:219], v32 offset:0
    s_waitcnt lgkmcnt(3)
    v_mfma_f32_32x32x16_bf16 v[104:119], v[192:195], v[168:171], v[104:119]
    ds_read_b128 v[220:223], v33 offset:0
    v_exp_f32 v152, v152
    v_exp_f32 v153, v153
    ds_read_b128 v[224:227], v34 offset:0
    s_waitcnt lgkmcnt(3)
    v_mfma_f32_32x32x16_bf16 v[120:135], v[196:199], v[168:171], v[120:135]
    ds_read_b64_tr_b16 v[184:185], v28 offset:8192
    ds_read_b64_tr_b16 v[186:187], v28 offset:10240
    ds_read_b64_tr_b16 v[188:189], v29 offset:8192
    v_exp_f32 v154, v154
    v_mfma_f32_32x32x16_bf16 v[72:87], v[200:203], v[172:175], v[72:87]
    ds_read_b64_tr_b16 v[190:191], v29 offset:10240
    ds_read_b64_tr_b16 v[192:193], v30 offset:8192
    ds_read_b64_tr_b16 v[194:195], v30 offset:10240
    v_exp_f32 v155, v155
    v_add_f32 v20, v20, v152
    v_mfma_f32_32x32x16_bf16 v[88:103], v[204:207], v[172:175], v[88:103]
    v_add_f32 v21, v21, v153
    v_cvt_pk_bf16_f32 v176, v152, v153
    v_exp_f32 v156, v156
    v_exp_f32 v157, v157
    v_mfma_f32_32x32x16_bf16 v[104:119], v[208:211], v[172:175], v[104:119]
    v_add_f32 v20, v20, v154
    v_add_f32 v21, v21, v155
    v_cvt_pk_bf16_f32 v177, v154, v155
    v_exp_f32 v158, v158
    v_exp_f32 v159, v159
    v_add_f32 v20, v20, v156
    v_add_f32 v21, v21, v157
    v_cvt_pk_bf16_f32 v178, v156, v157
    v_add_f32 v20, v20, v158
    v_add_f32 v21, v21, v159
    v_cvt_pk_bf16_f32 v179, v158, v159
    ds_read_b64_tr_b16 v[196:197], v31 offset:8192
    ds_read_b64_tr_b16 v[198:199], v31 offset:10240
    v_mfma_f32_32x32x16_bf16 v[120:135], v[212:215], v[172:175], v[120:135]
    ds_read_b128 v[228:231], v35 offset:0
    ds_read_b128 v[232:235], v36 offset:0
    v_exp_f32 v160, v160
    v_exp_f32 v161, v161
L_j8_r2:
    s_waitcnt lgkmcnt(8)
    v_mfma_f32_32x32x16_bf16 v[72:87], v[184:187], v[176:179], v[72:87]
    ds_read_b64_tr_b16 v[200:201], v28 offset:12288
    ds_read_b64_tr_b16 v[202:203], v28 offset:14336
    ds_read_b128 v[236:239], v37 offset:0
    v_exp_f32 v162, v162
    s_waitcnt lgkmcnt(9)
    v_mfma_f32_32x32x16_bf16 v[88:103], v[188:191], v[176:179], v[88:103]
    ds_read_b64_tr_b16 v[204:205], v29 offset:12288
    ds_read_b64_tr_b16 v[206:207], v29 offset:14336
    ds_read_b64_tr_b16 v[208:209], v30 offset:12288
    v_exp_f32 v163, v163
    v_add_f32 v20, v20, v160
    s_waitcnt lgkmcnt(10)
    v_mfma_f32_32x32x16_bf16 v[104:119], v[192:195], v[176:179], v[104:119]
    ds_read_b64_tr_b16 v[210:211], v30 offset:14336
    ds_read_b64_tr_b16 v[212:213], v31 offset:12288
    ds_read_b64_tr_b16 v[214:215], v31 offset:14336
    v_add_f32 v21, v21, v161
    v_cvt_pk_bf16_f32 v180, v160, v161
    s_waitcnt lgkmcnt(11)
    v_mfma_f32_32x32x16_bf16 v[120:135], v[196:199], v[176:179], v[120:135]
    ds_read_b128 v[184:187], v38 offset:0
    ds_read_b128 v[188:191], v39 offset:0
    v_exp_f32 v164, v164
    v_exp_f32 v165, v165
    v_mfma_f32_32x32x16_bf16 v[136:151], v[216:219], v[40:43], v[240:255]
    ds_read_b128 v[192:195], v32 offset:8192
    ds_read_b128 v[196:199], v33 offset:8192
    v_add_f32 v20, v20, v162
    v_add_f32 v21, v21, v163
    v_cvt_pk_bf16_f32 v181, v162, v163
    v_mfma_f32_32x32x16_bf16 v[136:151], v[220:223], v[44:47], v[136:151]
    ds_read_b128 v[216:219], v34 offset:8192
    ds_read_b128 v[220:223], v35 offset:8192
    v_exp_f32 v166, v166
    v_exp_f32 v167, v167
    v_mfma_f32_32x32x16_bf16 v[136:151], v[224:227], v[48:51], v[136:151]
    v_add_f32 v20, v20, v164
    v_add_f32 v21, v21, v165
    v_cvt_pk_bf16_f32 v182, v164, v165
    v_add_f32 v20, v20, v166
    v_add_f32 v21, v21, v167
    v_cvt_pk_bf16_f32 v183, v166, v167
    s_waitcnt lgkmcnt(15)
    v_mfma_f32_32x32x16_bf16 v[136:151], v[228:231], v[52:55], v[136:151]
    ds_read_b128 v[224:227], v36 offset:8192
    ds_read_b128 v[228:231], v37 offset:8192
    s_add_u32 s36, s44, 16384
    s_cmp_ge_u32 s36, 114688
    s_cselect_b32 s36, 49152, s36
    s_waitcnt lgkmcnt(15)
    v_mfma_f32_32x32x16_bf16 v[136:151], v[232:235], v[56:59], v[136:151]
    ds_read_b128 v[232:235], v38 offset:8192
    s_waitcnt lgkmcnt(15)
    v_mfma_f32_32x32x16_bf16 v[136:151], v[236:239], v[60:63], v[136:151]
    ds_read_b128 v[236:239], v39 offset:8192
    s_add_u32 s37, s45, 16384
    s_cmp_ge_u32 s37, 49152
    s_cselect_b32 s37, 0, s37
    s_waitcnt lgkmcnt(9)
    v_mfma_f32_32x32x16_bf16 v[136:151], v[184:187], v[64:67], v[136:151]
    s_waitcnt lgkmcnt(8)
    v_mfma_f32_32x32x16_bf16 v[136:151], v[188:191], v[68:71], v[136:151]
    v_add_u32 v28, s36, v11
    v_add_u32 v29, s36, v12
    v_add_u32 v30, s36, v13
    v_add_u32 v31, s36, v14
    v_add_u32 v32, s37, v10
    v_xor_b32 v33, 32, v32
    v_mfma_f32_32x32x16_bf16 v[72:87], v[200:203], v[180:183], v[72:87]
    v_xor_b32 v34, 64, v32
    v_xor_b32 v35, 96, v32
    v_xor_b32 v36, 128, v32
    v_xor_b32 v37, 160, v32
    v_xor_b32 v38, 192, v32
    v_xor_b32 v39, 224, v32
    v_mfma_f32_32x32x16_bf16 v[88:103], v[204:207], v[180:183], v[88:103]
    s_mov_b32 s59, s44
    s_mov_b32 s31, s45
    v_mfma_f32_32x32x16_bf16 v[104:119], v[208:211], v[180:183], v[104:119]
    v_max3_f32 v22, v136, v137, v138
    v_max3_f32 v23, v139, v140, v141
    v_max3_f32 v22, v22, v142, v143
    v_max3_f32 v23, v23, v144, v145
    v_max3_f32 v22, v22, v146, v147
    v_max3_f32 v23, v23, v148, v149
    v_mfma_f32_32x32x16_bf16 v[120:135], v[212:215], v[180:183], v[120:135]
    v_max3_f32 v23, v23, v150, v151
    v_max_f32 v22, v22, v23
    v_cmp_lt_f32 vcc, s46, v22
    s_nop 0
    s_cbranch_vccnz L_slow0_r2
L_fast0_r2:
    ds_read_b64_tr_b16 v[200:201], v28 offset:4096
    s_waitcnt lgkmcnt(8)
    v_mfma_f32_32x32x16_bf16 v[152:167], v[192:195], v[40:43], v[240:255]
    ds_read_b64_tr_b16 v[202:203], v28 offset:6144
    ds_read_b64_tr_b16 v[204:205], v29 offset:4096
    ds_read_b64_tr_b16 v[206:207], v29 offset:6144
    v_exp_f32 v136, v136
    s_waitcnt lgkmcnt(10)
    v_mfma_f32_32x32x16_bf16 v[152:167], v[196:199], v[44:47], v[152:167]
    ds_read_b64_tr_b16 v[208:209], v30 offset:4096
    ds_read_b64_tr_b16 v[210:211], v30 offset:6144
    ds_read_b64_tr_b16 v[212:213], v31 offset:4096
    v_exp_f32 v137, v137
    s_waitcnt lgkmcnt(12)
    v_mfma_f32_32x32x16_bf16 v[152:167], v[216:219], v[48:51], v[152:167]
    ds_read_b64_tr_b16 v[214:215], v31 offset:6144
    ds_read_b64_tr_b16 v[184:185], v28 offset:0
    ds_read_b64_tr_b16 v[186:187], v28 offset:2048
    v_exp_f32 v138, v138
    s_waitcnt lgkmcnt(14)
    v_mfma_f32_32x32x16_bf16 v[152:167], v[220:223], v[52:55], v[152:167]
    ds_read_b64_tr_b16 v[188:189], v29 offset:0
    ds_read_b64_tr_b16 v[190:191], v29 offset:2048
    ds_read_b64_tr_b16 v[192:193], v30 offset:0
    v_exp_f32 v139, v139
    v_add_f32 v20, v20, v136
    s_waitcnt lgkmcnt(15)
    v_mfma_f32_32x32x16_bf16 v[152:167], v[224:227], v[56:59], v[152:167]
    ds_read_b64_tr_b16 v[194:195], v30 offset:2048
    ds_read_b64_tr_b16 v[196:197], v31 offset:0
    ds_read_b64_tr_b16 v[198:199], v31 offset:2048
    v_add_f32 v21, v21, v137
    v_cvt_pk_bf16_f32 v168, v136, v137
    s_waitcnt lgkmcnt(15)
    v_mfma_f32_32x32x16_bf16 v[152:167], v[228:231], v[60:63], v[152:167]
    v_exp_f32 v140, v140
    v_exp_f32 v141, v141
    v_add_f32 v20, v20, v138
    v_add_f32 v21, v21, v139
    s_waitcnt lgkmcnt(15)
    v_mfma_f32_32x32x16_bf16 v[152:167], v[232:235], v[64:67], v[152:167]
    v_cvt_pk_bf16_f32 v169, v138, v139
    v_exp_f32 v142, v142
    v_exp_f32 v143, v143
    v_add_f32 v20, v20, v140
    s_waitcnt lgkmcnt(15)
    v_mfma_f32_32x32x16_bf16 v[152:167], v[236:239], v[68:71], v[152:167]
    v_add_f32 v21, v21, v141
    v_cvt_pk_bf16_f32 v170, v140, v141
    v_add_f32 v20, v20, v142
    v_add_f32 v21, v21, v143
    v_cvt_pk_bf16_f32 v171, v142, v143
    v_exp_f32 v144, v144
    v_exp_f32 v145, v145
    v_exp_f32 v146, v146
    v_exp_f32 v147, v147
    v_add_f32 v20, v20, v144
    v_add_f32 v21, v21, v145
    v_cvt_pk_bf16_f32 v172, v144, v145
    v_exp_f32 v148, v148
    v_exp_f32 v149, v149
    v_add_f32 v20, v20, v146
    v_add_f32 v21, v21, v147
    v_cvt_pk_bf16_f32 v173, v146, v147
    v_exp_f32 v150, v150
    v_exp_f32 v151, v151
    v_add_f32 v20, v20, v148
    v_add_f32 v21, v21, v149
    v_cvt_pk_bf16_f32 v174, v148, v149
    v_add_f32 v20, v20, v150
    v_add_f32 v21, v21, v151
    v_cvt_pk_bf16_f32 v175, v150, v151
    s_mov_b32 s44, s36
    s_mov_b32 s45, s37
    s_waitcnt vmcnt(0)
    s_add_u32 s32, s32, 1
    s_cmp_lt_u32 s32, 15
    s_cbranch_scc1 L_att_r2
    s_barrier
    v_max3_f32 v22, v152, v153, v154
    v_max3_f32 v23, v155, v156, v157
    v_max3_f32 v22, v22, v158, v159
    v_max3_f32 v23, v23, v160, v161
    v_max3_f32 v22, v22, v162, v163
    v_max3_f32 v23, v23, v164, v165
    v_max3_f32 v23, v23, v166, v167
    v_max_f32 v22, v22, v23
    v_cmp_lt_f32 vcc, s43, v22
    s_waitcnt lgkmcnt(0)
    s_cbranch_vccnz L_slowL_r2
    v_mfma_f32_32x32x16_bf16 v[72:87], v[184:187], v[168:171], v[72:87]
    v_exp_f32 v152, v152
    v_exp_f32 v153, v153
    v_exp_f32 v154, v154
    v_exp_f32 v155, v155
    v_add_f32 v20, v20, v152
    v_mfma_f32_32x32x16_bf16 v[88:103], v[188:191], v[168:171], v[88:103]
    v_add_f32 v21, v21, v153
    v_cvt_pk_bf16_f32 v176, v152, v153
    v_exp_f32 v156, v156
    v_exp_f32 v157, v157
    v_add_f32 v20, v20, v154
    v_mfma_f32_32x32x16_bf16 v[104:119], v[192:195], v[168:171], v[104:119]
    v_add_f32 v21, v21, v155
    v_cvt_pk_bf16_f32 v177, v154, v155
    v_exp_f32 v158, v158
    v_exp_f32 v159, v159
    v_add_f32 v20, v20, v156
    v_mfma_f32_32x32x16_bf16 v[120:135], v[196:199], v[168:171], v[120:135]
    v_add_f32 v21, v21, v157
    v_cvt_pk_bf16_f32 v178, v156, v157
    v_add_f32 v20, v20, v158
    v_add_f32 v21, v21, v159
    v_cvt_pk_bf16_f32 v179, v158, v159
    ds_read_b64_tr_b16 v[184:185], v28 offset:8192
    ds_read_b64_tr_b16 v[186:187], v28 offset:10240
    ds_read_b64_tr_b16 v[188:189], v29 offset:8192
    ds_read_b64_tr_b16 v[190:191], v29 offset:10240
    ds_read_b64_tr_b16 v[192:193], v30 offset:8192
    ds_read_b64_tr_b16 v[194:195], v30 offset:10240
    ds_read_b64_tr_b16 v[196:197], v31 offset:8192
    ds_read_b64_tr_b16 v[198:199], v31 offset:10240
    v_mfma_f32_32x32x16_bf16 v[72:87], v[200:203], v[172:175], v[72:87]
    v_exp_f32 v160, v160
    v_exp_f32 v161, v161
    v_exp_f32 v162, v162
    v_exp_f32 v163, v163
    v_add_f32 v20, v20, v160
    v_mfma_f32_32x32x16_bf16 v[88:103], v[204:207], v[172:175], v[88:103]
    v_add_f32 v21, v21, v161
    v_cvt_pk_bf16_f32 v180, v160, v161
    v_exp_f32 v164, v164
    v_exp_f32 v165, v165
    v_add_f32 v20, v20, v162
    v_mfma_f32_32x32x16_bf16 v[104:119], v[208:211], v[172:175], v[104:119]
    v_add_f32 v21, v21, v163
    v_cvt_pk_bf16_f32 v181, v162, v163
    v_exp_f32 v166, v166
    v_exp_f32 v167, v167
    v_add_f32 v20, v20, v164
    v_mfma_f32_32x32x16_bf16 v[120:135], v[212:215], v[172:175], v[120:135]
    v_add_f32 v21, v21, v165
    v_cvt_pk_bf16_f32 v182, v164, v165
    v_add_f32 v20, v20, v166
    v_add_f32 v21, v21, v167
    v_cvt_pk_bf16_f32 v183, v166, v167
    ds_read_b64_tr_b16 v[200:201], v28 offset:12288
    ds_read_b64_tr_b16 v[202:203], v28 offset:14336
    ds_read_b64_tr_b16 v[204:205], v29 offset:12288
    ds_read_b64_tr_b16 v[206:207], v29 offset:14336
    ds_read_b64_tr_b16 v[208:209], v30 offset:12288
    ds_read_b64_tr_b16 v[210:211], v30 offset:14336
    ds_read_b64_tr_b16 v[212:213], v31 offset:12288
    ds_read_b64_tr_b16 v[214:215], v31 offset:14336
L_joinL_r2:
    s_waitcnt lgkmcnt(8)
    v_mfma_f32_32x32x16_bf16 v[72:87], v[184:187], v[176:179], v[72:87]
    v_mfma_f32_32x32x16_bf16 v[88:103], v[188:191], v[176:179], v[88:103]
    v_mfma_f32_32x32x16_bf16 v[104:119], v[192:195], v[176:179], v[104:119]
    v_mfma_f32_32x32x16_bf16 v[120:135], v[196:199], v[176:179], v[120:135]
    s_waitcnt lgkmcnt(0)
    v_mfma_f32_32x32x16_bf16 v[72:87], v[200:203], v[180:183], v[72:87]
    v_mfma_f32_32x32x16_bf16 v[88:103], v[204:207], v[180:183], v[88:103]
    v_mfma_f32_32x32x16_bf16 v[104:119], v[208:211], v[180:183], v[104:119]
    v_mfma_f32_32x32x16_bf16 v[120:135], v[212:215], v[180:183], v[120:135]
    v_add_f32 v22, v20, v21
    v_mov_b32 v23, v22
    s_nop 1
    v_permlane32_swap_b32 v22, v23
    v_add_f32 v22, v22, v23
    v_rcp_f32 v22, v22
    s_nop 7
    s_add_u32 s34, s42, 524288
    v_mul_f32 v72, v72, v22
    v_mul_f32 v73, v73, v22
    v_mul_f32 v74, v74, v22
    v_mul_f32 v75, v75, v22
    v_mul_f32 v80, v80, v22
    v_mul_f32 v81, v81, v22
    v_mul_f32 v82, v82, v22
    v_mul_f32 v83, v83, v22
    v_cvt_pk_bf16_f32 v184, v72, v73
    v_cvt_pk_bf16_f32 v185, v74, v75
    v_cvt_pk_bf16_f32 v186, v80, v81
    v_cvt_pk_bf16_f32 v187, v82, v83
    buffer_store_dwordx4 v[184:187], v26, s[24:27], s34 offen offset:0 sc1
    v_mul_f32 v76, v76, v22
    v_mul_f32 v77, v77, v22
    v_mul_f32 v78, v78, v22
    v_mul_f32 v79, v79, v22
    v_mul_f32 v84, v84, v22
    v_mul_f32 v85, v85, v22
    v_mul_f32 v86, v86, v22
    v_mul_f32 v87, v87, v22
    v_cvt_pk_bf16_f32 v188, v76, v77
    v_cvt_pk_bf16_f32 v189, v78, v79
    v_cvt_pk_bf16_f32 v190, v84, v85
    v_cvt_pk_bf16_f32 v191, v86, v87
    buffer_store_dwordx4 v[188:191], v26, s[24:27], s34 offen offset:512 sc1
    s_add_u32 s34, s42, 532480
    v_mul_f32 v88, v88, v22
    v_mul_f32 v89, v89, v22
    v_mul_f32 v90, v90, v22
    v_mul_f32 v91, v91, v22
    v_mul_f32 v96, v96, v22
    v_mul_f32 v97, v97, v22
    v_mul_f32 v98, v98, v22
    v_mul_f32 v99, v99, v22
    v_cvt_pk_bf16_f32 v192, v88, v89
    v_cvt_pk_bf16_f32 v193, v90, v91
    v_cvt_pk_bf16_f32 v194, v96, v97
    v_cvt_pk_bf16_f32 v195, v98, v99
    buffer_store_dwordx4 v[192:195], v26, s[24:27], s34 offen offset:0 sc1
    v_mul_f32 v92, v92, v22
    v_mul_f32 v93, v93, v22
    v_mul_f32 v94, v94, v22
    v_mul_f32 v95, v95, v22
    v_mul_f32 v100, v100, v22
    v_mul_f32 v101, v101, v22
    v_mul_f32 v102, v102, v22
    v_mul_f32 v103, v103, v22
    v_cvt_pk_bf16_f32 v196, v92, v93
    v_cvt_pk_bf16_f32 v197, v94, v95
    v_cvt_pk_bf16_f32 v198, v100, v101
    v_cvt_pk_bf16_f32 v199, v102, v103
    buffer_store_dwordx4 v[196:199], v26, s[24:27], s34 offen offset:512 sc1
    s_add_u32 s34, s42, 540672
    v_mul_f32 v104, v104, v22
    v_mul_f32 v105, v105, v22
    v_mul_f32 v106, v106, v22
    v_mul_f32 v107, v107, v22
    v_mul_f32 v112, v112, v22
    v_mul_f32 v113, v113, v22
    v_mul_f32 v114, v114, v22
    v_mul_f32 v115, v115, v22
    v_cvt_pk_bf16_f32 v200, v104, v105
    v_cvt_pk_bf16_f32 v201, v106, v107
    v_cvt_pk_bf16_f32 v202, v112, v113
    v_cvt_pk_bf16_f32 v203, v114, v115
    buffer_store_dwordx4 v[200:203], v26, s[24:27], s34 offen offset:0 sc1
    v_mul_f32 v108, v108, v22
    v_mul_f32 v109, v109, v22
    v_mul_f32 v110, v110, v22
    v_mul_f32 v111, v111, v22
    v_mul_f32 v116, v116, v22
    v_mul_f32 v117, v117, v22
    v_mul_f32 v118, v118, v22
    v_mul_f32 v119, v119, v22
    v_cvt_pk_bf16_f32 v204, v108, v109
    v_cvt_pk_bf16_f32 v205, v110, v111
    v_cvt_pk_bf16_f32 v206, v116, v117
    v_cvt_pk_bf16_f32 v207, v118, v119
    buffer_store_dwordx4 v[204:207], v26, s[24:27], s34 offen offset:512 sc1
    s_add_u32 s34, s42, 548864
    v_mul_f32 v120, v120, v22
    v_mul_f32 v121, v121, v22
    v_mul_f32 v122, v122, v22
    v_mul_f32 v123, v123, v22
    v_mul_f32 v128, v128, v22
    v_mul_f32 v129, v129, v22
    v_mul_f32 v130, v130, v22
    v_mul_f32 v131, v131, v22
    v_cvt_pk_bf16_f32 v208, v120, v121
    v_cvt_pk_bf16_f32 v209, v122, v123
    v_cvt_pk_bf16_f32 v210, v128, v129
    v_cvt_pk_bf16_f32 v211, v130, v131
    buffer_store_dwordx4 v[208:211], v26, s[24:27], s34 offen offset:0 sc1
    v_mul_f32 v124, v124, v22
    v_mul_f32 v125, v125, v22
    v_mul_f32 v126, v126, v22
    v_mul_f32 v127, v127, v22
    v_mul_f32 v132, v132, v22
    v_mul_f32 v133, v133, v22
    v_mul_f32 v134, v134, v22
    v_mul_f32 v135, v135, v22
    v_cvt_pk_bf16_f32 v212, v124, v125
    v_cvt_pk_bf16_f32 v213, v126, v127
    v_cvt_pk_bf16_f32 v214, v132, v133
    v_cvt_pk_bf16_f32 v215, v134, v135
    buffer_store_dwordx4 v[212:215], v26, s[24:27], s34 offen offset:512 sc1
    s_waitcnt vmcnt(0)
    v_mov_b32 v10, 124928
    v_mov_b32 v11, 1
    s_mov_b64 exec, 1
    ds_add_rtn_u32 v12, v10, v11
    s_waitcnt lgkmcnt(0)
    s_mov_b64 exec, -1
    v_readfirstlane_b32 s36, v12
    s_nop 1
    s_cmp_eq_u32 s36, 3
    s_cbranch_scc0 L_nosig_b
    s_and_b32 s34, s97, 31
    s_add_u32 s34, s34, 16
    s_lshl_b32 s35, 1, s34
    s_lshr_b32 s34, s97, 5
    s_lshl_b32 s34, s34, 4
    v_mov_b32 v15, s35
    v_mov_b32 v13, s34
    s_mov_b64 exec, 1
    buffer_atomic_or v15, v13, s[84:87], 0 offen sc1
    s_mov_b64 exec, -1
L_nosig_b:
    s_barrier
    s_setprio 0

    v_add_u32 v10, 0, v1
    v_mul_u32_u24 v11, 6554, v10
    v_lshrrev_b32 v11, 16, v11
    v_mul_u32_u24 v12, 10, v11
    v_sub_u32 v12, v10, v12
    v_mul_u32_u24 v11, 1280, v11
    v_lshl_add_u32 v11, v12, 4, v11
    v_subrev_u32 v2, 0, v11

    v_add_u32 v10, 64, v1
    v_mul_u32_u24 v11, 6554, v10
    v_lshrrev_b32 v11, 16, v11
    v_mul_u32_u24 v12, 10, v11
    v_sub_u32 v12, v10, v12
    v_mul_u32_u24 v11, 1280, v11
    v_lshl_add_u32 v11, v12, 4, v11
    v_subrev_u32 v3, 1024, v11

    v_add_u32 v10, 128, v1
    v_mul_u32_u24 v11, 6554, v10
    v_lshrrev_b32 v11, 16, v11
    v_mul_u32_u24 v12, 10, v11
    v_sub_u32 v12, v10, v12
    v_mul_u32_u24 v11, 1280, v11
    v_lshl_add_u32 v11, v12, 4, v11
    v_subrev_u32 v4, 2048, v11

    v_add_u32 v10, 192, v1
    v_mul_u32_u24 v11, 6554, v10
    v_lshrrev_b32 v11, 16, v11
    v_mul_u32_u24 v12, 10, v11
    v_sub_u32 v12, v10, v12
    v_mul_u32_u24 v11, 1280, v11
    v_lshl_add_u32 v11, v12, 4, v11
    v_subrev_u32 v5, 3072, v11

    v_add_u32 v10, 256, v1
    v_mul_u32_u24 v11, 6554, v10
    v_lshrrev_b32 v11, 16, v11
    v_mul_u32_u24 v12, 10, v11
    v_sub_u32 v12, v10, v12
    v_mul_u32_u24 v11, 1280, v11
    v_lshl_add_u32 v11, v12, 4, v11
    v_subrev_u32 v6, 0, v11

    v_lshrrev_b32 v10, 4, v1
    v_bfe_u32 v11, v1, 2, 2
    v_lshl_add_u32 v10, v10, 2, v11
    v_mul_u32_u24 v10, 160, v10
    v_and_b32 v11, 3, v1
    v_lshl_add_u32 v8, v11, 3, v10

    v_lshlrev_b32 v7, 4, v1
    v_mov_b64 v[32:33], 0
    v_mov_b64 v[34:35], 0
    v_mov_b64 v[36:37], 0
    v_mov_b64 v[38:39], 0
    v_mov_b64 v[40:41], 0
    v_mov_b64 v[42:43], 0
    v_mov_b64 v[44:45], 0
    v_mov_b64 v[46:47], 0
    v_mov_b64 v[48:49], 0
    v_mov_b64 v[50:51], 0
    v_mov_b64 v[52:53], 0
    v_mov_b64 v[54:55], 0
    v_mov_b64 v[56:57], 0
    v_mov_b64 v[58:59], 0
    v_mov_b64 v[60:61], 0
    v_mov_b64 v[62:63], 0
    v_mov_b64 v[64:65], 0
    v_mov_b64 v[66:67], 0
    v_mov_b64 v[68:69], 0
    v_mov_b64 v[70:71], 0
    v_mov_b64 v[72:73], 0
    v_mov_b64 v[74:75], 0
    v_mov_b64 v[76:77], 0
    v_mov_b64 v[78:79], 0
    v_mov_b64 v[80:81], 0
    v_mov_b64 v[82:83], 0
    v_mov_b64 v[84:85], 0
    v_mov_b64 v[86:87], 0
    v_mov_b64 v[88:89], 0
    v_mov_b64 v[90:91], 0
    v_mov_b64 v[92:93], 0
    v_mov_b64 v[94:95], 0
    v_mov_b64 v[96:97], 0
    v_mov_b64 v[98:99], 0
    v_mov_b64 v[100:101], 0
    v_mov_b64 v[102:103], 0
    v_mov_b64 v[104:105], 0
    v_mov_b64 v[106:107], 0
    v_mov_b64 v[108:109], 0
    v_mov_b64 v[110:111], 0
    s_lshr_b32 s34, s90, 1
    s_lshl_b32 s34, s34, 4
    v_mov_b32 v14, s34
    s_mul_i32 s36, s5, 6

    s_mul_i32 s89, s36, 40960
    s_mul_i32 s35, s91, 160
    s_add_u32 s89, s89, s35
    s_lshr_b32 s35, s90, 1
    s_lshl_b32 s35, s35, 7
    s_add_u32 s35, s35, s36
    s_lshl_b32 s88, s35, 13
    s_and_b32 s35, s90, 1
    s_lshl_b32 s35, s35, 12
    s_add_u32 s88, s88, s35

    s_mov_b32 s98, s89
    s_mov_b32 s99, s88
    s_and_b32 s92, s91, 3
    s_lshl_b32 s92, s92, 1
    s_and_b32 s37, s90, 7
    s_add_u32 s92, s92, s37
    s_mov_b32 s97, s92
    s_cmp_ge_u32 s92, 6
    s_cselect_b32 s37, 6, 0
    s_sub_u32 s92, s92, s37
    s_cmp_ge_u32 s92, 6
    s_cselect_b32 s37, 6, 0
    s_sub_u32 s92, s92, s37
    s_mul_i32 s93, s3, 20480
    s_add_u32 s94, s93, 5120
    s_add_u32 s95, s93, 10240
    s_add_u32 s100, s93, 15360
    s_add_u32 s36, s92, 0
    s_cmp_ge_u32 s36, 6
    s_cselect_b32 s37, 6, 0
    s_sub_u32 s36, s36, s37
    s_mul_i32 s89, s36, 40960
    s_add_u32 s89, s89, s98
    s_mov_b32 m0, s93
    s_nop 0
    buffer_load_dwordx4 v2, s[76:79], s89 offen lds
    buffer_load_dwordx4 v3, s[76:79], s89 offen offset:1024 lds
    buffer_load_dwordx4 v4, s[76:79], s89 offen offset:2048 lds
    buffer_load_dwordx4 v5, s[76:79], s89 offen offset:3072 lds
    s_add_u32 m0, s93, 4096
    s_nop 0
    buffer_load_dwordx4 v6, s[76:79], s89 offen lds
    s_add_u32 s36, s92, 1
    s_cmp_ge_u32 s36, 6
    s_cselect_b32 s37, 6, 0
    s_sub_u32 s36, s36, s37
    s_mul_i32 s89, s36, 40960
    s_add_u32 s89, s89, s98
    s_mov_b32 m0, s94
    s_nop 0
    buffer_load_dwordx4 v2, s[76:79], s89 offen lds
    buffer_load_dwordx4 v3, s[76:79], s89 offen offset:1024 lds
    buffer_load_dwordx4 v4, s[76:79], s89 offen offset:2048 lds
    buffer_load_dwordx4 v5, s[76:79], s89 offen offset:3072 lds
    s_add_u32 m0, s94, 4096
    s_nop 0
    buffer_load_dwordx4 v6, s[76:79], s89 offen lds
    s_add_u32 s36, s92, 2
    s_cmp_ge_u32 s36, 6
    s_cselect_b32 s37, 6, 0
    s_sub_u32 s36, s36, s37
    s_mul_i32 s89, s36, 40960
    s_add_u32 s89, s89, s98
    s_mov_b32 m0, s95
    s_nop 0
    buffer_load_dwordx4 v2, s[76:79], s89 offen lds
    buffer_load_dwordx4 v3, s[76:79], s89 offen offset:1024 lds
    buffer_load_dwordx4 v4, s[76:79], s89 offen offset:2048 lds
    buffer_load_dwordx4 v5, s[76:79], s89 offen offset:3072 lds
    s_add_u32 m0, s95, 4096
    s_nop 0
    buffer_load_dwordx4 v6, s[76:79], s89 offen lds
    s_add_u32 s36, s92, 3
    s_cmp_ge_u32 s36, 6
    s_cselect_b32 s37, 6, 0
    s_sub_u32 s36, s36, s37
    s_mul_i32 s89, s36, 40960
    s_add_u32 s89, s89, s98
    s_mov_b32 m0, s100
    s_nop 0
    buffer_load_dwordx4 v2, s[76:79], s89 offen lds
    buffer_load_dwordx4 v3, s[76:79], s89 offen offset:1024 lds
    buffer_load_dwordx4 v4, s[76:79], s89 offen offset:2048 lds
    buffer_load_dwordx4 v5, s[76:79], s89 offen offset:3072 lds
    s_add_u32 m0, s100, 4096
    s_nop 0
    buffer_load_dwordx4 v6, s[76:79], s89 offen lds
    s_mov_b32 s96, 0
L_poll_p1g0:
    buffer_load_dword v13, v14, s[84:87], 0 offen sc1
    s_waitcnt vmcnt(0)
    v_readfirstlane_b32 s34, v13
    s_nop 1
    s_and_b32 s34, s34, 0xffff
    s_cmp_eq_u32 s34, 0xffff
    s_cbranch_scc1 L_polld_p1g0
    s_sleep 16
    s_add_u32 s96, s96, 1
    s_cmp_lt_u32 s96, 0x40000
    s_cbranch_scc1 L_poll_p1g0
L_polld_p1g0:
    s_add_u32 s36, s92, 0
    s_cmp_ge_u32 s36, 6
    s_cselect_b32 s37, 6, 0
    s_sub_u32 s36, s36, s37
    s_lshl_b32 s88, s36, 13
    s_add_u32 s88, s88, s99
    buffer_load_dwordx4 v[112:115], v7, s[24:27], s88 offen offset:0 sc1
    buffer_load_dwordx4 v[116:119], v7, s[24:27], s88 offen offset:1024 sc1
    buffer_load_dwordx4 v[120:123], v7, s[24:27], s88 offen offset:2048 sc1
    buffer_load_dwordx4 v[124:127], v7, s[24:27], s88 offen offset:3072 sc1
    s_add_u32 s36, s92, 1
    s_cmp_ge_u32 s36, 6
    s_cselect_b32 s37, 6, 0
    s_sub_u32 s36, s36, s37
    s_lshl_b32 s88, s36, 13
    s_add_u32 s88, s88, s99
    buffer_load_dwordx4 v[128:131], v7, s[24:27], s88 offen offset:0 sc1
    buffer_load_dwordx4 v[132:135], v7, s[24:27], s88 offen offset:1024 sc1
    buffer_load_dwordx4 v[136:139], v7, s[24:27], s88 offen offset:2048 sc1
    buffer_load_dwordx4 v[140:143], v7, s[24:27], s88 offen offset:3072 sc1
    s_add_u32 s36, s92, 2
    s_cmp_ge_u32 s36, 6
    s_cselect_b32 s37, 6, 0
    s_sub_u32 s36, s36, s37
    s_lshl_b32 s88, s36, 13
    s_add_u32 s88, s88, s99
    buffer_load_dwordx4 v[144:147], v7, s[24:27], s88 offen offset:0 sc1
    buffer_load_dwordx4 v[148:151], v7, s[24:27], s88 offen offset:1024 sc1
    buffer_load_dwordx4 v[152:155], v7, s[24:27], s88 offen offset:2048 sc1
    buffer_load_dwordx4 v[156:159], v7, s[24:27], s88 offen offset:3072 sc1
    v_add_u32 v10, s93, v8
    ds_read_b64_tr_b16 v[176:177], v10 offset:0
    ds_read_b64_tr_b16 v[178:179], v10 offset:2560
    ds_read_b64_tr_b16 v[180:181], v10 offset:32
    ds_read_b64_tr_b16 v[182:183], v10 offset:2592
    ds_read_b64_tr_b16 v[184:185], v10 offset:64
    ds_read_b64_tr_b16 v[186:187], v10 offset:2624
    ds_read_b64_tr_b16 v[188:189], v10 offset:96
    ds_read_b64_tr_b16 v[190:191], v10 offset:2656
    ds_read_b64_tr_b16 v[192:193], v10 offset:128
    ds_read_b64_tr_b16 v[194:195], v10 offset:2688
    s_waitcnt vmcnt(8)
    s_waitcnt lgkmcnt(0)
    s_add_u32 s36, s92, 4
    s_cmp_ge_u32 s36, 6
    s_cselect_b32 s37, 6, 0
    s_sub_u32 s36, s36, s37
    s_mul_i32 s89, s36, 40960
    s_add_u32 s89, s89, s98
    s_add_u32 s36, s92, 3
    s_cmp_ge_u32 s36, 6
    s_cselect_b32 s37, 6, 0
    s_sub_u32 s36, s36, s37
    s_lshl_b32 s88, s36, 13
    s_add_u32 s88, s88, s99
    v_mfma_f32_16x16x32_bf16 v[32:35], v[176:179], v[112:115], v[32:35]
    v_add_u32 v11, s94, v8
    v_mfma_f32_16x16x32_bf16 v[52:55], v[176:179], v[116:119], v[52:55]
    s_mov_b32 m0, s93
    s_nop 0
    buffer_load_dwordx4 v2, s[76:79], s89 offen lds
    v_mfma_f32_16x16x32_bf16 v[72:75], v[176:179], v[120:123], v[72:75]
    ds_read_b64_tr_b16 v[196:197], v11 offset:0
    v_mfma_f32_16x16x32_bf16 v[92:95], v[176:179], v[124:127], v[92:95]
    buffer_load_dwordx4 v3, s[76:79], s89 offen offset:1024 lds
    v_mfma_f32_16x16x32_bf16 v[36:39], v[180:183], v[112:115], v[36:39]
    ds_read_b64_tr_b16 v[198:199], v11 offset:2560
    v_mfma_f32_16x16x32_bf16 v[56:59], v[180:183], v[116:119], v[56:59]
    buffer_load_dwordx4 v4, s[76:79], s89 offen offset:2048 lds
    v_mfma_f32_16x16x32_bf16 v[76:79], v[180:183], v[120:123], v[76:79]
    ds_read_b64_tr_b16 v[200:201], v11 offset:32
    v_mfma_f32_16x16x32_bf16 v[96:99], v[180:183], v[124:127], v[96:99]
    buffer_load_dwordx4 v5, s[76:79], s89 offen offset:3072 lds
    v_mfma_f32_16x16x32_bf16 v[40:43], v[184:187], v[112:115], v[40:43]
    ds_read_b64_tr_b16 v[202:203], v11 offset:2592
    v_mfma_f32_16x16x32_bf16 v[60:63], v[184:187], v[116:119], v[60:63]
    s_add_u32 m0, s93, 4096
    s_nop 0
    buffer_load_dwordx4 v6, s[76:79], s89 offen lds
    v_mfma_f32_16x16x32_bf16 v[80:83], v[184:187], v[120:123], v[80:83]
    ds_read_b64_tr_b16 v[204:205], v11 offset:64
    v_mfma_f32_16x16x32_bf16 v[100:103], v[184:187], v[124:127], v[100:103]
    buffer_load_dwordx4 v[160:163], v7, s[24:27], s88 offen offset:0 sc1
    v_mfma_f32_16x16x32_bf16 v[44:47], v[188:191], v[112:115], v[44:47]
    ds_read_b64_tr_b16 v[206:207], v11 offset:2624
    v_mfma_f32_16x16x32_bf16 v[64:67], v[188:191], v[116:119], v[64:67]
    buffer_load_dwordx4 v[164:167], v7, s[24:27], s88 offen offset:1024 sc1
    v_mfma_f32_16x16x32_bf16 v[84:87], v[188:191], v[120:123], v[84:87]
    ds_read_b64_tr_b16 v[208:209], v11 offset:96
    v_mfma_f32_16x16x32_bf16 v[104:107], v[188:191], v[124:127], v[104:107]
    buffer_load_dwordx4 v[168:171], v7, s[24:27], s88 offen offset:2048 sc1
    v_mfma_f32_16x16x32_bf16 v[48:51], v[192:195], v[112:115], v[48:51]
    ds_read_b64_tr_b16 v[210:211], v11 offset:2656
    v_mfma_f32_16x16x32_bf16 v[68:71], v[192:195], v[116:119], v[68:71]
    buffer_load_dwordx4 v[172:175], v7, s[24:27], s88 offen offset:3072 sc1
    v_mfma_f32_16x16x32_bf16 v[88:91], v[192:195], v[120:123], v[88:91]
    ds_read_b64_tr_b16 v[212:213], v11 offset:128
    v_mfma_f32_16x16x32_bf16 v[108:111], v[192:195], v[124:127], v[108:111]
    ds_read_b64_tr_b16 v[214:215], v11 offset:2688
    s_waitcnt vmcnt(13)
    s_waitcnt lgkmcnt(0)
    s_add_u32 s36, s92, 5
    s_cmp_ge_u32 s36, 6
    s_cselect_b32 s37, 6, 0
    s_sub_u32 s36, s36, s37
    s_mul_i32 s89, s36, 40960
    s_add_u32 s89, s89, s98
    s_add_u32 s36, s92, 4
    s_cmp_ge_u32 s36, 6
    s_cselect_b32 s37, 6, 0
    s_sub_u32 s36, s36, s37
    s_lshl_b32 s88, s36, 13
    s_add_u32 s88, s88, s99
    v_mfma_f32_16x16x32_bf16 v[32:35], v[196:199], v[128:131], v[32:35]
    v_add_u32 v10, s95, v8
    v_mfma_f32_16x16x32_bf16 v[52:55], v[196:199], v[132:135], v[52:55]
    s_mov_b32 m0, s94
    s_nop 0
    buffer_load_dwordx4 v2, s[76:79], s89 offen lds
    v_mfma_f32_16x16x32_bf16 v[72:75], v[196:199], v[136:139], v[72:75]
    ds_read_b64_tr_b16 v[176:177], v10 offset:0
    v_mfma_f32_16x16x32_bf16 v[92:95], v[196:199], v[140:143], v[92:95]
    buffer_load_dwordx4 v3, s[76:79], s89 offen offset:1024 lds
    v_mfma_f32_16x16x32_bf16 v[36:39], v[200:203], v[128:131], v[36:39]
    ds_read_b64_tr_b16 v[178:179], v10 offset:2560
    v_mfma_f32_16x16x32_bf16 v[56:59], v[200:203], v[132:135], v[56:59]
    buffer_load_dwordx4 v4, s[76:79], s89 offen offset:2048 lds
    v_mfma_f32_16x16x32_bf16 v[76:79], v[200:203], v[136:139], v[76:79]
    ds_read_b64_tr_b16 v[180:181], v10 offset:32
    v_mfma_f32_16x16x32_bf16 v[96:99], v[200:203], v[140:143], v[96:99]
    buffer_load_dwordx4 v5, s[76:79], s89 offen offset:3072 lds
    v_mfma_f32_16x16x32_bf16 v[40:43], v[204:207], v[128:131], v[40:43]
    ds_read_b64_tr_b16 v[182:183], v10 offset:2592
    v_mfma_f32_16x16x32_bf16 v[60:63], v[204:207], v[132:135], v[60:63]
    s_add_u32 m0, s94, 4096
    s_nop 0
    buffer_load_dwordx4 v6, s[76:79], s89 offen lds
    v_mfma_f32_16x16x32_bf16 v[80:83], v[204:207], v[136:139], v[80:83]
    ds_read_b64_tr_b16 v[184:185], v10 offset:64
    v_mfma_f32_16x16x32_bf16 v[100:103], v[204:207], v[140:143], v[100:103]
    buffer_load_dwordx4 v[112:115], v7, s[24:27], s88 offen offset:0 sc1
    v_mfma_f32_16x16x32_bf16 v[44:47], v[208:211], v[128:131], v[44:47]
    ds_read_b64_tr_b16 v[186:187], v10 offset:2624
    v_mfma_f32_16x16x32_bf16 v[64:67], v[208:211], v[132:135], v[64:67]
    buffer_load_dwordx4 v[116:119], v7, s[24:27], s88 offen offset:1024 sc1
    v_mfma_f32_16x16x32_bf16 v[84:87], v[208:211], v[136:139], v[84:87]
    ds_read_b64_tr_b16 v[188:189], v10 offset:96
    v_mfma_f32_16x16x32_bf16 v[104:107], v[208:211], v[140:143], v[104:107]
    buffer_load_dwordx4 v[120:123], v7, s[24:27], s88 offen offset:2048 sc1
    v_mfma_f32_16x16x32_bf16 v[48:51], v[212:215], v[128:131], v[48:51]
    ds_read_b64_tr_b16 v[190:191], v10 offset:2656
    v_mfma_f32_16x16x32_bf16 v[68:71], v[212:215], v[132:135], v[68:71]
    buffer_load_dwordx4 v[124:127], v7, s[24:27], s88 offen offset:3072 sc1
    v_mfma_f32_16x16x32_bf16 v[88:91], v[212:215], v[136:139], v[88:91]
    ds_read_b64_tr_b16 v[192:193], v10 offset:128
    v_mfma_f32_16x16x32_bf16 v[108:111], v[212:215], v[140:143], v[108:111]
    ds_read_b64_tr_b16 v[194:195], v10 offset:2688
    s_waitcnt vmcnt(18)
    s_waitcnt lgkmcnt(0)
    s_lshl_b32 s36, s3, 3
    s_add_u32 s36, s36, 64
    s_mul_i32 s98, s36, 40960
    s_mul_i32 s37, s91, 160
    s_add_u32 s98, s98, s37
    s_add_u32 s36, s97, 0
    s_and_b32 s36, s36, 7
    s_mul_i32 s89, s36, 40960
    s_add_u32 s89, s89, s98
    s_add_u32 s36, s92, 5
    s_cmp_ge_u32 s36, 6
    s_cselect_b32 s37, 6, 0
    s_sub_u32 s36, s36, s37
    s_lshl_b32 s88, s36, 13
    s_add_u32 s88, s88, s99
    v_mfma_f32_16x16x32_bf16 v[32:35], v[176:179], v[144:147], v[32:35]
    v_add_u32 v11, s100, v8
    v_mfma_f32_16x16x32_bf16 v[52:55], v[176:179], v[148:151], v[52:55]
    s_mov_b32 m0, s95
    s_nop 0
    buffer_load_dwordx4 v2, s[76:79], s89 offen lds
    v_mfma_f32_16x16x32_bf16 v[72:75], v[176:179], v[152:155], v[72:75]
    ds_read_b64_tr_b16 v[196:197], v11 offset:0
    v_mfma_f32_16x16x32_bf16 v[92:95], v[176:179], v[156:159], v[92:95]
    buffer_load_dwordx4 v3, s[76:79], s89 offen offset:1024 lds
    v_mfma_f32_16x16x32_bf16 v[36:39], v[180:183], v[144:147], v[36:39]
    ds_read_b64_tr_b16 v[198:199], v11 offset:2560
    v_mfma_f32_16x16x32_bf16 v[56:59], v[180:183], v[148:151], v[56:59]
    buffer_load_dwordx4 v4, s[76:79], s89 offen offset:2048 lds
    v_mfma_f32_16x16x32_bf16 v[76:79], v[180:183], v[152:155], v[76:79]
    ds_read_b64_tr_b16 v[200:201], v11 offset:32
    v_mfma_f32_16x16x32_bf16 v[96:99], v[180:183], v[156:159], v[96:99]
    buffer_load_dwordx4 v5, s[76:79], s89 offen offset:3072 lds
    v_mfma_f32_16x16x32_bf16 v[40:43], v[184:187], v[144:147], v[40:43]
    ds_read_b64_tr_b16 v[202:203], v11 offset:2592
    v_mfma_f32_16x16x32_bf16 v[60:63], v[184:187], v[148:151], v[60:63]
    s_add_u32 m0, s95, 4096
    s_nop 0
    buffer_load_dwordx4 v6, s[76:79], s89 offen lds
    v_mfma_f32_16x16x32_bf16 v[80:83], v[184:187], v[152:155], v[80:83]
    ds_read_b64_tr_b16 v[204:205], v11 offset:64
    v_mfma_f32_16x16x32_bf16 v[100:103], v[184:187], v[156:159], v[100:103]
    buffer_load_dwordx4 v[128:131], v7, s[24:27], s88 offen offset:0 sc1
    v_mfma_f32_16x16x32_bf16 v[44:47], v[188:191], v[144:147], v[44:47]
    ds_read_b64_tr_b16 v[206:207], v11 offset:2624
    v_mfma_f32_16x16x32_bf16 v[64:67], v[188:191], v[148:151], v[64:67]
    buffer_load_dwordx4 v[132:135], v7, s[24:27], s88 offen offset:1024 sc1
    v_mfma_f32_16x16x32_bf16 v[84:87], v[188:191], v[152:155], v[84:87]
    ds_read_b64_tr_b16 v[208:209], v11 offset:96
    v_mfma_f32_16x16x32_bf16 v[104:107], v[188:191], v[156:159], v[104:107]
    buffer_load_dwordx4 v[136:139], v7, s[24:27], s88 offen offset:2048 sc1
    v_mfma_f32_16x16x32_bf16 v[48:51], v[192:195], v[144:147], v[48:51]
    ds_read_b64_tr_b16 v[210:211], v11 offset:2656
    v_mfma_f32_16x16x32_bf16 v[68:71], v[192:195], v[148:151], v[68:71]
    buffer_load_dwordx4 v[140:143], v7, s[24:27], s88 offen offset:3072 sc1
    v_mfma_f32_16x16x32_bf16 v[88:91], v[192:195], v[152:155], v[88:91]
    ds_read_b64_tr_b16 v[212:213], v11 offset:128
    v_mfma_f32_16x16x32_bf16 v[108:111], v[192:195], v[156:159], v[108:111]
    ds_read_b64_tr_b16 v[214:215], v11 offset:2688
    s_waitcnt vmcnt(18)
    s_waitcnt lgkmcnt(0)
    s_add_u32 s36, s97, 1
    s_and_b32 s36, s36, 7
    s_mul_i32 s89, s36, 40960
    s_add_u32 s89, s89, s98
    v_mfma_f32_16x16x32_bf16 v[32:35], v[196:199], v[160:163], v[32:35]
    v_add_u32 v10, s93, v8
    v_mfma_f32_16x16x32_bf16 v[52:55], v[196:199], v[164:167], v[52:55]
    s_mov_b32 m0, s100
    s_nop 0
    buffer_load_dwordx4 v2, s[76:79], s89 offen lds
    v_mfma_f32_16x16x32_bf16 v[72:75], v[196:199], v[168:171], v[72:75]
    ds_read_b64_tr_b16 v[176:177], v10 offset:0
    v_mfma_f32_16x16x32_bf16 v[92:95], v[196:199], v[172:175], v[92:95]
    buffer_load_dwordx4 v3, s[76:79], s89 offen offset:1024 lds
    v_mfma_f32_16x16x32_bf16 v[36:39], v[200:203], v[160:163], v[36:39]
    ds_read_b64_tr_b16 v[178:179], v10 offset:2560
    v_mfma_f32_16x16x32_bf16 v[56:59], v[200:203], v[164:167], v[56:59]
    buffer_load_dwordx4 v4, s[76:79], s89 offen offset:2048 lds
    v_mfma_f32_16x16x32_bf16 v[76:79], v[200:203], v[168:171], v[76:79]
    ds_read_b64_tr_b16 v[180:181], v10 offset:32
    v_mfma_f32_16x16x32_bf16 v[96:99], v[200:203], v[172:175], v[96:99]
    buffer_load_dwordx4 v5, s[76:79], s89 offen offset:3072 lds
    v_mfma_f32_16x16x32_bf16 v[40:43], v[204:207], v[160:163], v[40:43]
    ds_read_b64_tr_b16 v[182:183], v10 offset:2592
    v_mfma_f32_16x16x32_bf16 v[60:63], v[204:207], v[164:167], v[60:63]
    s_add_u32 m0, s100, 4096
    s_nop 0
    buffer_load_dwordx4 v6, s[76:79], s89 offen lds
    v_mfma_f32_16x16x32_bf16 v[80:83], v[204:207], v[168:171], v[80:83]
    ds_read_b64_tr_b16 v[184:185], v10 offset:64
    v_mfma_f32_16x16x32_bf16 v[100:103], v[204:207], v[172:175], v[100:103]
    ds_read_b64_tr_b16 v[186:187], v10 offset:2624
    v_mfma_f32_16x16x32_bf16 v[44:47], v[208:211], v[160:163], v[44:47]
    ds_read_b64_tr_b16 v[188:189], v10 offset:96
    v_mfma_f32_16x16x32_bf16 v[64:67], v[208:211], v[164:167], v[64:67]
    ds_read_b64_tr_b16 v[190:191], v10 offset:2656
    v_mfma_f32_16x16x32_bf16 v[84:87], v[208:211], v[168:171], v[84:87]
    ds_read_b64_tr_b16 v[192:193], v10 offset:128
    v_mfma_f32_16x16x32_bf16 v[104:107], v[208:211], v[172:175], v[104:107]
    ds_read_b64_tr_b16 v[194:195], v10 offset:2688
    v_mfma_f32_16x16x32_bf16 v[48:51], v[212:215], v[160:163], v[48:51]
    v_mfma_f32_16x16x32_bf16 v[68:71], v[212:215], v[164:167], v[68:71]
    v_mfma_f32_16x16x32_bf16 v[88:91], v[212:215], v[168:171], v[88:91]
    v_mfma_f32_16x16x32_bf16 v[108:111], v[212:215], v[172:175], v[108:111]
    s_waitcnt vmcnt(14)
    s_waitcnt lgkmcnt(0)
    s_add_u32 s36, s97, 2
    s_and_b32 s36, s36, 7
    s_mul_i32 s89, s36, 40960
    s_add_u32 s89, s89, s98
    v_mfma_f32_16x16x32_bf16 v[32:35], v[176:179], v[112:115], v[32:35]
    v_add_u32 v11, s94, v8
    v_mfma_f32_16x16x32_bf16 v[52:55], v[176:179], v[116:119], v[52:55]
    s_mov_b32 m0, s93
    s_nop 0
    buffer_load_dwordx4 v2, s[76:79], s89 offen lds
    v_mfma_f32_16x16x32_bf16 v[72:75], v[176:179], v[120:123], v[72:75]
    ds_read_b64_tr_b16 v[196:197], v11 offset:0
    v_mfma_f32_16x16x32_bf16 v[92:95], v[176:179], v[124:127], v[92:95]
    buffer_load_dwordx4 v3, s[76:79], s89 offen offset:1024 lds
    v_mfma_f32_16x16x32_bf16 v[36:39], v[180:183], v[112:115], v[36:39]
    ds_read_b64_tr_b16 v[198:199], v11 offset:2560
    v_mfma_f32_16x16x32_bf16 v[56:59], v[180:183], v[116:119], v[56:59]
    buffer_load_dwordx4 v4, s[76:79], s89 offen offset:2048 lds
    v_mfma_f32_16x16x32_bf16 v[76:79], v[180:183], v[120:123], v[76:79]
    ds_read_b64_tr_b16 v[200:201], v11 offset:32
    v_mfma_f32_16x16x32_bf16 v[96:99], v[180:183], v[124:127], v[96:99]
    buffer_load_dwordx4 v5, s[76:79], s89 offen offset:3072 lds
    v_mfma_f32_16x16x32_bf16 v[40:43], v[184:187], v[112:115], v[40:43]
    ds_read_b64_tr_b16 v[202:203], v11 offset:2592
    v_mfma_f32_16x16x32_bf16 v[60:63], v[184:187], v[116:119], v[60:63]
    s_add_u32 m0, s93, 4096
    s_nop 0
    buffer_load_dwordx4 v6, s[76:79], s89 offen lds
    v_mfma_f32_16x16x32_bf16 v[80:83], v[184:187], v[120:123], v[80:83]
    ds_read_b64_tr_b16 v[204:205], v11 offset:64
    v_mfma_f32_16x16x32_bf16 v[100:103], v[184:187], v[124:127], v[100:103]
    ds_read_b64_tr_b16 v[206:207], v11 offset:2624
    v_mfma_f32_16x16x32_bf16 v[44:47], v[188:191], v[112:115], v[44:47]
    ds_read_b64_tr_b16 v[208:209], v11 offset:96
    v_mfma_f32_16x16x32_bf16 v[64:67], v[188:191], v[116:119], v[64:67]
    ds_read_b64_tr_b16 v[210:211], v11 offset:2656
    v_mfma_f32_16x16x32_bf16 v[84:87], v[188:191], v[120:123], v[84:87]
    ds_read_b64_tr_b16 v[212:213], v11 offset:128
    v_mfma_f32_16x16x32_bf16 v[104:107], v[188:191], v[124:127], v[104:107]
    ds_read_b64_tr_b16 v[214:215], v11 offset:2688
    v_mfma_f32_16x16x32_bf16 v[48:51], v[192:195], v[112:115], v[48:51]
    v_mfma_f32_16x16x32_bf16 v[68:71], v[192:195], v[116:119], v[68:71]
    v_mfma_f32_16x16x32_bf16 v[88:91], v[192:195], v[120:123], v[88:91]
    v_mfma_f32_16x16x32_bf16 v[108:111], v[192:195], v[124:127], v[108:111]
    s_waitcnt vmcnt(10)
    s_waitcnt lgkmcnt(0)
    s_add_u32 s36, s97, 3
    s_and_b32 s36, s36, 7
    s_mul_i32 s89, s36, 40960
    s_add_u32 s89, s89, s98
    v_mfma_f32_16x16x32_bf16 v[32:35], v[196:199], v[128:131], v[32:35]
    v_add_u32 v10, s95, v8
    v_mfma_f32_16x16x32_bf16 v[52:55], v[196:199], v[132:135], v[52:55]
    s_mov_b32 m0, s94
    s_nop 0
    buffer_load_dwordx4 v2, s[76:79], s89 offen lds
    v_mfma_f32_16x16x32_bf16 v[72:75], v[196:199], v[136:139], v[72:75]
    ds_read_b64_tr_b16 v[176:177], v10 offset:0
    v_mfma_f32_16x16x32_bf16 v[92:95], v[196:199], v[140:143], v[92:95]
    buffer_load_dwordx4 v3, s[76:79], s89 offen offset:1024 lds
    v_mfma_f32_16x16x32_bf16 v[36:39], v[200:203], v[128:131], v[36:39]
    ds_read_b64_tr_b16 v[178:179], v10 offset:2560
    v_mfma_f32_16x16x32_bf16 v[56:59], v[200:203], v[132:135], v[56:59]
    buffer_load_dwordx4 v4, s[76:79], s89 offen offset:2048 lds
    v_mfma_f32_16x16x32_bf16 v[76:79], v[200:203], v[136:139], v[76:79]
    ds_read_b64_tr_b16 v[180:181], v10 offset:32
    v_mfma_f32_16x16x32_bf16 v[96:99], v[200:203], v[140:143], v[96:99]
    buffer_load_dwordx4 v5, s[76:79], s89 offen offset:3072 lds
    v_mfma_f32_16x16x32_bf16 v[40:43], v[204:207], v[128:131], v[40:43]
    ds_read_b64_tr_b16 v[182:183], v10 offset:2592
    v_mfma_f32_16x16x32_bf16 v[60:63], v[204:207], v[132:135], v[60:63]
    s_add_u32 m0, s94, 4096
    s_nop 0
    buffer_load_dwordx4 v6, s[76:79], s89 offen lds
    v_mfma_f32_16x16x32_bf16 v[80:83], v[204:207], v[136:139], v[80:83]
    ds_read_b64_tr_b16 v[184:185], v10 offset:64
    v_mfma_f32_16x16x32_bf16 v[100:103], v[204:207], v[140:143], v[100:103]
    ds_read_b64_tr_b16 v[186:187], v10 offset:2624
    v_mfma_f32_16x16x32_bf16 v[44:47], v[208:211], v[128:131], v[44:47]
    ds_read_b64_tr_b16 v[188:189], v10 offset:96
    v_mfma_f32_16x16x32_bf16 v[64:67], v[208:211], v[132:135], v[64:67]
    ds_read_b64_tr_b16 v[190:191], v10 offset:2656
    v_mfma_f32_16x16x32_bf16 v[84:87], v[208:211], v[136:139], v[84:87]
    ds_read_b64_tr_b16 v[192:193], v10 offset:128
    v_mfma_f32_16x16x32_bf16 v[104:107], v[208:211], v[140:143], v[104:107]
    ds_read_b64_tr_b16 v[194:195], v10 offset:2688
    v_mfma_f32_16x16x32_bf16 v[48:51], v[212:215], v[128:131], v[48:51]
    v_mfma_f32_16x16x32_bf16 v[68:71], v[212:215], v[132:135], v[68:71]
    v_mfma_f32_16x16x32_bf16 v[88:91], v[212:215], v[136:139], v[88:91]
    v_mfma_f32_16x16x32_bf16 v[108:111], v[212:215], v[140:143], v[108:111]
    s_lshl_b32 s35, s3, 1
    s_add_u32 s35, s35, 16
    s_lshl_b32 s35, 3, s35
    s_mov_b32 s96, 0
L_poll_p2g0:
    buffer_load_dword v13, v14, s[84:87], 0 offen sc1
    s_waitcnt vmcnt(0)
    v_readfirstlane_b32 s34, v13
    s_nop 1
    s_and_b32 s34, s34, s35
    s_cmp_eq_u32 s34, s35
    s_cbranch_scc1 L_polld_p2g0
    s_sleep 16
    s_add_u32 s96, s96, 1
    s_cmp_lt_u32 s96, 0x40000
    s_cbranch_scc1 L_poll_p2g0
L_polld_p2g0:
    s_lshl_b32 s36, s3, 3
    s_add_u32 s36, s36, 64
    s_lshr_b32 s37, s90, 1
    s_lshl_b32 s37, s37, 7
    s_add_u32 s37, s37, s36
    s_lshl_b32 s99, s37, 13
    s_and_b32 s37, s90, 1
    s_lshl_b32 s37, s37, 12
    s_add_u32 s99, s99, s37
    s_add_u32 s36, s97, 0
    s_and_b32 s36, s36, 7
    s_lshl_b32 s88, s36, 13
    s_add_u32 s88, s88, s99
    buffer_load_dwordx4 v[144:147], v7, s[24:27], s88 offen offset:0 sc1
    buffer_load_dwordx4 v[148:151], v7, s[24:27], s88 offen offset:1024 sc1
    buffer_load_dwordx4 v[152:155], v7, s[24:27], s88 offen offset:2048 sc1
    buffer_load_dwordx4 v[156:159], v7, s[24:27], s88 offen offset:3072 sc1
    s_add_u32 s36, s97, 1
    s_and_b32 s36, s36, 7
    s_lshl_b32 s88, s36, 13
    s_add_u32 s88, s88, s99
    buffer_load_dwordx4 v[160:163], v7, s[24:27], s88 offen offset:0 sc1
    buffer_load_dwordx4 v[164:167], v7, s[24:27], s88 offen offset:1024 sc1
    buffer_load_dwordx4 v[168:171], v7, s[24:27], s88 offen offset:2048 sc1
    buffer_load_dwordx4 v[172:175], v7, s[24:27], s88 offen offset:3072 sc1
    s_add_u32 s36, s97, 2
    s_and_b32 s36, s36, 7
    s_lshl_b32 s88, s36, 13
    s_add_u32 s88, s88, s99
    buffer_load_dwordx4 v[112:115], v7, s[24:27], s88 offen offset:0 sc1
    buffer_load_dwordx4 v[116:119], v7, s[24:27], s88 offen offset:1024 sc1
    buffer_load_dwordx4 v[120:123], v7, s[24:27], s88 offen offset:2048 sc1
    buffer_load_dwordx4 v[124:127], v7, s[24:27], s88 offen offset:3072 sc1
    s_waitcnt vmcnt(8)
    s_waitcnt lgkmcnt(0)
    s_add_u32 s36, s97, 4
    s_and_b32 s36, s36, 7
    s_mul_i32 s89, s36, 40960
    s_add_u32 s89, s89, s98
    s_add_u32 s36, s97, 3
    s_and_b32 s36, s36, 7
    s_lshl_b32 s88, s36, 13
    s_add_u32 s88, s88, s99
    v_mfma_f32_16x16x32_bf16 v[32:35], v[176:179], v[144:147], v[32:35]
    v_add_u32 v11, s100, v8
    v_mfma_f32_16x16x32_bf16 v[52:55], v[176:179], v[148:151], v[52:55]
    s_mov_b32 m0, s95
    s_nop 0
    buffer_load_dwordx4 v2, s[76:79], s89 offen lds
    v_mfma_f32_16x16x32_bf16 v[72:75], v[176:179], v[152:155], v[72:75]
    ds_read_b64_tr_b16 v[196:197], v11 offset:0
    v_mfma_f32_16x16x32_bf16 v[92:95], v[176:179], v[156:159], v[92:95]
    buffer_load_dwordx4 v3, s[76:79], s89 offen offset:1024 lds
    v_mfma_f32_16x16x32_bf16 v[36:39], v[180:183], v[144:147], v[36:39]
    ds_read_b64_tr_b16 v[198:199], v11 offset:2560
    v_mfma_f32_16x16x32_bf16 v[56:59], v[180:183], v[148:151], v[56:59]
    buffer_load_dwordx4 v4, s[76:79], s89 offen offset:2048 lds
    v_mfma_f32_16x16x32_bf16 v[76:79], v[180:183], v[152:155], v[76:79]
    ds_read_b64_tr_b16 v[200:201], v11 offset:32
    v_mfma_f32_16x16x32_bf16 v[96:99], v[180:183], v[156:159], v[96:99]
    buffer_load_dwordx4 v5, s[76:79], s89 offen offset:3072 lds
    v_mfma_f32_16x16x32_bf16 v[40:43], v[184:187], v[144:147], v[40:43]
    ds_read_b64_tr_b16 v[202:203], v11 offset:2592
    v_mfma_f32_16x16x32_bf16 v[60:63], v[184:187], v[148:151], v[60:63]
    s_add_u32 m0, s95, 4096
    s_nop 0
    buffer_load_dwordx4 v6, s[76:79], s89 offen lds
    v_mfma_f32_16x16x32_bf16 v[80:83], v[184:187], v[152:155], v[80:83]
    ds_read_b64_tr_b16 v[204:205], v11 offset:64
    v_mfma_f32_16x16x32_bf16 v[100:103], v[184:187], v[156:159], v[100:103]
    buffer_load_dwordx4 v[128:131], v7, s[24:27], s88 offen offset:0 sc1
    v_mfma_f32_16x16x32_bf16 v[44:47], v[188:191], v[144:147], v[44:47]
    ds_read_b64_tr_b16 v[206:207], v11 offset:2624
    v_mfma_f32_16x16x32_bf16 v[64:67], v[188:191], v[148:151], v[64:67]
    buffer_load_dwordx4 v[132:135], v7, s[24:27], s88 offen offset:1024 sc1
    v_mfma_f32_16x16x32_bf16 v[84:87], v[188:191], v[152:155], v[84:87]
    ds_read_b64_tr_b16 v[208:209], v11 offset:96
    v_mfma_f32_16x16x32_bf16 v[104:107], v[188:191], v[156:159], v[104:107]
    buffer_load_dwordx4 v[136:139], v7, s[24:27], s88 offen offset:2048 sc1
    v_mfma_f32_16x16x32_bf16 v[48:51], v[192:195], v[144:147], v[48:51]
    ds_read_b64_tr_b16 v[210:211], v11 offset:2656
    v_mfma_f32_16x16x32_bf16 v[68:71], v[192:195], v[148:151], v[68:71]
    buffer_load_dwordx4 v[140:143], v7, s[24:27], s88 offen offset:3072 sc1
    v_mfma_f32_16x16x32_bf16 v[88:91], v[192:195], v[152:155], v[88:91]
    ds_read_b64_tr_b16 v[212:213], v11 offset:128
    v_mfma_f32_16x16x32_bf16 v[108:111], v[192:195], v[156:159], v[108:111]
    ds_read_b64_tr_b16 v[214:215], v11 offset:2688
    s_waitcnt vmcnt(13)
    s_waitcnt lgkmcnt(0)
    s_add_u32 s36, s97, 5
    s_and_b32 s36, s36, 7
    s_mul_i32 s89, s36, 40960
    s_add_u32 s89, s89, s98
    s_add_u32 s36, s97, 4
    s_and_b32 s36, s36, 7
    s_lshl_b32 s88, s36, 13
    s_add_u32 s88, s88, s99
    v_mfma_f32_16x16x32_bf16 v[32:35], v[196:199], v[160:163], v[32:35]
    v_add_u32 v10, s93, v8
    v_mfma_f32_16x16x32_bf16 v[52:55], v[196:199], v[164:167], v[52:55]
    s_mov_b32 m0, s100
    s_nop 0
    buffer_load_dwordx4 v2, s[76:79], s89 offen lds
    v_mfma_f32_16x16x32_bf16 v[72:75], v[196:199], v[168:171], v[72:75]
    ds_read_b64_tr_b16 v[176:177], v10 offset:0
    v_mfma_f32_16x16x32_bf16 v[92:95], v[196:199], v[172:175], v[92:95]
    buffer_load_dwordx4 v3, s[76:79], s89 offen offset:1024 lds
    v_mfma_f32_16x16x32_bf16 v[36:39], v[200:203], v[160:163], v[36:39]
    ds_read_b64_tr_b16 v[178:179], v10 offset:2560
    v_mfma_f32_16x16x32_bf16 v[56:59], v[200:203], v[164:167], v[56:59]
    buffer_load_dwordx4 v4, s[76:79], s89 offen offset:2048 lds
    v_mfma_f32_16x16x32_bf16 v[76:79], v[200:203], v[168:171], v[76:79]
    ds_read_b64_tr_b16 v[180:181], v10 offset:32
    v_mfma_f32_16x16x32_bf16 v[96:99], v[200:203], v[172:175], v[96:99]
    buffer_load_dwordx4 v5, s[76:79], s89 offen offset:3072 lds
    v_mfma_f32_16x16x32_bf16 v[40:43], v[204:207], v[160:163], v[40:43]
    ds_read_b64_tr_b16 v[182:183], v10 offset:2592
    v_mfma_f32_16x16x32_bf16 v[60:63], v[204:207], v[164:167], v[60:63]
    s_add_u32 m0, s100, 4096
    s_nop 0
    buffer_load_dwordx4 v6, s[76:79], s89 offen lds
    v_mfma_f32_16x16x32_bf16 v[80:83], v[204:207], v[168:171], v[80:83]
    ds_read_b64_tr_b16 v[184:185], v10 offset:64
    v_mfma_f32_16x16x32_bf16 v[100:103], v[204:207], v[172:175], v[100:103]
    buffer_load_dwordx4 v[144:147], v7, s[24:27], s88 offen offset:0 sc1
    v_mfma_f32_16x16x32_bf16 v[44:47], v[208:211], v[160:163], v[44:47]
    ds_read_b64_tr_b16 v[186:187], v10 offset:2624
    v_mfma_f32_16x16x32_bf16 v[64:67], v[208:211], v[164:167], v[64:67]
    buffer_load_dwordx4 v[148:151], v7, s[24:27], s88 offen offset:1024 sc1
    v_mfma_f32_16x16x32_bf16 v[84:87], v[208:211], v[168:171], v[84:87]
    ds_read_b64_tr_b16 v[188:189], v10 offset:96
    v_mfma_f32_16x16x32_bf16 v[104:107], v[208:211], v[172:175], v[104:107]
    buffer_load_dwordx4 v[152:155], v7, s[24:27], s88 offen offset:2048 sc1
    v_mfma_f32_16x16x32_bf16 v[48:51], v[212:215], v[160:163], v[48:51]
    ds_read_b64_tr_b16 v[190:191], v10 offset:2656
    v_mfma_f32_16x16x32_bf16 v[68:71], v[212:215], v[164:167], v[68:71]
    buffer_load_dwordx4 v[156:159], v7, s[24:27], s88 offen offset:3072 sc1
    v_mfma_f32_16x16x32_bf16 v[88:91], v[212:215], v[168:171], v[88:91]
    ds_read_b64_tr_b16 v[192:193], v10 offset:128
    v_mfma_f32_16x16x32_bf16 v[108:111], v[212:215], v[172:175], v[108:111]
    ds_read_b64_tr_b16 v[194:195], v10 offset:2688
    s_waitcnt vmcnt(18)
    s_waitcnt lgkmcnt(0)
    s_add_u32 s36, s97, 6
    s_and_b32 s36, s36, 7
    s_mul_i32 s89, s36, 40960
    s_add_u32 s89, s89, s98
    s_add_u32 s36, s97, 5
    s_and_b32 s36, s36, 7
    s_lshl_b32 s88, s36, 13
    s_add_u32 s88, s88, s99
    v_mfma_f32_16x16x32_bf16 v[32:35], v[176:179], v[112:115], v[32:35]
    v_add_u32 v11, s94, v8
    v_mfma_f32_16x16x32_bf16 v[52:55], v[176:179], v[116:119], v[52:55]
    s_mov_b32 m0, s93
    s_nop 0
    buffer_load_dwordx4 v2, s[76:79], s89 offen lds
    v_mfma_f32_16x16x32_bf16 v[72:75], v[176:179], v[120:123], v[72:75]
    ds_read_b64_tr_b16 v[196:197], v11 offset:0
    v_mfma_f32_16x16x32_bf16 v[92:95], v[176:179], v[124:127], v[92:95]
    buffer_load_dwordx4 v3, s[76:79], s89 offen offset:1024 lds
    v_mfma_f32_16x16x32_bf16 v[36:39], v[180:183], v[112:115], v[36:39]
    ds_read_b64_tr_b16 v[198:199], v11 offset:2560
    v_mfma_f32_16x16x32_bf16 v[56:59], v[180:183], v[116:119], v[56:59]
    buffer_load_dwordx4 v4, s[76:79], s89 offen offset:2048 lds
    v_mfma_f32_16x16x32_bf16 v[76:79], v[180:183], v[120:123], v[76:79]
    ds_read_b64_tr_b16 v[200:201], v11 offset:32
    v_mfma_f32_16x16x32_bf16 v[96:99], v[180:183], v[124:127], v[96:99]
    buffer_load_dwordx4 v5, s[76:79], s89 offen offset:3072 lds
    v_mfma_f32_16x16x32_bf16 v[40:43], v[184:187], v[112:115], v[40:43]
    ds_read_b64_tr_b16 v[202:203], v11 offset:2592
    v_mfma_f32_16x16x32_bf16 v[60:63], v[184:187], v[116:119], v[60:63]
    s_add_u32 m0, s93, 4096
    s_nop 0
    buffer_load_dwordx4 v6, s[76:79], s89 offen lds
    v_mfma_f32_16x16x32_bf16 v[80:83], v[184:187], v[120:123], v[80:83]
    ds_read_b64_tr_b16 v[204:205], v11 offset:64
    v_mfma_f32_16x16x32_bf16 v[100:103], v[184:187], v[124:127], v[100:103]
    buffer_load_dwordx4 v[160:163], v7, s[24:27], s88 offen offset:0 sc1
    v_mfma_f32_16x16x32_bf16 v[44:47], v[188:191], v[112:115], v[44:47]
    ds_read_b64_tr_b16 v[206:207], v11 offset:2624
    v_mfma_f32_16x16x32_bf16 v[64:67], v[188:191], v[116:119], v[64:67]
    buffer_load_dwordx4 v[164:167], v7, s[24:27], s88 offen offset:1024 sc1
    v_mfma_f32_16x16x32_bf16 v[84:87], v[188:191], v[120:123], v[84:87]
    ds_read_b64_tr_b16 v[208:209], v11 offset:96
    v_mfma_f32_16x16x32_bf16 v[104:107], v[188:191], v[124:127], v[104:107]
    buffer_load_dwordx4 v[168:171], v7, s[24:27], s88 offen offset:2048 sc1
    v_mfma_f32_16x16x32_bf16 v[48:51], v[192:195], v[112:115], v[48:51]
    ds_read_b64_tr_b16 v[210:211], v11 offset:2656
    v_mfma_f32_16x16x32_bf16 v[68:71], v[192:195], v[116:119], v[68:71]
    buffer_load_dwordx4 v[172:175], v7, s[24:27], s88 offen offset:3072 sc1
    v_mfma_f32_16x16x32_bf16 v[88:91], v[192:195], v[120:123], v[88:91]
    ds_read_b64_tr_b16 v[212:213], v11 offset:128
    v_mfma_f32_16x16x32_bf16 v[108:111], v[192:195], v[124:127], v[108:111]
    ds_read_b64_tr_b16 v[214:215], v11 offset:2688
    s_waitcnt vmcnt(18)
    s_waitcnt lgkmcnt(0)
    s_add_u32 s36, s97, 7
    s_and_b32 s36, s36, 7
    s_mul_i32 s89, s36, 40960
    s_add_u32 s89, s89, s98
    s_add_u32 s36, s97, 6
    s_and_b32 s36, s36, 7
    s_lshl_b32 s88, s36, 13
    s_add_u32 s88, s88, s99
    v_mfma_f32_16x16x32_bf16 v[32:35], v[196:199], v[128:131], v[32:35]
    v_add_u32 v10, s95, v8
    v_mfma_f32_16x16x32_bf16 v[52:55], v[196:199], v[132:135], v[52:55]
    s_mov_b32 m0, s94
    s_nop 0
    buffer_load_dwordx4 v2, s[76:79], s89 offen lds
    v_mfma_f32_16x16x32_bf16 v[72:75], v[196:199], v[136:139], v[72:75]
    ds_read_b64_tr_b16 v[176:177], v10 offset:0
    v_mfma_f32_16x16x32_bf16 v[92:95], v[196:199], v[140:143], v[92:95]
    buffer_load_dwordx4 v3, s[76:79], s89 offen offset:1024 lds
    v_mfma_f32_16x16x32_bf16 v[36:39], v[200:203], v[128:131], v[36:39]
    ds_read_b64_tr_b16 v[178:179], v10 offset:2560
    v_mfma_f32_16x16x32_bf16 v[56:59], v[200:203], v[132:135], v[56:59]
    buffer_load_dwordx4 v4, s[76:79], s89 offen offset:2048 lds
    v_mfma_f32_16x16x32_bf16 v[76:79], v[200:203], v[136:139], v[76:79]
    ds_read_b64_tr_b16 v[180:181], v10 offset:32
    v_mfma_f32_16x16x32_bf16 v[96:99], v[200:203], v[140:143], v[96:99]
    buffer_load_dwordx4 v5, s[76:79], s89 offen offset:3072 lds
    v_mfma_f32_16x16x32_bf16 v[40:43], v[204:207], v[128:131], v[40:43]
    ds_read_b64_tr_b16 v[182:183], v10 offset:2592
    v_mfma_f32_16x16x32_bf16 v[60:63], v[204:207], v[132:135], v[60:63]
    s_add_u32 m0, s94, 4096
    s_nop 0
    buffer_load_dwordx4 v6, s[76:79], s89 offen lds
    v_mfma_f32_16x16x32_bf16 v[80:83], v[204:207], v[136:139], v[80:83]
    ds_read_b64_tr_b16 v[184:185], v10 offset:64
    v_mfma_f32_16x16x32_bf16 v[100:103], v[204:207], v[140:143], v[100:103]
    buffer_load_dwordx4 v[112:115], v7, s[24:27], s88 offen offset:0 sc1
    v_mfma_f32_16x16x32_bf16 v[44:47], v[208:211], v[128:131], v[44:47]
    ds_read_b64_tr_b16 v[186:187], v10 offset:2624
    v_mfma_f32_16x16x32_bf16 v[64:67], v[208:211], v[132:135], v[64:67]
    buffer_load_dwordx4 v[116:119], v7, s[24:27], s88 offen offset:1024 sc1
    v_mfma_f32_16x16x32_bf16 v[84:87], v[208:211], v[136:139], v[84:87]
    ds_read_b64_tr_b16 v[188:189], v10 offset:96
    v_mfma_f32_16x16x32_bf16 v[104:107], v[208:211], v[140:143], v[104:107]
    buffer_load_dwordx4 v[120:123], v7, s[24:27], s88 offen offset:2048 sc1
    v_mfma_f32_16x16x32_bf16 v[48:51], v[212:215], v[128:131], v[48:51]
    ds_read_b64_tr_b16 v[190:191], v10 offset:2656
    v_mfma_f32_16x16x32_bf16 v[68:71], v[212:215], v[132:135], v[68:71]
    buffer_load_dwordx4 v[124:127], v7, s[24:27], s88 offen offset:3072 sc1
    v_mfma_f32_16x16x32_bf16 v[88:91], v[212:215], v[136:139], v[88:91]
    ds_read_b64_tr_b16 v[192:193], v10 offset:128
    v_mfma_f32_16x16x32_bf16 v[108:111], v[212:215], v[140:143], v[108:111]
    ds_read_b64_tr_b16 v[194:195], v10 offset:2688
    s_waitcnt vmcnt(18)
    s_waitcnt lgkmcnt(0)
    s_add_u32 s36, s97, 7
    s_and_b32 s36, s36, 7
    s_lshl_b32 s88, s36, 13
    s_add_u32 s88, s88, s99
    v_mfma_f32_16x16x32_bf16 v[32:35], v[176:179], v[144:147], v[32:35]
    v_add_u32 v11, s100, v8
    v_mfma_f32_16x16x32_bf16 v[52:55], v[176:179], v[148:151], v[52:55]
    buffer_load_dwordx4 v[128:131], v7, s[24:27], s88 offen offset:0 sc1
    v_mfma_f32_16x16x32_bf16 v[72:75], v[176:179], v[152:155], v[72:75]
    ds_read_b64_tr_b16 v[196:197], v11 offset:0
    v_mfma_f32_16x16x32_bf16 v[92:95], v[176:179], v[156:159], v[92:95]
    buffer_load_dwordx4 v[132:135], v7, s[24:27], s88 offen offset:1024 sc1
    v_mfma_f32_16x16x32_bf16 v[36:39], v[180:183], v[144:147], v[36:39]
    ds_read_b64_tr_b16 v[198:199], v11 offset:2560
    v_mfma_f32_16x16x32_bf16 v[56:59], v[180:183], v[148:151], v[56:59]
    buffer_load_dwordx4 v[136:139], v7, s[24:27], s88 offen offset:2048 sc1
    v_mfma_f32_16x16x32_bf16 v[76:79], v[180:183], v[152:155], v[76:79]
    ds_read_b64_tr_b16 v[200:201], v11 offset:32
    v_mfma_f32_16x16x32_bf16 v[96:99], v[180:183], v[156:159], v[96:99]
    buffer_load_dwordx4 v[140:143], v7, s[24:27], s88 offen offset:3072 sc1
    v_mfma_f32_16x16x32_bf16 v[40:43], v[184:187], v[144:147], v[40:43]
    ds_read_b64_tr_b16 v[202:203], v11 offset:2592
    v_mfma_f32_16x16x32_bf16 v[60:63], v[184:187], v[148:151], v[60:63]
    ds_read_b64_tr_b16 v[204:205], v11 offset:64
    v_mfma_f32_16x16x32_bf16 v[80:83], v[184:187], v[152:155], v[80:83]
    ds_read_b64_tr_b16 v[206:207], v11 offset:2624
    v_mfma_f32_16x16x32_bf16 v[100:103], v[184:187], v[156:159], v[100:103]
    ds_read_b64_tr_b16 v[208:209], v11 offset:96
    v_mfma_f32_16x16x32_bf16 v[44:47], v[188:191], v[144:147], v[44:47]
    ds_read_b64_tr_b16 v[210:211], v11 offset:2656
    v_mfma_f32_16x16x32_bf16 v[64:67], v[188:191], v[148:151], v[64:67]
    ds_read_b64_tr_b16 v[212:213], v11 offset:128
    v_mfma_f32_16x16x32_bf16 v[84:87], v[188:191], v[152:155], v[84:87]
    ds_read_b64_tr_b16 v[214:215], v11 offset:2688
    v_mfma_f32_16x16x32_bf16 v[104:107], v[188:191], v[156:159], v[104:107]
    v_mfma_f32_16x16x32_bf16 v[48:51], v[192:195], v[144:147], v[48:51]
    v_mfma_f32_16x16x32_bf16 v[68:71], v[192:195], v[148:151], v[68:71]
    v_mfma_f32_16x16x32_bf16 v[88:91], v[192:195], v[152:155], v[88:91]
    v_mfma_f32_16x16x32_bf16 v[108:111], v[192:195], v[156:159], v[108:111]
    s_waitcnt vmcnt(13)
    s_waitcnt lgkmcnt(0)
    v_mfma_f32_16x16x32_bf16 v[32:35], v[196:199], v[160:163], v[32:35]
    v_add_u32 v10, s93, v8
    v_mfma_f32_16x16x32_bf16 v[52:55], v[196:199], v[164:167], v[52:55]
    ds_read_b64_tr_b16 v[176:177], v10 offset:0
    v_mfma_f32_16x16x32_bf16 v[72:75], v[196:199], v[168:171], v[72:75]
    ds_read_b64_tr_b16 v[178:179], v10 offset:2560
    v_mfma_f32_16x16x32_bf16 v[92:95], v[196:199], v[172:175], v[92:95]
    ds_read_b64_tr_b16 v[180:181], v10 offset:32
    v_mfma_f32_16x16x32_bf16 v[36:39], v[200:203], v[160:163], v[36:39]
    ds_read_b64_tr_b16 v[182:183], v10 offset:2592
    v_mfma_f32_16x16x32_bf16 v[56:59], v[200:203], v[164:167], v[56:59]
    ds_read_b64_tr_b16 v[184:185], v10 offset:64
    v_mfma_f32_16x16x32_bf16 v[76:79], v[200:203], v[168:171], v[76:79]
    ds_read_b64_tr_b16 v[186:187], v10 offset:2624
    v_mfma_f32_16x16x32_bf16 v[96:99], v[200:203], v[172:175], v[96:99]
    ds_read_b64_tr_b16 v[188:189], v10 offset:96
    v_mfma_f32_16x16x32_bf16 v[40:43], v[204:207], v[160:163], v[40:43]
    ds_read_b64_tr_b16 v[190:191], v10 offset:2656
    v_mfma_f32_16x16x32_bf16 v[60:63], v[204:207], v[164:167], v[60:63]
    ds_read_b64_tr_b16 v[192:193], v10 offset:128
    v_mfma_f32_16x16x32_bf16 v[80:83], v[204:207], v[168:171], v[80:83]
    ds_read_b64_tr_b16 v[194:195], v10 offset:2688
    v_mfma_f32_16x16x32_bf16 v[100:103], v[204:207], v[172:175], v[100:103]
    v_mfma_f32_16x16x32_bf16 v[44:47], v[208:211], v[160:163], v[44:47]
    v_mfma_f32_16x16x32_bf16 v[64:67], v[208:211], v[164:167], v[64:67]
    v_mfma_f32_16x16x32_bf16 v[84:87], v[208:211], v[168:171], v[84:87]
    v_mfma_f32_16x16x32_bf16 v[104:107], v[208:211], v[172:175], v[104:107]
    v_mfma_f32_16x16x32_bf16 v[48:51], v[212:215], v[160:163], v[48:51]
    v_mfma_f32_16x16x32_bf16 v[68:71], v[212:215], v[164:167], v[68:71]
    v_mfma_f32_16x16x32_bf16 v[88:91], v[212:215], v[168:171], v[88:91]
    v_mfma_f32_16x16x32_bf16 v[108:111], v[212:215], v[172:175], v[108:111]
    s_waitcnt vmcnt(4)
    s_waitcnt lgkmcnt(0)
    v_mfma_f32_16x16x32_bf16 v[32:35], v[176:179], v[112:115], v[32:35]
    v_add_u32 v11, s94, v8
    v_mfma_f32_16x16x32_bf16 v[52:55], v[176:179], v[116:119], v[52:55]
    ds_read_b64_tr_b16 v[196:197], v11 offset:0
    v_mfma_f32_16x16x32_bf16 v[72:75], v[176:179], v[120:123], v[72:75]
    ds_read_b64_tr_b16 v[198:199], v11 offset:2560
    v_mfma_f32_16x16x32_bf16 v[92:95], v[176:179], v[124:127], v[92:95]
    ds_read_b64_tr_b16 v[200:201], v11 offset:32
    v_mfma_f32_16x16x32_bf16 v[36:39], v[180:183], v[112:115], v[36:39]
    ds_read_b64_tr_b16 v[202:203], v11 offset:2592
    v_mfma_f32_16x16x32_bf16 v[56:59], v[180:183], v[116:119], v[56:59]
    ds_read_b64_tr_b16 v[204:205], v11 offset:64
    v_mfma_f32_16x16x32_bf16 v[76:79], v[180:183], v[120:123], v[76:79]
    ds_read_b64_tr_b16 v[206:207], v11 offset:2624
    v_mfma_f32_16x16x32_bf16 v[96:99], v[180:183], v[124:127], v[96:99]
    ds_read_b64_tr_b16 v[208:209], v11 offset:96
    v_mfma_f32_16x16x32_bf16 v[40:43], v[184:187], v[112:115], v[40:43]
    ds_read_b64_tr_b16 v[210:211], v11 offset:2656
    v_mfma_f32_16x16x32_bf16 v[60:63], v[184:187], v[116:119], v[60:63]
    ds_read_b64_tr_b16 v[212:213], v11 offset:128
    v_mfma_f32_16x16x32_bf16 v[80:83], v[184:187], v[120:123], v[80:83]
    ds_read_b64_tr_b16 v[214:215], v11 offset:2688
    v_mfma_f32_16x16x32_bf16 v[100:103], v[184:187], v[124:127], v[100:103]
    v_mfma_f32_16x16x32_bf16 v[44:47], v[188:191], v[112:115], v[44:47]
    v_mfma_f32_16x16x32_bf16 v[64:67], v[188:191], v[116:119], v[64:67]
    v_mfma_f32_16x16x32_bf16 v[84:87], v[188:191], v[120:123], v[84:87]
    v_mfma_f32_16x16x32_bf16 v[104:107], v[188:191], v[124:127], v[104:107]
    v_mfma_f32_16x16x32_bf16 v[48:51], v[192:195], v[112:115], v[48:51]
    v_mfma_f32_16x16x32_bf16 v[68:71], v[192:195], v[116:119], v[68:71]
    v_mfma_f32_16x16x32_bf16 v[88:91], v[192:195], v[120:123], v[88:91]
    v_mfma_f32_16x16x32_bf16 v[108:111], v[192:195], v[124:127], v[108:111]
    s_waitcnt vmcnt(0)
    s_waitcnt lgkmcnt(0)
    v_mfma_f32_16x16x32_bf16 v[32:35], v[196:199], v[128:131], v[32:35]
    v_mfma_f32_16x16x32_bf16 v[52:55], v[196:199], v[132:135], v[52:55]
    v_mfma_f32_16x16x32_bf16 v[72:75], v[196:199], v[136:139], v[72:75]
    v_mfma_f32_16x16x32_bf16 v[92:95], v[196:199], v[140:143], v[92:95]
    v_mfma_f32_16x16x32_bf16 v[36:39], v[200:203], v[128:131], v[36:39]
    v_mfma_f32_16x16x32_bf16 v[56:59], v[200:203], v[132:135], v[56:59]
    v_mfma_f32_16x16x32_bf16 v[76:79], v[200:203], v[136:139], v[76:79]
    v_mfma_f32_16x16x32_bf16 v[96:99], v[200:203], v[140:143], v[96:99]
    v_mfma_f32_16x16x32_bf16 v[40:43], v[204:207], v[128:131], v[40:43]
    v_mfma_f32_16x16x32_bf16 v[60:63], v[204:207], v[132:135], v[60:63]
    v_mfma_f32_16x16x32_bf16 v[80:83], v[204:207], v[136:139], v[80:83]
    v_mfma_f32_16x16x32_bf16 v[100:103], v[204:207], v[140:143], v[100:103]
    v_mfma_f32_16x16x32_bf16 v[44:47], v[208:211], v[128:131], v[44:47]
    v_mfma_f32_16x16x32_bf16 v[64:67], v[208:211], v[132:135], v[64:67]
    v_mfma_f32_16x16x32_bf16 v[84:87], v[208:211], v[136:139], v[84:87]
    v_mfma_f32_16x16x32_bf16 v[104:107], v[208:211], v[140:143], v[104:107]
    v_mfma_f32_16x16x32_bf16 v[48:51], v[212:215], v[128:131], v[48:51]
    v_mfma_f32_16x16x32_bf16 v[68:71], v[212:215], v[132:135], v[68:71]
    v_mfma_f32_16x16x32_bf16 v[88:91], v[212:215], v[136:139], v[88:91]
    v_mfma_f32_16x16x32_bf16 v[108:111], v[212:215], v[140:143], v[108:111]
    s_nop 7
    s_waitcnt lgkmcnt(0)
    s_mul_i32 s34, s3, 20480
    v_lshlrev_b32 v10, 4, v1
    v_add_u32 v11, s34, v10
    ds_write_b128 v11, v[32:35] offset:0
    ds_write_b128 v11, v[36:39] offset:1024
    ds_write_b128 v11, v[40:43] offset:2048
    ds_write_b128 v11, v[44:47] offset:3072
    ds_write_b128 v11, v[48:51] offset:4096
    ds_write_b128 v11, v[52:55] offset:5120
    ds_write_b128 v11, v[56:59] offset:6144
    ds_write_b128 v11, v[60:63] offset:7168
    ds_write_b128 v11, v[64:67] offset:8192
    ds_write_b128 v11, v[68:71] offset:9216
    ds_write_b128 v11, v[72:75] offset:10240
    ds_write_b128 v11, v[76:79] offset:11264
    ds_write_b128 v11, v[80:83] offset:12288
    ds_write_b128 v11, v[84:87] offset:13312
    ds_write_b128 v11, v[88:91] offset:14336
    ds_write_b128 v11, v[92:95] offset:15360
    ds_write_b128 v11, v[96:99] offset:16384
    ds_write_b128 v11, v[100:103] offset:17408
    ds_write_b128 v11, v[104:107] offset:18432
    ds_write_b128 v11, v[108:111] offset:19456
    s_waitcnt lgkmcnt(0)
    s_barrier

    s_and_b32 s34, s3, 3
    s_mul_i32 s35, s34, 5120
    s_lshr_b32 s36, s3, 2
    s_mul_i32 s36, s36, 3072
    s_add_u32 s35, s35, s36
    v_add_u32 v11, s35, v10
    v_add_u32 v12, 61440, v11
    v_add_u32 v13, 122880, v11
    v_and_b32 v14, 15, v1
    s_lshl_b32 s36, s90, 6
    s_lshl_b32 s37, s34, 4
    s_add_u32 s36, s36, s37
    v_add_u32 v14, s36, v14
    v_mul_u32_u24 v14, 1280, v14
    v_lshrrev_b32 v15, 4, v1
    v_lshl_add_u32 v14, v15, 3, v14
    s_mul_i32 s36, s91, 160
    s_lshr_b32 s37, s3, 2
    s_mul_i32 s37, s37, 96
    s_add_u32 s36, s36, s37

    ds_read_b128 v[32:35], v11 offset:0
    ds_read_b128 v[36:39], v11 offset:20480
    ds_read_b128 v[40:43], v11 offset:40960
    ds_read_b128 v[44:47], v12 offset:0
    ds_read_b128 v[48:51], v12 offset:20480
    ds_read_b128 v[52:55], v12 offset:40960
    ds_read_b128 v[56:59], v13 offset:0
    ds_read_b128 v[60:63], v13 offset:20480
    ds_read_b128 v[64:67], v11 offset:1024
    ds_read_b128 v[68:71], v11 offset:21504
    ds_read_b128 v[72:75], v11 offset:41984
    ds_read_b128 v[76:79], v12 offset:1024
    ds_read_b128 v[80:83], v12 offset:21504
    ds_read_b128 v[84:87], v12 offset:41984
    ds_read_b128 v[88:91], v13 offset:1024
    ds_read_b128 v[92:95], v13 offset:21504
    s_waitcnt lgkmcnt(8)
    v_add_f32 v32, v32, v36
    v_add_f32 v33, v33, v37
    v_add_f32 v34, v34, v38
    v_add_f32 v35, v35, v39
    v_add_f32 v32, v32, v40
    v_add_f32 v33, v33, v41
    v_add_f32 v34, v34, v42
    v_add_f32 v35, v35, v43
    v_add_f32 v32, v32, v44
    v_add_f32 v33, v33, v45
    v_add_f32 v34, v34, v46
    v_add_f32 v35, v35, v47
    v_add_f32 v32, v32, v48
    v_add_f32 v33, v33, v49
    v_add_f32 v34, v34, v50
    v_add_f32 v35, v35, v51
    v_add_f32 v32, v32, v52
    v_add_f32 v33, v33, v53
    v_add_f32 v34, v34, v54
    v_add_f32 v35, v35, v55
    v_add_f32 v32, v32, v56
    v_add_f32 v33, v33, v57
    v_add_f32 v34, v34, v58
    v_add_f32 v35, v35, v59
    v_add_f32 v32, v32, v60
    v_add_f32 v33, v33, v61
    v_add_f32 v34, v34, v62
    v_add_f32 v35, v35, v63
    v_cvt_pk_bf16_f32 v36, v32, v33
    v_cvt_pk_bf16_f32 v37, v34, v35
    buffer_store_dwordx2 v[36:37], v14, s[80:83], s36 offen offset:0
    s_waitcnt lgkmcnt(0)
    v_add_f32 v64, v64, v68
    v_add_f32 v65, v65, v69
    v_add_f32 v66, v66, v70
    v_add_f32 v67, v67, v71
    v_add_f32 v64, v64, v72
    v_add_f32 v65, v65, v73
    v_add_f32 v66, v66, v74
    v_add_f32 v67, v67, v75
    v_add_f32 v64, v64, v76
    v_add_f32 v65, v65, v77
    v_add_f32 v66, v66, v78
    v_add_f32 v67, v67, v79
    v_add_f32 v64, v64, v80
    v_add_f32 v65, v65, v81
    v_add_f32 v66, v66, v82
    v_add_f32 v67, v67, v83
    v_add_f32 v64, v64, v84
    v_add_f32 v65, v65, v85
    v_add_f32 v66, v66, v86
    v_add_f32 v67, v67, v87
    v_add_f32 v64, v64, v88
    v_add_f32 v65, v65, v89
    v_add_f32 v66, v66, v90
    v_add_f32 v67, v67, v91
    v_add_f32 v64, v64, v92
    v_add_f32 v65, v65, v93
    v_add_f32 v66, v66, v94
    v_add_f32 v67, v67, v95
    v_cvt_pk_bf16_f32 v68, v64, v65
    v_cvt_pk_bf16_f32 v69, v66, v67
    buffer_store_dwordx2 v[68:69], v14, s[80:83], s36 offen offset:32
    s_cmp_ge_u32 s3, 4
    s_cbranch_scc1 L_fin_done_g0
    ds_read_b128 v[96:99], v11 offset:2048
    ds_read_b128 v[100:103], v11 offset:22528
    ds_read_b128 v[104:107], v11 offset:43008
    ds_read_b128 v[108:111], v12 offset:2048
    ds_read_b128 v[112:115], v12 offset:22528
    ds_read_b128 v[116:119], v12 offset:43008
    ds_read_b128 v[120:123], v13 offset:2048
    ds_read_b128 v[124:127], v13 offset:22528
    s_waitcnt lgkmcnt(0)
    v_add_f32 v96, v96, v100
    v_add_f32 v97, v97, v101
    v_add_f32 v98, v98, v102
    v_add_f32 v99, v99, v103
    v_add_f32 v96, v96, v104
    v_add_f32 v97, v97, v105
    v_add_f32 v98, v98, v106
    v_add_f32 v99, v99, v107
    v_add_f32 v96, v96, v108
    v_add_f32 v97, v97, v109
    v_add_f32 v98, v98, v110
    v_add_f32 v99, v99, v111
    v_add_f32 v96, v96, v112
    v_add_f32 v97, v97, v113
    v_add_f32 v98, v98, v114
    v_add_f32 v99, v99, v115
    v_add_f32 v96, v96, v116
    v_add_f32 v97, v97, v117
    v_add_f32 v98, v98, v118
    v_add_f32 v99, v99, v119
    v_add_f32 v96, v96, v120
    v_add_f32 v97, v97, v121
    v_add_f32 v98, v98, v122
    v_add_f32 v99, v99, v123
    v_add_f32 v96, v96, v124
    v_add_f32 v97, v97, v125
    v_add_f32 v98, v98, v126
    v_add_f32 v99, v99, v127
    v_cvt_pk_bf16_f32 v100, v96, v97
    v_cvt_pk_bf16_f32 v101, v98, v99
    buffer_store_dwordx2 v[100:101], v14, s[80:83], s36 offen offset:64
L_fin_done_g0:
    s_branch L_end
L_slow0_pa:
    s_nop 15
    v_mov_b32 v23, s46
    v_min_f32 v23, 0, v23
    v_mov_b32 v24, v22
    s_nop 1
    v_permlane32_swap_b32 v22, v24
    v_max_f32 v22, v22, v24
    v_max_f32 v22, v22, v23
    v_max_f32 v23, 0, v22
    v_sub_f32 v23, 0, v23
    v_exp_f32 v23, v23
    v_sub_f32 v136, v136, v22
    v_sub_f32 v137, v137, v22
    v_sub_f32 v138, v138, v22
    v_sub_f32 v139, v139, v22
    v_sub_f32 v140, v140, v22
    v_sub_f32 v141, v141, v22
    v_sub_f32 v142, v142, v22
    v_sub_f32 v143, v143, v22
    v_sub_f32 v144, v144, v22
    v_sub_f32 v145, v145, v22
    v_sub_f32 v146, v146, v22
    v_sub_f32 v147, v147, v22
    v_sub_f32 v148, v148, v22
    v_sub_f32 v149, v149, v22
    v_sub_f32 v150, v150, v22
    v_sub_f32 v151, v151, v22
    v_sub_f32 v240, v240, v22
    v_sub_f32 v241, v241, v22
    v_sub_f32 v242, v242, v22
    v_sub_f32 v243, v243, v22
    v_sub_f32 v244, v244, v22
    v_sub_f32 v245, v245, v22
    v_sub_f32 v246, v246, v22
    v_sub_f32 v247, v247, v22
    v_sub_f32 v248, v248, v22
    v_sub_f32 v249, v249, v22
    v_sub_f32 v250, v250, v22
    v_sub_f32 v251, v251, v22
    v_sub_f32 v252, v252, v22
    v_sub_f32 v253, v253, v22
    v_sub_f32 v254, v254, v22
    v_sub_f32 v255, v255, v22
    v_mul_f32 v72, v72, v23
    v_mul_f32 v73, v73, v23
    v_mul_f32 v74, v74, v23
    v_mul_f32 v75, v75, v23
    v_mul_f32 v76, v76, v23
    v_mul_f32 v77, v77, v23
    v_mul_f32 v78, v78, v23
    v_mul_f32 v79, v79, v23
    v_mul_f32 v80, v80, v23
    v_mul_f32 v81, v81, v23
    v_mul_f32 v82, v82, v23
    v_mul_f32 v83, v83, v23
    v_mul_f32 v84, v84, v23
    v_mul_f32 v85, v85, v23
    v_mul_f32 v86, v86, v23
    v_mul_f32 v87, v87, v23
    v_mul_f32 v88, v88, v23
    v_mul_f32 v89, v89, v23
    v_mul_f32 v90, v90, v23
    v_mul_f32 v91, v91, v23
    v_mul_f32 v92, v92, v23
    v_mul_f32 v93, v93, v23
    v_mul_f32 v94, v94, v23
    v_mul_f32 v95, v95, v23
    v_mul_f32 v96, v96, v23
    v_mul_f32 v97, v97, v23
    v_mul_f32 v98, v98, v23
    v_mul_f32 v99, v99, v23
    v_mul_f32 v100, v100, v23
    v_mul_f32 v101, v101, v23
    v_mul_f32 v102, v102, v23
    v_mul_f32 v103, v103, v23
    v_mul_f32 v104, v104, v23
    v_mul_f32 v105, v105, v23
    v_mul_f32 v106, v106, v23
    v_mul_f32 v107, v107, v23
    v_mul_f32 v108, v108, v23
    v_mul_f32 v109, v109, v23
    v_mul_f32 v110, v110, v23
    v_mul_f32 v111, v111, v23
    v_mul_f32 v112, v112, v23
    v_mul_f32 v113, v113, v23
    v_mul_f32 v114, v114, v23
    v_mul_f32 v115, v115, v23
    v_mul_f32 v116, v116, v23
    v_mul_f32 v117, v117, v23
    v_mul_f32 v118, v118, v23
    v_mul_f32 v119, v119, v23
    v_mul_f32 v120, v120, v23
    v_mul_f32 v121, v121, v23
    v_mul_f32 v122, v122, v23
    v_mul_f32 v123, v123, v23
    v_mul_f32 v124, v124, v23
    v_mul_f32 v125, v125, v23
    v_mul_f32 v126, v126, v23
    v_mul_f32 v127, v127, v23
    v_mul_f32 v128, v128, v23
    v_mul_f32 v129, v129, v23
    v_mul_f32 v130, v130, v23
    v_mul_f32 v131, v131, v23
    v_mul_f32 v132, v132, v23
    v_mul_f32 v133, v133, v23
    v_mul_f32 v134, v134, v23
    v_mul_f32 v135, v135, v23
    v_mul_f32 v20, v20, v23
    v_mul_f32 v21, v21, v23
    s_mov_b32 s46, s43
    s_branch L_fast0_pa
L_slow0_r1:
    s_nop 15
    v_mov_b32 v23, s46
    v_min_f32 v23, 0, v23
    v_mov_b32 v24, v22
    s_nop 1
    v_permlane32_swap_b32 v22, v24
    v_max_f32 v22, v22, v24
    v_max_f32 v22, v22, v23
    v_max_f32 v23, 0, v22
    v_sub_f32 v23, 0, v23
    v_exp_f32 v23, v23
    v_sub_f32 v136, v136, v22
    v_sub_f32 v137, v137, v22
    v_sub_f32 v138, v138, v22
    v_sub_f32 v139, v139, v22
    v_sub_f32 v140, v140, v22
    v_sub_f32 v141, v141, v22
    v_sub_f32 v142, v142, v22
    v_sub_f32 v143, v143, v22
    v_sub_f32 v144, v144, v22
    v_sub_f32 v145, v145, v22
    v_sub_f32 v146, v146, v22
    v_sub_f32 v147, v147, v22
    v_sub_f32 v148, v148, v22
    v_sub_f32 v149, v149, v22
    v_sub_f32 v150, v150, v22
    v_sub_f32 v151, v151, v22
    v_sub_f32 v240, v240, v22
    v_sub_f32 v241, v241, v22
    v_sub_f32 v242, v242, v22
    v_sub_f32 v243, v243, v22
    v_sub_f32 v244, v244, v22
    v_sub_f32 v245, v245, v22
    v_sub_f32 v246, v246, v22
    v_sub_f32 v247, v247, v22
    v_sub_f32 v248, v248, v22
    v_sub_f32 v249, v249, v22
    v_sub_f32 v250, v250, v22
    v_sub_f32 v251, v251, v22
    v_sub_f32 v252, v252, v22
    v_sub_f32 v253, v253, v22
    v_sub_f32 v254, v254, v22
    v_sub_f32 v255, v255, v22
    v_mul_f32 v72, v72, v23
    v_mul_f32 v73, v73, v23
    v_mul_f32 v74, v74, v23
    v_mul_f32 v75, v75, v23
    v_mul_f32 v76, v76, v23
    v_mul_f32 v77, v77, v23
    v_mul_f32 v78, v78, v23
    v_mul_f32 v79, v79, v23
    v_mul_f32 v80, v80, v23
    v_mul_f32 v81, v81, v23
    v_mul_f32 v82, v82, v23
    v_mul_f32 v83, v83, v23
    v_mul_f32 v84, v84, v23
    v_mul_f32 v85, v85, v23
    v_mul_f32 v86, v86, v23
    v_mul_f32 v87, v87, v23
    v_mul_f32 v88, v88, v23
    v_mul_f32 v89, v89, v23
    v_mul_f32 v90, v90, v23
    v_mul_f32 v91, v91, v23
    v_mul_f32 v92, v92, v23
    v_mul_f32 v93, v93, v23
    v_mul_f32 v94, v94, v23
    v_mul_f32 v95, v95, v23
    v_mul_f32 v96, v96, v23
    v_mul_f32 v97, v97, v23
    v_mul_f32 v98, v98, v23
    v_mul_f32 v99, v99, v23
    v_mul_f32 v100, v100, v23
    v_mul_f32 v101, v101, v23
    v_mul_f32 v102, v102, v23
    v_mul_f32 v103, v103, v23
    v_mul_f32 v104, v104, v23
    v_mul_f32 v105, v105, v23
    v_mul_f32 v106, v106, v23
    v_mul_f32 v107, v107, v23
    v_mul_f32 v108, v108, v23
    v_mul_f32 v109, v109, v23
    v_mul_f32 v110, v110, v23
    v_mul_f32 v111, v111, v23
    v_mul_f32 v112, v112, v23
    v_mul_f32 v113, v113, v23
    v_mul_f32 v114, v114, v23
    v_mul_f32 v115, v115, v23
    v_mul_f32 v116, v116, v23
    v_mul_f32 v117, v117, v23
    v_mul_f32 v118, v118, v23
    v_mul_f32 v119, v119, v23
    v_mul_f32 v120, v120, v23
    v_mul_f32 v121, v121, v23
    v_mul_f32 v122, v122, v23
    v_mul_f32 v123, v123, v23
    v_mul_f32 v124, v124, v23
    v_mul_f32 v125, v125, v23
    v_mul_f32 v126, v126, v23
    v_mul_f32 v127, v127, v23
    v_mul_f32 v128, v128, v23
    v_mul_f32 v129, v129, v23
    v_mul_f32 v130, v130, v23
    v_mul_f32 v131, v131, v23
    v_mul_f32 v132, v132, v23
    v_mul_f32 v133, v133, v23
    v_mul_f32 v134, v134, v23
    v_mul_f32 v135, v135, v23
    v_mul_f32 v20, v20, v23
    v_mul_f32 v21, v21, v23
    s_mov_b32 s46, s43
    s_branch L_fast0_r1
L_slow0_pb:
    s_nop 15
    v_mov_b32 v23, s46
    v_min_f32 v23, 0, v23
    v_mov_b32 v24, v22
    s_nop 1
    v_permlane32_swap_b32 v22, v24
    v_max_f32 v22, v22, v24
    v_max_f32 v22, v22, v23
    v_max_f32 v23, 0, v22
    v_sub_f32 v23, 0, v23
    v_exp_f32 v23, v23
    v_sub_f32 v136, v136, v22
    v_sub_f32 v137, v137, v22
    v_sub_f32 v138, v138, v22
    v_sub_f32 v139, v139, v22
    v_sub_f32 v140, v140, v22
    v_sub_f32 v141, v141, v22
    v_sub_f32 v142, v142, v22
    v_sub_f32 v143, v143, v22
    v_sub_f32 v144, v144, v22
    v_sub_f32 v145, v145, v22
    v_sub_f32 v146, v146, v22
    v_sub_f32 v147, v147, v22
    v_sub_f32 v148, v148, v22
    v_sub_f32 v149, v149, v22
    v_sub_f32 v150, v150, v22
    v_sub_f32 v151, v151, v22
    v_sub_f32 v240, v240, v22
    v_sub_f32 v241, v241, v22
    v_sub_f32 v242, v242, v22
    v_sub_f32 v243, v243, v22
    v_sub_f32 v244, v244, v22
    v_sub_f32 v245, v245, v22
    v_sub_f32 v246, v246, v22
    v_sub_f32 v247, v247, v22
    v_sub_f32 v248, v248, v22
    v_sub_f32 v249, v249, v22
    v_sub_f32 v250, v250, v22
    v_sub_f32 v251, v251, v22
    v_sub_f32 v252, v252, v22
    v_sub_f32 v253, v253, v22
    v_sub_f32 v254, v254, v22
    v_sub_f32 v255, v255, v22
    v_mul_f32 v72, v72, v23
    v_mul_f32 v73, v73, v23
    v_mul_f32 v74, v74, v23
    v_mul_f32 v75, v75, v23
    v_mul_f32 v76, v76, v23
    v_mul_f32 v77, v77, v23
    v_mul_f32 v78, v78, v23
    v_mul_f32 v79, v79, v23
    v_mul_f32 v80, v80, v23
    v_mul_f32 v81, v81, v23
    v_mul_f32 v82, v82, v23
    v_mul_f32 v83, v83, v23
    v_mul_f32 v84, v84, v23
    v_mul_f32 v85, v85, v23
    v_mul_f32 v86, v86, v23
    v_mul_f32 v87, v87, v23
    v_mul_f32 v88, v88, v23
    v_mul_f32 v89, v89, v23
    v_mul_f32 v90, v90, v23
    v_mul_f32 v91, v91, v23
    v_mul_f32 v92, v92, v23
    v_mul_f32 v93, v93, v23
    v_mul_f32 v94, v94, v23
    v_mul_f32 v95, v95, v23
    v_mul_f32 v96, v96, v23
    v_mul_f32 v97, v97, v23
    v_mul_f32 v98, v98, v23
    v_mul_f32 v99, v99, v23
    v_mul_f32 v100, v100, v23
    v_mul_f32 v101, v101, v23
    v_mul_f32 v102, v102, v23
    v_mul_f32 v103, v103, v23
    v_mul_f32 v104, v104, v23
    v_mul_f32 v105, v105, v23
    v_mul_f32 v106, v106, v23
    v_mul_f32 v107, v107, v23
    v_mul_f32 v108, v108, v23
    v_mul_f32 v109, v109, v23
    v_mul_f32 v110, v110, v23
    v_mul_f32 v111, v111, v23
    v_mul_f32 v112, v112, v23
    v_mul_f32 v113, v113, v23
    v_mul_f32 v114, v114, v23
    v_mul_f32 v115, v115, v23
    v_mul_f32 v116, v116, v23
    v_mul_f32 v117, v117, v23
    v_mul_f32 v118, v118, v23
    v_mul_f32 v119, v119, v23
    v_mul_f32 v120, v120, v23
    v_mul_f32 v121, v121, v23
    v_mul_f32 v122, v122, v23
    v_mul_f32 v123, v123, v23
    v_mul_f32 v124, v124, v23
    v_mul_f32 v125, v125, v23
    v_mul_f32 v126, v126, v23
    v_mul_f32 v127, v127, v23
    v_mul_f32 v128, v128, v23
    v_mul_f32 v129, v129, v23
    v_mul_f32 v130, v130, v23
    v_mul_f32 v131, v131, v23
    v_mul_f32 v132, v132, v23
    v_mul_f32 v133, v133, v23
    v_mul_f32 v134, v134, v23
    v_mul_f32 v135, v135, v23
    v_mul_f32 v20, v20, v23
    v_mul_f32 v21, v21, v23
    s_mov_b32 s46, s43
    s_branch L_fast0_pb
L_slow0_r2:
    s_nop 15
    v_mov_b32 v23, s46
    v_min_f32 v23, 0, v23
    v_mov_b32 v24, v22
    s_nop 1
    v_permlane32_swap_b32 v22, v24
    v_max_f32 v22, v22, v24
    v_max_f32 v22, v22, v23
    v_max_f32 v23, 0, v22
    v_sub_f32 v23, 0, v23
    v_exp_f32 v23, v23
    v_sub_f32 v136, v136, v22
    v_sub_f32 v137, v137, v22
    v_sub_f32 v138, v138, v22
    v_sub_f32 v139, v139, v22
    v_sub_f32 v140, v140, v22
    v_sub_f32 v141, v141, v22
    v_sub_f32 v142, v142, v22
    v_sub_f32 v143, v143, v22
    v_sub_f32 v144, v144, v22
    v_sub_f32 v145, v145, v22
    v_sub_f32 v146, v146, v22
    v_sub_f32 v147, v147, v22
    v_sub_f32 v148, v148, v22
    v_sub_f32 v149, v149, v22
    v_sub_f32 v150, v150, v22
    v_sub_f32 v151, v151, v22
    v_sub_f32 v240, v240, v22
    v_sub_f32 v241, v241, v22
    v_sub_f32 v242, v242, v22
    v_sub_f32 v243, v243, v22
    v_sub_f32 v244, v244, v22
    v_sub_f32 v245, v245, v22
    v_sub_f32 v246, v246, v22
    v_sub_f32 v247, v247, v22
    v_sub_f32 v248, v248, v22
    v_sub_f32 v249, v249, v22
    v_sub_f32 v250, v250, v22
    v_sub_f32 v251, v251, v22
    v_sub_f32 v252, v252, v22
    v_sub_f32 v253, v253, v22
    v_sub_f32 v254, v254, v22
    v_sub_f32 v255, v255, v22
    v_mul_f32 v72, v72, v23
    v_mul_f32 v73, v73, v23
    v_mul_f32 v74, v74, v23
    v_mul_f32 v75, v75, v23
    v_mul_f32 v76, v76, v23
    v_mul_f32 v77, v77, v23
    v_mul_f32 v78, v78, v23
    v_mul_f32 v79, v79, v23
    v_mul_f32 v80, v80, v23
    v_mul_f32 v81, v81, v23
    v_mul_f32 v82, v82, v23
    v_mul_f32 v83, v83, v23
    v_mul_f32 v84, v84, v23
    v_mul_f32 v85, v85, v23
    v_mul_f32 v86, v86, v23
    v_mul_f32 v87, v87, v23
    v_mul_f32 v88, v88, v23
    v_mul_f32 v89, v89, v23
    v_mul_f32 v90, v90, v23
    v_mul_f32 v91, v91, v23
    v_mul_f32 v92, v92, v23
    v_mul_f32 v93, v93, v23
    v_mul_f32 v94, v94, v23
    v_mul_f32 v95, v95, v23
    v_mul_f32 v96, v96, v23
    v_mul_f32 v97, v97, v23
    v_mul_f32 v98, v98, v23
    v_mul_f32 v99, v99, v23
    v_mul_f32 v100, v100, v23
    v_mul_f32 v101, v101, v23
    v_mul_f32 v102, v102, v23
    v_mul_f32 v103, v103, v23
    v_mul_f32 v104, v104, v23
    v_mul_f32 v105, v105, v23
    v_mul_f32 v106, v106, v23
    v_mul_f32 v107, v107, v23
    v_mul_f32 v108, v108, v23
    v_mul_f32 v109, v109, v23
    v_mul_f32 v110, v110, v23
    v_mul_f32 v111, v111, v23
    v_mul_f32 v112, v112, v23
    v_mul_f32 v113, v113, v23
    v_mul_f32 v114, v114, v23
    v_mul_f32 v115, v115, v23
    v_mul_f32 v116, v116, v23
    v_mul_f32 v117, v117, v23
    v_mul_f32 v118, v118, v23
    v_mul_f32 v119, v119, v23
    v_mul_f32 v120, v120, v23
    v_mul_f32 v121, v121, v23
    v_mul_f32 v122, v122, v23
    v_mul_f32 v123, v123, v23
    v_mul_f32 v124, v124, v23
    v_mul_f32 v125, v125, v23
    v_mul_f32 v126, v126, v23
    v_mul_f32 v127, v127, v23
    v_mul_f32 v128, v128, v23
    v_mul_f32 v129, v129, v23
    v_mul_f32 v130, v130, v23
    v_mul_f32 v131, v131, v23
    v_mul_f32 v132, v132, v23
    v_mul_f32 v133, v133, v23
    v_mul_f32 v134, v134, v23
    v_mul_f32 v135, v135, v23
    v_mul_f32 v20, v20, v23
    v_mul_f32 v21, v21, v23
    s_mov_b32 s46, s43
    s_branch L_fast0_r2
L_slow1_r1:
    ds_read_b128 v[216:219], v32 offset:0
    s_waitcnt lgkmcnt(3)
    v_mfma_f32_32x32x16_bf16 v[104:119], v[192:195], v[168:171], v[104:119]
    ds_read_b128 v[220:223], v33 offset:0
    ds_read_b128 v[224:227], v34 offset:0
    s_waitcnt lgkmcnt(3)
    v_mfma_f32_32x32x16_bf16 v[120:135], v[196:199], v[168:171], v[120:135]
    ds_read_b64_tr_b16 v[184:185], v28 offset:8192
    ds_read_b64_tr_b16 v[186:187], v28 offset:10240
    ds_read_b64_tr_b16 v[188:189], v29 offset:8192
    v_mfma_f32_32x32x16_bf16 v[72:87], v[200:203], v[172:175], v[72:87]
    ds_read_b64_tr_b16 v[190:191], v29 offset:10240
    ds_read_b64_tr_b16 v[192:193], v30 offset:8192
    ds_read_b64_tr_b16 v[194:195], v30 offset:10240
    v_mfma_f32_32x32x16_bf16 v[88:103], v[204:207], v[172:175], v[88:103]
    v_mfma_f32_32x32x16_bf16 v[104:119], v[208:211], v[172:175], v[104:119]
    ds_read_b64_tr_b16 v[196:197], v31 offset:8192
    ds_read_b64_tr_b16 v[198:199], v31 offset:10240
    v_mfma_f32_32x32x16_bf16 v[120:135], v[212:215], v[172:175], v[120:135]
    ds_read_b128 v[228:231], v35 offset:0
    ds_read_b128 v[232:235], v36 offset:0
    s_nop 15
    v_mov_b32 v23, 0
    v_mov_b32 v24, v22
    s_nop 1
    v_permlane32_swap_b32 v22, v24
    v_max_f32 v22, v22, v24
    v_max_f32 v22, v22, v23
    v_max_f32 v23, 0, v22
    v_sub_f32 v23, 0, v23
    v_exp_f32 v23, v23
    v_sub_f32 v152, v152, v22
    v_sub_f32 v153, v153, v22
    v_sub_f32 v154, v154, v22
    v_sub_f32 v155, v155, v22
    v_sub_f32 v156, v156, v22
    v_sub_f32 v157, v157, v22
    v_sub_f32 v158, v158, v22
    v_sub_f32 v159, v159, v22
    v_sub_f32 v160, v160, v22
    v_sub_f32 v161, v161, v22
    v_sub_f32 v162, v162, v22
    v_sub_f32 v163, v163, v22
    v_sub_f32 v164, v164, v22
    v_sub_f32 v165, v165, v22
    v_sub_f32 v166, v166, v22
    v_sub_f32 v167, v167, v22
    v_sub_f32 v240, v240, v22
    v_sub_f32 v241, v241, v22
    v_sub_f32 v242, v242, v22
    v_sub_f32 v243, v243, v22
    v_sub_f32 v244, v244, v22
    v_sub_f32 v245, v245, v22
    v_sub_f32 v246, v246, v22
    v_sub_f32 v247, v247, v22
    v_sub_f32 v248, v248, v22
    v_sub_f32 v249, v249, v22
    v_sub_f32 v250, v250, v22
    v_sub_f32 v251, v251, v22
    v_sub_f32 v252, v252, v22
    v_sub_f32 v253, v253, v22
    v_sub_f32 v254, v254, v22
    v_sub_f32 v255, v255, v22
    v_mul_f32 v72, v72, v23
    v_mul_f32 v73, v73, v23
    v_mul_f32 v74, v74, v23
    v_mul_f32 v75, v75, v23
    v_mul_f32 v76, v76, v23
    v_mul_f32 v77, v77, v23
    v_mul_f32 v78, v78, v23
    v_mul_f32 v79, v79, v23
    v_mul_f32 v80, v80, v23
    v_mul_f32 v81, v81, v23
    v_mul_f32 v82, v82, v23
    v_mul_f32 v83, v83, v23
    v_mul_f32 v84, v84, v23
    v_mul_f32 v85, v85, v23
    v_mul_f32 v86, v86, v23
    v_mul_f32 v87, v87, v23
    v_mul_f32 v88, v88, v23
    v_mul_f32 v89, v89, v23
    v_mul_f32 v90, v90, v23
    v_mul_f32 v91, v91, v23
    v_mul_f32 v92, v92, v23
    v_mul_f32 v93, v93, v23
    v_mul_f32 v94, v94, v23
    v_mul_f32 v95, v95, v23
    v_mul_f32 v96, v96, v23
    v_mul_f32 v97, v97, v23
    v_mul_f32 v98, v98, v23
    v_mul_f32 v99, v99, v23
    v_mul_f32 v100, v100, v23
    v_mul_f32 v101, v101, v23
    v_mul_f32 v102, v102, v23
    v_mul_f32 v103, v103, v23
    v_mul_f32 v104, v104, v23
    v_mul_f32 v105, v105, v23
    v_mul_f32 v106, v106, v23
    v_mul_f32 v107, v107, v23
    v_mul_f32 v108, v108, v23
    v_mul_f32 v109, v109, v23
    v_mul_f32 v110, v110, v23
    v_mul_f32 v111, v111, v23
    v_mul_f32 v112, v112, v23
    v_mul_f32 v113, v113, v23
    v_mul_f32 v114, v114, v23
    v_mul_f32 v115, v115, v23
    v_mul_f32 v116, v116, v23
    v_mul_f32 v117, v117, v23
    v_mul_f32 v118, v118, v23
    v_mul_f32 v119, v119, v23
    v_mul_f32 v120, v120, v23
    v_mul_f32 v121, v121, v23
    v_mul_f32 v122, v122, v23
    v_mul_f32 v123, v123, v23
    v_mul_f32 v124, v124, v23
    v_mul_f32 v125, v125, v23
    v_mul_f32 v126, v126, v23
    v_mul_f32 v127, v127, v23
    v_mul_f32 v128, v128, v23
    v_mul_f32 v129, v129, v23
    v_mul_f32 v130, v130, v23
    v_mul_f32 v131, v131, v23
    v_mul_f32 v132, v132, v23
    v_mul_f32 v133, v133, v23
    v_mul_f32 v134, v134, v23
    v_mul_f32 v135, v135, v23
    v_mul_f32 v20, v20, v23
    v_mul_f32 v21, v21, v23
    v_exp_f32 v152, v152
    v_exp_f32 v153, v153
    v_exp_f32 v154, v154
    v_exp_f32 v155, v155
    v_add_f32 v20, v20, v152
    v_add_f32 v21, v21, v153
    v_cvt_pk_bf16_f32 v176, v152, v153
    v_exp_f32 v156, v156
    v_exp_f32 v157, v157
    v_add_f32 v20, v20, v154
    v_add_f32 v21, v21, v155
    v_cvt_pk_bf16_f32 v177, v154, v155
    v_exp_f32 v158, v158
    v_exp_f32 v159, v159
    v_add_f32 v20, v20, v156
    v_add_f32 v21, v21, v157
    v_cvt_pk_bf16_f32 v178, v156, v157
    v_add_f32 v20, v20, v158
    v_add_f32 v21, v21, v159
    v_cvt_pk_bf16_f32 v179, v158, v159
    v_exp_f32 v160, v160
    v_exp_f32 v161, v161
    s_nop 1
    s_branch L_j8_r1
L_slow1_r2:
    ds_read_b128 v[216:219], v32 offset:0
    s_waitcnt lgkmcnt(3)
    v_mfma_f32_32x32x16_bf16 v[104:119], v[192:195], v[168:171], v[104:119]
    ds_read_b128 v[220:223], v33 offset:0
    ds_read_b128 v[224:227], v34 offset:0
    s_waitcnt lgkmcnt(3)
    v_mfma_f32_32x32x16_bf16 v[120:135], v[196:199], v[168:171], v[120:135]
    ds_read_b64_tr_b16 v[184:185], v28 offset:8192
    ds_read_b64_tr_b16 v[186:187], v28 offset:10240
    ds_read_b64_tr_b16 v[188:189], v29 offset:8192
    v_mfma_f32_32x32x16_bf16 v[72:87], v[200:203], v[172:175], v[72:87]
    ds_read_b64_tr_b16 v[190:191], v29 offset:10240
    ds_read_b64_tr_b16 v[192:193], v30 offset:8192
    ds_read_b64_tr_b16 v[194:195], v30 offset:10240
    v_mfma_f32_32x32x16_bf16 v[88:103], v[204:207], v[172:175], v[88:103]
    v_mfma_f32_32x32x16_bf16 v[104:119], v[208:211], v[172:175], v[104:119]
    ds_read_b64_tr_b16 v[196:197], v31 offset:8192
    ds_read_b64_tr_b16 v[198:199], v31 offset:10240
    v_mfma_f32_32x32x16_bf16 v[120:135], v[212:215], v[172:175], v[120:135]
    ds_read_b128 v[228:231], v35 offset:0
    ds_read_b128 v[232:235], v36 offset:0
    s_nop 15
    v_mov_b32 v23, 0
    v_mov_b32 v24, v22
    s_nop 1
    v_permlane32_swap_b32 v22, v24
    v_max_f32 v22, v22, v24
    v_max_f32 v22, v22, v23
    v_max_f32 v23, 0, v22
    v_sub_f32 v23, 0, v23
    v_exp_f32 v23, v23
    v_sub_f32 v152, v152, v22
    v_sub_f32 v153, v153, v22
    v_sub_f32 v154, v154, v22
    v_sub_f32 v155, v155, v22
    v_sub_f32 v156, v156, v22
    v_sub_f32 v157, v157, v22
    v_sub_f32 v158, v158, v22
    v_sub_f32 v159, v159, v22
    v_sub_f32 v160, v160, v22
    v_sub_f32 v161, v161, v22
    v_sub_f32 v162, v162, v22
    v_sub_f32 v163, v163, v22
    v_sub_f32 v164, v164, v22
    v_sub_f32 v165, v165, v22
    v_sub_f32 v166, v166, v22
    v_sub_f32 v167, v167, v22
    v_sub_f32 v240, v240, v22
    v_sub_f32 v241, v241, v22
    v_sub_f32 v242, v242, v22
    v_sub_f32 v243, v243, v22
    v_sub_f32 v244, v244, v22
    v_sub_f32 v245, v245, v22
    v_sub_f32 v246, v246, v22
    v_sub_f32 v247, v247, v22
    v_sub_f32 v248, v248, v22
    v_sub_f32 v249, v249, v22
    v_sub_f32 v250, v250, v22
    v_sub_f32 v251, v251, v22
    v_sub_f32 v252, v252, v22
    v_sub_f32 v253, v253, v22
    v_sub_f32 v254, v254, v22
    v_sub_f32 v255, v255, v22
    v_mul_f32 v72, v72, v23
    v_mul_f32 v73, v73, v23
    v_mul_f32 v74, v74, v23
    v_mul_f32 v75, v75, v23
    v_mul_f32 v76, v76, v23
    v_mul_f32 v77, v77, v23
    v_mul_f32 v78, v78, v23
    v_mul_f32 v79, v79, v23
    v_mul_f32 v80, v80, v23
    v_mul_f32 v81, v81, v23
    v_mul_f32 v82, v82, v23
    v_mul_f32 v83, v83, v23
    v_mul_f32 v84, v84, v23
    v_mul_f32 v85, v85, v23
    v_mul_f32 v86, v86, v23
    v_mul_f32 v87, v87, v23
    v_mul_f32 v88, v88, v23
    v_mul_f32 v89, v89, v23
    v_mul_f32 v90, v90, v23
    v_mul_f32 v91, v91, v23
    v_mul_f32 v92, v92, v23
    v_mul_f32 v93, v93, v23
    v_mul_f32 v94, v94, v23
    v_mul_f32 v95, v95, v23
    v_mul_f32 v96, v96, v23
    v_mul_f32 v97, v97, v23
    v_mul_f32 v98, v98, v23
    v_mul_f32 v99, v99, v23
    v_mul_f32 v100, v100, v23
    v_mul_f32 v101, v101, v23
    v_mul_f32 v102, v102, v23
    v_mul_f32 v103, v103, v23
    v_mul_f32 v104, v104, v23
    v_mul_f32 v105, v105, v23
    v_mul_f32 v106, v106, v23
    v_mul_f32 v107, v107, v23
    v_mul_f32 v108, v108, v23
    v_mul_f32 v109, v109, v23
    v_mul_f32 v110, v110, v23
    v_mul_f32 v111, v111, v23
    v_mul_f32 v112, v112, v23
    v_mul_f32 v113, v113, v23
    v_mul_f32 v114, v114, v23
    v_mul_f32 v115, v115, v23
    v_mul_f32 v116, v116, v23
    v_mul_f32 v117, v117, v23
    v_mul_f32 v118, v118, v23
    v_mul_f32 v119, v119, v23
    v_mul_f32 v120, v120, v23
    v_mul_f32 v121, v121, v23
    v_mul_f32 v122, v122, v23
    v_mul_f32 v123, v123, v23
    v_mul_f32 v124, v124, v23
    v_mul_f32 v125, v125, v23
    v_mul_f32 v126, v126, v23
    v_mul_f32 v127, v127, v23
    v_mul_f32 v128, v128, v23
    v_mul_f32 v129, v129, v23
    v_mul_f32 v130, v130, v23
    v_mul_f32 v131, v131, v23
    v_mul_f32 v132, v132, v23
    v_mul_f32 v133, v133, v23
    v_mul_f32 v134, v134, v23
    v_mul_f32 v135, v135, v23
    v_mul_f32 v20, v20, v23
    v_mul_f32 v21, v21, v23
    v_exp_f32 v152, v152
    v_exp_f32 v153, v153
    v_exp_f32 v154, v154
    v_exp_f32 v155, v155
    v_add_f32 v20, v20, v152
    v_add_f32 v21, v21, v153
    v_cvt_pk_bf16_f32 v176, v152, v153
    v_exp_f32 v156, v156
    v_exp_f32 v157, v157
    v_add_f32 v20, v20, v154
    v_add_f32 v21, v21, v155
    v_cvt_pk_bf16_f32 v177, v154, v155
    v_exp_f32 v158, v158
    v_exp_f32 v159, v159
    v_add_f32 v20, v20, v156
    v_add_f32 v21, v21, v157
    v_cvt_pk_bf16_f32 v178, v156, v157
    v_add_f32 v20, v20, v158
    v_add_f32 v21, v21, v159
    v_cvt_pk_bf16_f32 v179, v158, v159
    v_exp_f32 v160, v160
    v_exp_f32 v161, v161
    s_nop 1
    s_branch L_j8_r2
L_slowL_r1:
    v_mfma_f32_32x32x16_bf16 v[72:87], v[184:187], v[168:171], v[72:87]
    v_mfma_f32_32x32x16_bf16 v[88:103], v[188:191], v[168:171], v[88:103]
    v_mfma_f32_32x32x16_bf16 v[104:119], v[192:195], v[168:171], v[104:119]
    v_mfma_f32_32x32x16_bf16 v[120:135], v[196:199], v[168:171], v[120:135]
    ds_read_b64_tr_b16 v[184:185], v28 offset:8192
    ds_read_b64_tr_b16 v[186:187], v28 offset:10240
    ds_read_b64_tr_b16 v[188:189], v29 offset:8192
    ds_read_b64_tr_b16 v[190:191], v29 offset:10240
    ds_read_b64_tr_b16 v[192:193], v30 offset:8192
    ds_read_b64_tr_b16 v[194:195], v30 offset:10240
    ds_read_b64_tr_b16 v[196:197], v31 offset:8192
    ds_read_b64_tr_b16 v[198:199], v31 offset:10240
    v_mfma_f32_32x32x16_bf16 v[72:87], v[200:203], v[172:175], v[72:87]
    v_mfma_f32_32x32x16_bf16 v[88:103], v[204:207], v[172:175], v[88:103]
    v_mfma_f32_32x32x16_bf16 v[104:119], v[208:211], v[172:175], v[104:119]
    v_mfma_f32_32x32x16_bf16 v[120:135], v[212:215], v[172:175], v[120:135]
    ds_read_b64_tr_b16 v[200:201], v28 offset:12288
    ds_read_b64_tr_b16 v[202:203], v28 offset:14336
    ds_read_b64_tr_b16 v[204:205], v29 offset:12288
    ds_read_b64_tr_b16 v[206:207], v29 offset:14336
    ds_read_b64_tr_b16 v[208:209], v30 offset:12288
    ds_read_b64_tr_b16 v[210:211], v30 offset:14336
    ds_read_b64_tr_b16 v[212:213], v31 offset:12288
    ds_read_b64_tr_b16 v[214:215], v31 offset:14336
    s_nop 15
    v_mov_b32 v23, 0
    v_mov_b32 v24, v22
    s_nop 1
    v_permlane32_swap_b32 v22, v24
    v_max_f32 v22, v22, v24
    v_max_f32 v22, v22, v23
    v_max_f32 v23, 0, v22
    v_sub_f32 v23, 0, v23
    v_exp_f32 v23, v23
    v_sub_f32 v152, v152, v22
    v_sub_f32 v153, v153, v22
    v_sub_f32 v154, v154, v22
    v_sub_f32 v155, v155, v22
    v_sub_f32 v156, v156, v22
    v_sub_f32 v157, v157, v22
    v_sub_f32 v158, v158, v22
    v_sub_f32 v159, v159, v22
    v_sub_f32 v160, v160, v22
    v_sub_f32 v161, v161, v22
    v_sub_f32 v162, v162, v22
    v_sub_f32 v163, v163, v22
    v_sub_f32 v164, v164, v22
    v_sub_f32 v165, v165, v22
    v_sub_f32 v166, v166, v22
    v_sub_f32 v167, v167, v22
    v_sub_f32 v240, v240, v22
    v_sub_f32 v241, v241, v22
    v_sub_f32 v242, v242, v22
    v_sub_f32 v243, v243, v22
    v_sub_f32 v244, v244, v22
    v_sub_f32 v245, v245, v22
    v_sub_f32 v246, v246, v22
    v_sub_f32 v247, v247, v22
    v_sub_f32 v248, v248, v22
    v_sub_f32 v249, v249, v22
    v_sub_f32 v250, v250, v22
    v_sub_f32 v251, v251, v22
    v_sub_f32 v252, v252, v22
    v_sub_f32 v253, v253, v22
    v_sub_f32 v254, v254, v22
    v_sub_f32 v255, v255, v22
    v_mul_f32 v72, v72, v23
    v_mul_f32 v73, v73, v23
    v_mul_f32 v74, v74, v23
    v_mul_f32 v75, v75, v23
    v_mul_f32 v76, v76, v23
    v_mul_f32 v77, v77, v23
    v_mul_f32 v78, v78, v23
    v_mul_f32 v79, v79, v23
    v_mul_f32 v80, v80, v23
    v_mul_f32 v81, v81, v23
    v_mul_f32 v82, v82, v23
    v_mul_f32 v83, v83, v23
    v_mul_f32 v84, v84, v23
    v_mul_f32 v85, v85, v23
    v_mul_f32 v86, v86, v23
    v_mul_f32 v87, v87, v23
    v_mul_f32 v88, v88, v23
    v_mul_f32 v89, v89, v23
    v_mul_f32 v90, v90, v23
    v_mul_f32 v91, v91, v23
    v_mul_f32 v92, v92, v23
    v_mul_f32 v93, v93, v23
    v_mul_f32 v94, v94, v23
    v_mul_f32 v95, v95, v23
    v_mul_f32 v96, v96, v23
    v_mul_f32 v97, v97, v23
    v_mul_f32 v98, v98, v23
    v_mul_f32 v99, v99, v23
    v_mul_f32 v100, v100, v23
    v_mul_f32 v101, v101, v23
    v_mul_f32 v102, v102, v23
    v_mul_f32 v103, v103, v23
    v_mul_f32 v104, v104, v23
    v_mul_f32 v105, v105, v23
    v_mul_f32 v106, v106, v23
    v_mul_f32 v107, v107, v23
    v_mul_f32 v108, v108, v23
    v_mul_f32 v109, v109, v23
    v_mul_f32 v110, v110, v23
    v_mul_f32 v111, v111, v23
    v_mul_f32 v112, v112, v23
    v_mul_f32 v113, v113, v23
    v_mul_f32 v114, v114, v23
    v_mul_f32 v115, v115, v23
    v_mul_f32 v116, v116, v23
    v_mul_f32 v117, v117, v23
    v_mul_f32 v118, v118, v23
    v_mul_f32 v119, v119, v23
    v_mul_f32 v120, v120, v23
    v_mul_f32 v121, v121, v23
    v_mul_f32 v122, v122, v23
    v_mul_f32 v123, v123, v23
    v_mul_f32 v124, v124, v23
    v_mul_f32 v125, v125, v23
    v_mul_f32 v126, v126, v23
    v_mul_f32 v127, v127, v23
    v_mul_f32 v128, v128, v23
    v_mul_f32 v129, v129, v23
    v_mul_f32 v130, v130, v23
    v_mul_f32 v131, v131, v23
    v_mul_f32 v132, v132, v23
    v_mul_f32 v133, v133, v23
    v_mul_f32 v134, v134, v23
    v_mul_f32 v135, v135, v23
    v_mul_f32 v20, v20, v23
    v_mul_f32 v21, v21, v23
    v_exp_f32 v152, v152
    v_exp_f32 v153, v153
    v_exp_f32 v154, v154
    v_exp_f32 v155, v155
    v_add_f32 v20, v20, v152
    v_add_f32 v21, v21, v153
    v_cvt_pk_bf16_f32 v176, v152, v153
    v_exp_f32 v156, v156
    v_exp_f32 v157, v157
    v_add_f32 v20, v20, v154
    v_add_f32 v21, v21, v155
    v_cvt_pk_bf16_f32 v177, v154, v155
    v_exp_f32 v158, v158
    v_exp_f32 v159, v159
    v_add_f32 v20, v20, v156
    v_add_f32 v21, v21, v157
    v_cvt_pk_bf16_f32 v178, v156, v157
    v_add_f32 v20, v20, v158
    v_add_f32 v21, v21, v159
    v_cvt_pk_bf16_f32 v179, v158, v159
    v_exp_f32 v160, v160
    v_exp_f32 v161, v161
    v_exp_f32 v162, v162
    v_exp_f32 v163, v163
    v_add_f32 v20, v20, v160
    v_add_f32 v21, v21, v161
    v_cvt_pk_bf16_f32 v180, v160, v161
    v_exp_f32 v164, v164
    v_exp_f32 v165, v165
    v_add_f32 v20, v20, v162
    v_add_f32 v21, v21, v163
    v_cvt_pk_bf16_f32 v181, v162, v163
    v_exp_f32 v166, v166
    v_exp_f32 v167, v167
    v_add_f32 v20, v20, v164
    v_add_f32 v21, v21, v165
    v_cvt_pk_bf16_f32 v182, v164, v165
    v_add_f32 v20, v20, v166
    v_add_f32 v21, v21, v167
    v_cvt_pk_bf16_f32 v183, v166, v167
    s_branch L_joinL_r1
L_slowL_r2:
    v_mfma_f32_32x32x16_bf16 v[72:87], v[184:187], v[168:171], v[72:87]
    v_mfma_f32_32x32x16_bf16 v[88:103], v[188:191], v[168:171], v[88:103]
    v_mfma_f32_32x32x16_bf16 v[104:119], v[192:195], v[168:171], v[104:119]
    v_mfma_f32_32x32x16_bf16 v[120:135], v[196:199], v[168:171], v[120:135]
    ds_read_b64_tr_b16 v[184:185], v28 offset:8192
    ds_read_b64_tr_b16 v[186:187], v28 offset:10240
    ds_read_b64_tr_b16 v[188:189], v29 offset:8192
    ds_read_b64_tr_b16 v[190:191], v29 offset:10240
    ds_read_b64_tr_b16 v[192:193], v30 offset:8192
    ds_read_b64_tr_b16 v[194:195], v30 offset:10240
    ds_read_b64_tr_b16 v[196:197], v31 offset:8192
    ds_read_b64_tr_b16 v[198:199], v31 offset:10240
    v_mfma_f32_32x32x16_bf16 v[72:87], v[200:203], v[172:175], v[72:87]
    v_mfma_f32_32x32x16_bf16 v[88:103], v[204:207], v[172:175], v[88:103]
    v_mfma_f32_32x32x16_bf16 v[104:119], v[208:211], v[172:175], v[104:119]
    v_mfma_f32_32x32x16_bf16 v[120:135], v[212:215], v[172:175], v[120:135]
    ds_read_b64_tr_b16 v[200:201], v28 offset:12288
    ds_read_b64_tr_b16 v[202:203], v28 offset:14336
    ds_read_b64_tr_b16 v[204:205], v29 offset:12288
    ds_read_b64_tr_b16 v[206:207], v29 offset:14336
    ds_read_b64_tr_b16 v[208:209], v30 offset:12288
    ds_read_b64_tr_b16 v[210:211], v30 offset:14336
    ds_read_b64_tr_b16 v[212:213], v31 offset:12288
    ds_read_b64_tr_b16 v[214:215], v31 offset:14336
    s_nop 15
    v_mov_b32 v23, 0
    v_mov_b32 v24, v22
    s_nop 1
    v_permlane32_swap_b32 v22, v24
    v_max_f32 v22, v22, v24
    v_max_f32 v22, v22, v23
    v_max_f32 v23, 0, v22
    v_sub_f32 v23, 0, v23
    v_exp_f32 v23, v23
    v_sub_f32 v152, v152, v22
    v_sub_f32 v153, v153, v22
    v_sub_f32 v154, v154, v22
    v_sub_f32 v155, v155, v22
    v_sub_f32 v156, v156, v22
    v_sub_f32 v157, v157, v22
    v_sub_f32 v158, v158, v22
    v_sub_f32 v159, v159, v22
    v_sub_f32 v160, v160, v22
    v_sub_f32 v161, v161, v22
    v_sub_f32 v162, v162, v22
    v_sub_f32 v163, v163, v22
    v_sub_f32 v164, v164, v22
    v_sub_f32 v165, v165, v22
    v_sub_f32 v166, v166, v22
    v_sub_f32 v167, v167, v22
    v_sub_f32 v240, v240, v22
    v_sub_f32 v241, v241, v22
    v_sub_f32 v242, v242, v22
    v_sub_f32 v243, v243, v22
    v_sub_f32 v244, v244, v22
    v_sub_f32 v245, v245, v22
    v_sub_f32 v246, v246, v22
    v_sub_f32 v247, v247, v22
    v_sub_f32 v248, v248, v22
    v_sub_f32 v249, v249, v22
    v_sub_f32 v250, v250, v22
    v_sub_f32 v251, v251, v22
    v_sub_f32 v252, v252, v22
    v_sub_f32 v253, v253, v22
    v_sub_f32 v254, v254, v22
    v_sub_f32 v255, v255, v22
    v_mul_f32 v72, v72, v23
    v_mul_f32 v73, v73, v23
    v_mul_f32 v74, v74, v23
    v_mul_f32 v75, v75, v23
    v_mul_f32 v76, v76, v23
    v_mul_f32 v77, v77, v23
    v_mul_f32 v78, v78, v23
    v_mul_f32 v79, v79, v23
    v_mul_f32 v80, v80, v23
    v_mul_f32 v81, v81, v23
    v_mul_f32 v82, v82, v23
    v_mul_f32 v83, v83, v23
    v_mul_f32 v84, v84, v23
    v_mul_f32 v85, v85, v23
    v_mul_f32 v86, v86, v23
    v_mul_f32 v87, v87, v23
    v_mul_f32 v88, v88, v23
    v_mul_f32 v89, v89, v23
    v_mul_f32 v90, v90, v23
    v_mul_f32 v91, v91, v23
    v_mul_f32 v92, v92, v23
    v_mul_f32 v93, v93, v23
    v_mul_f32 v94, v94, v23
    v_mul_f32 v95, v95, v23
    v_mul_f32 v96, v96, v23
    v_mul_f32 v97, v97, v23
    v_mul_f32 v98, v98, v23
    v_mul_f32 v99, v99, v23
    v_mul_f32 v100, v100, v23
    v_mul_f32 v101, v101, v23
    v_mul_f32 v102, v102, v23
    v_mul_f32 v103, v103, v23
    v_mul_f32 v104, v104, v23
    v_mul_f32 v105, v105, v23
    v_mul_f32 v106, v106, v23
    v_mul_f32 v107, v107, v23
    v_mul_f32 v108, v108, v23
    v_mul_f32 v109, v109, v23
    v_mul_f32 v110, v110, v23
    v_mul_f32 v111, v111, v23
    v_mul_f32 v112, v112, v23
    v_mul_f32 v113, v113, v23
    v_mul_f32 v114, v114, v23
    v_mul_f32 v115, v115, v23
    v_mul_f32 v116, v116, v23
    v_mul_f32 v117, v117, v23
    v_mul_f32 v118, v118, v23
    v_mul_f32 v119, v119, v23
    v_mul_f32 v120, v120, v23
    v_mul_f32 v121, v121, v23
    v_mul_f32 v122, v122, v23
    v_mul_f32 v123, v123, v23
    v_mul_f32 v124, v124, v23
    v_mul_f32 v125, v125, v23
    v_mul_f32 v126, v126, v23
    v_mul_f32 v127, v127, v23
    v_mul_f32 v128, v128, v23
    v_mul_f32 v129, v129, v23
    v_mul_f32 v130, v130, v23
    v_mul_f32 v131, v131, v23
    v_mul_f32 v132, v132, v23
    v_mul_f32 v133, v133, v23
    v_mul_f32 v134, v134, v23
    v_mul_f32 v135, v135, v23
    v_mul_f32 v20, v20, v23
    v_mul_f32 v21, v21, v23
    v_exp_f32 v152, v152
    v_exp_f32 v153, v153
    v_exp_f32 v154, v154
    v_exp_f32 v155, v155
    v_add_f32 v20, v20, v152
    v_add_f32 v21, v21, v153
    v_cvt_pk_bf16_f32 v176, v152, v153
    v_exp_f32 v156, v156
    v_exp_f32 v157, v157
    v_add_f32 v20, v20, v154
    v_add_f32 v21, v21, v155
    v_cvt_pk_bf16_f32 v177, v154, v155
    v_exp_f32 v158, v158
    v_exp_f32 v159, v159
    v_add_f32 v20, v20, v156
    v_add_f32 v21, v21, v157
    v_cvt_pk_bf16_f32 v178, v156, v157
    v_add_f32 v20, v20, v158
    v_add_f32 v21, v21, v159
    v_cvt_pk_bf16_f32 v179, v158, v159
    v_exp_f32 v160, v160
    v_exp_f32 v161, v161
    v_exp_f32 v162, v162
    v_exp_f32 v163, v163
    v_add_f32 v20, v20, v160
    v_add_f32 v21, v21, v161
    v_cvt_pk_bf16_f32 v180, v160, v161
    v_exp_f32 v164, v164
    v_exp_f32 v165, v165
    v_add_f32 v20, v20, v162
    v_add_f32 v21, v21, v163
    v_cvt_pk_bf16_f32 v181, v162, v163
    v_exp_f32 v166, v166
    v_exp_f32 v167, v167
    v_add_f32 v20, v20, v164
    v_add_f32 v21, v21, v165
    v_cvt_pk_bf16_f32 v182, v164, v165
    v_add_f32 v20, v20, v166
    v_add_f32 v21, v21, v167
    v_cvt_pk_bf16_f32 v183, v166, v167
    s_branch L_joinL_r2
L_g1:

    v_and_b32 v32, 15, v1
    v_lshrrev_b32 v33, 4, v1
    v_and_b32 v34, 31, v1
    v_lshrrev_b32 v35, 5, v1

    v_lshlrev_b32 v37, 2, v33
    v_xor_b32 v37, v32, v37
    s_lshl_b32 s34, s5, 4
    v_add_u32 v38, s34, v33
    v_lshlrev_b32 v38, 13, v38
    v_lshl_add_u32 v7, v37, 4, v38
    v_lshrrev_b32 v38, 3, v1
    s_lshl_b32 s34, s5, 5
    v_add_u32 v38, s34, v38
    v_mul_u32_u24 v38, 1280, v38
    v_and_b32 v39, 7, v1
    v_xor_b32 v37, v39, v33
    v_lshl_add_u32 v16, v37, 4, v38
    v_xor_b32 v37, 4, v37
    v_lshl_add_u32 v17, v37, 4, v38

    s_add_u32 s34, s29, 0
    s_add_u32 m0, s38, 131072
    s_nop 0
    buffer_load_dwordx4 v16, s[16:19], s34 offen offset:0 lds
    s_add_u32 s34, s34, 9216
    buffer_load_dwordx4 v17, s[16:19], s34 offen offset:1024 lds
    s_add_u32 s34, s34, 9216
    buffer_load_dwordx4 v16, s[16:19], s34 offen offset:2048 lds
    s_add_u32 s34, s34, 9216
    buffer_load_dwordx4 v17, s[16:19], s34 offen offset:3072 lds
    s_add_u32 s35, s30, 0
    s_add_u32 m0, s38, 147456
    s_nop 0
    buffer_load_dwordx4 v7, s[20:23], s35 offen offset:0 lds
    s_add_u32 s35, s35, 31744
    buffer_load_dwordx4 v7, s[20:23], s35 offen offset:1024 lds
    s_add_u32 s35, s35, 31744
    buffer_load_dwordx4 v7, s[20:23], s35 offen offset:2048 lds
    s_add_u32 s35, s35, 31744
    buffer_load_dwordx4 v7, s[20:23], s35 offen offset:3072 lds

    v_lshlrev_b32 v36, 8, v33
    v_add_u32 v36, s38, v36

    v_add_u32 v37, 0, v33
    v_xor_b32 v37, v32, v37
    v_lshl_add_u32 v2, v37, 4, v36

    v_add_u32 v37, 4, v33
    v_xor_b32 v37, v32, v37
    v_lshl_add_u32 v3, v37, 4, v36

    v_add_u32 v37, 8, v33
    v_xor_b32 v37, v32, v37
    v_lshl_add_u32 v4, v37, 4, v36

    v_add_u32 v37, 12, v33
    v_xor_b32 v37, v32, v37
    v_lshl_add_u32 v5, v37, 4, v36

    v_lshlrev_b32 v37, 2, v33
    v_xor_b32 v37, v32, v37
    v_lshl_add_u32 v6, v37, 4, v36

    s_add_u32 s34, s29, 128
    s_add_u32 m0, s38, 32768
    s_nop 0
    buffer_load_dwordx4 v16, s[16:19], s34 offen offset:0 lds
    s_add_u32 s34, s34, 9216
    buffer_load_dwordx4 v17, s[16:19], s34 offen offset:1024 lds
    s_add_u32 s34, s34, 9216
    buffer_load_dwordx4 v16, s[16:19], s34 offen offset:2048 lds
    s_add_u32 s34, s34, 9216
    buffer_load_dwordx4 v17, s[16:19], s34 offen offset:3072 lds
    s_add_u32 s35, s30, 524288
    s_add_u32 m0, s38, 81920
    s_nop 0
    buffer_load_dwordx4 v7, s[20:23], s35 offen offset:0 lds
    s_add_u32 s35, s35, 31744
    buffer_load_dwordx4 v7, s[20:23], s35 offen offset:1024 lds
    s_add_u32 s35, s35, 31744
    buffer_load_dwordx4 v7, s[20:23], s35 offen offset:2048 lds
    s_add_u32 s35, s35, 31744
    buffer_load_dwordx4 v7, s[20:23], s35 offen offset:3072 lds
    s_add_u32 s34, s29, 256
    s_add_u32 m0, s38, 98304
    s_nop 0
    buffer_load_dwordx4 v16, s[16:19], s34 offen offset:0 lds
    s_add_u32 s34, s34, 9216
    buffer_load_dwordx4 v17, s[16:19], s34 offen offset:1024 lds
    s_add_u32 s34, s34, 9216
    buffer_load_dwordx4 v16, s[16:19], s34 offen offset:2048 lds
    s_add_u32 s34, s34, 9216
    buffer_load_dwordx4 v17, s[16:19], s34 offen offset:3072 lds
    s_add_u32 s35, s30, 1048576
    s_add_u32 m0, s38, 114688
    s_nop 0
    buffer_load_dwordx4 v7, s[20:23], s35 offen offset:0 lds
    s_add_u32 s35, s35, 31744
    buffer_load_dwordx4 v7, s[20:23], s35 offen offset:1024 lds
    s_add_u32 s35, s35, 31744
    buffer_load_dwordx4 v7, s[20:23], s35 offen offset:2048 lds
    s_add_u32 s35, s35, 31744
    buffer_load_dwordx4 v7, s[20:23], s35 offen offset:3072 lds

    v_lshrrev_b32 v36, 2, v32
    v_and_b32 v37, 3, v32
    v_and_b32 v38, 1, v33
    v_lshlrev_b32 v38, 5, v38
    v_and_b32 v31, 1, v37
    v_lshlrev_b32 v31, 1, v31
    v_lshrrev_b32 v37, 1, v37
    v_or_b32 v37, v37, v31
    v_lshl_add_u32 v38, v37, 3, v38
    v_lshl_add_u32 v30, v35, 3, v36
    v_lshl_add_u32 v38, v30, 8, v38

    v_xor_b32 v37, 0, v36
    v_lshl_add_u32 v8, v37, 6, v38

    v_xor_b32 v37, 1, v36
    v_lshl_add_u32 v9, v37, 6, v38

    v_xor_b32 v37, 2, v36
    v_lshl_add_u32 v10, v37, 6, v38

    v_xor_b32 v37, 3, v36
    v_lshl_add_u32 v11, v37, 6, v38

    v_lshrrev_b32 v36, 1, v34
    v_and_b32 v36, 7, v36
    v_xor_b32 v36, v35, v36
    v_lshlrev_b32 v36, 4, v36
    v_lshl_add_u32 v36, v34, 7, v36
    v_add_u32 v18, s38, v36

    s_add_u32 m0, s38, 0
    s_add_u32 s34, s28, 0
    buffer_load_dwordx4 v2, s[8:11], s34 offen offset:0 nt lds
    buffer_load_dwordx4 v3, s[8:11], s34 offen offset:1024 nt lds
    buffer_load_dwordx4 v4, s[8:11], s34 offen offset:2048 nt lds
    buffer_load_dwordx4 v5, s[8:11], s34 offen offset:3072 nt lds
    s_add_u32 m0, s38, 49152
    s_add_u32 s34, s28, 0
    buffer_load_dwordx4 v6, s[12:15], s34 offen offset:0 nt lds
    buffer_load_dwordx4 v6, s[12:15], s34 offen offset:1024 nt lds
    buffer_load_dwordx4 v6, s[12:15], s34 offen offset:2048 nt lds
    buffer_load_dwordx4 v6, s[12:15], s34 offen offset:3072 nt lds
    s_add_u32 m0, s38, 16384
    s_add_u32 s34, s28, 16384
    buffer_load_dwordx4 v2, s[8:11], s34 offen offset:0 nt lds
    buffer_load_dwordx4 v3, s[8:11], s34 offen offset:1024 nt lds
    buffer_load_dwordx4 v4, s[8:11], s34 offen offset:2048 nt lds
    buffer_load_dwordx4 v5, s[8:11], s34 offen offset:3072 nt lds
    s_add_u32 m0, s38, 65536
    s_add_u32 s34, s28, 16384
    buffer_load_dwordx4 v6, s[12:15], s34 offen offset:0 nt lds
    buffer_load_dwordx4 v6, s[12:15], s34 offen offset:1024 nt lds
    buffer_load_dwordx4 v6, s[12:15], s34 offen offset:2048 nt lds
    buffer_load_dwordx4 v6, s[12:15], s34 offen offset:3072 nt lds
    v_mov_b64 v[192:193], 0
    v_mov_b64 v[194:195], 0
    v_mov_b64 v[196:197], 0
    v_mov_b64 v[198:199], 0
    v_mov_b64 v[200:201], 0
    v_mov_b64 v[202:203], 0
    v_mov_b64 v[204:205], 0
    v_mov_b64 v[206:207], 0
    v_mov_b64 v[208:209], 0
    v_mov_b64 v[210:211], 0
    v_mov_b64 v[212:213], 0
    v_mov_b64 v[214:215], 0
    v_mov_b64 v[216:217], 0
    v_mov_b64 v[218:219], 0
    v_mov_b64 v[220:221], 0
    v_mov_b64 v[222:223], 0
    v_mov_b64 v[224:225], 0
    v_mov_b64 v[226:227], 0
    v_mov_b64 v[228:229], 0
    v_mov_b64 v[230:231], 0
    v_mov_b64 v[232:233], 0
    v_mov_b64 v[234:235], 0
    v_mov_b64 v[236:237], 0
    v_mov_b64 v[238:239], 0
    v_mov_b64 v[240:241], 0
    v_mov_b64 v[242:243], 0
    v_mov_b64 v[244:245], 0
    v_mov_b64 v[246:247], 0
    v_mov_b64 v[248:249], 0
    v_mov_b64 v[250:251], 0
    v_mov_b64 v[252:253], 0
    v_mov_b64 v[254:255], 0
    s_waitcnt vmcnt(32)
    s_waitcnt lgkmcnt(0)
    s_barrier
    v_add_u32 v20, 131072, v18
    v_xor_b32 v21, 32, v20
    v_xor_b32 v22, 64, v20
    v_xor_b32 v23, 96, v20
    ds_read_b128 v[32:35], v20
    ds_read_b128 v[36:39], v21
    ds_read_b128 v[40:43], v22
    ds_read_b128 v[44:47], v23
    s_waitcnt vmcnt(24)
    s_waitcnt lgkmcnt(0)
    s_barrier
    s_add_u32 s34, s29, 384
    s_add_u32 m0, s38, 131072
    s_nop 0
    buffer_load_dwordx4 v16, s[16:19], s34 offen offset:0 lds
    s_add_u32 s34, s34, 9216
    buffer_load_dwordx4 v17, s[16:19], s34 offen offset:1024 lds
    s_add_u32 s34, s34, 9216
    buffer_load_dwordx4 v16, s[16:19], s34 offen offset:2048 lds
    s_add_u32 s34, s34, 9216
    buffer_load_dwordx4 v17, s[16:19], s34 offen offset:3072 lds
    s_add_u32 s35, s30, 1572864
    s_add_u32 m0, s38, 147456
    s_nop 0
    buffer_load_dwordx4 v7, s[20:23], s35 offen offset:0 lds
    s_add_u32 s35, s35, 31744
    buffer_load_dwordx4 v7, s[20:23], s35 offen offset:1024 lds
    s_add_u32 s35, s35, 31744
    buffer_load_dwordx4 v7, s[20:23], s35 offen offset:2048 lds
    s_add_u32 s35, s35, 31744
    buffer_load_dwordx4 v7, s[20:23], s35 offen offset:3072 lds
    v_add_u32 v20, 32768, v18
    v_xor_b32 v21, 32, v20
    v_xor_b32 v22, 64, v20
    v_xor_b32 v23, 96, v20
    ds_read_b128 v[48:51], v20
    ds_read_b128 v[52:55], v21
    ds_read_b128 v[56:59], v22
    ds_read_b128 v[60:63], v23
    s_waitcnt vmcnt(24)
    s_waitcnt lgkmcnt(0)
    s_barrier
    s_add_u32 s34, s29, 512
    s_add_u32 m0, s38, 32768
    s_nop 0
    buffer_load_dwordx4 v16, s[16:19], s34 offen offset:0 lds
    s_add_u32 s34, s34, 9216
    buffer_load_dwordx4 v17, s[16:19], s34 offen offset:1024 lds
    s_add_u32 s34, s34, 9216
    buffer_load_dwordx4 v16, s[16:19], s34 offen offset:2048 lds
    s_add_u32 s34, s34, 9216
    buffer_load_dwordx4 v17, s[16:19], s34 offen offset:3072 lds
    s_add_u32 s35, s30, 2097152
    s_add_u32 m0, s38, 81920
    s_nop 0
    buffer_load_dwordx4 v7, s[20:23], s35 offen offset:0 lds
    s_add_u32 s35, s35, 31744
    buffer_load_dwordx4 v7, s[20:23], s35 offen offset:1024 lds
    s_add_u32 s35, s35, 31744
    buffer_load_dwordx4 v7, s[20:23], s35 offen offset:2048 lds
    s_add_u32 s35, s35, 31744
    buffer_load_dwordx4 v7, s[20:23], s35 offen offset:3072 lds
    v_add_u32 v20, 98304, v18
    v_xor_b32 v21, 32, v20
    v_xor_b32 v22, 64, v20
    v_xor_b32 v23, 96, v20
    ds_read_b128 v[64:67], v20
    ds_read_b128 v[68:71], v21
    ds_read_b128 v[72:75], v22
    ds_read_b128 v[76:79], v23
    s_waitcnt vmcnt(8)
    s_waitcnt lgkmcnt(0)
    s_barrier
    s_add_u32 s34, s29, 640
    s_add_u32 m0, s38, 98304
    s_nop 0
    buffer_load_dwordx4 v16, s[16:19], s34 offen offset:0 lds
    s_add_u32 s34, s34, 9216
    buffer_load_dwordx4 v17, s[16:19], s34 offen offset:1024 lds
    s_add_u32 s34, s34, 9216
    buffer_load_dwordx4 v16, s[16:19], s34 offen offset:2048 lds
    s_add_u32 s34, s34, 9216
    buffer_load_dwordx4 v17, s[16:19], s34 offen offset:3072 lds
    s_add_u32 s35, s30, 2621440
    s_add_u32 m0, s38, 114688
    s_nop 0
    buffer_load_dwordx4 v7, s[20:23], s35 offen offset:0 lds
    s_add_u32 s35, s35, 31744
    buffer_load_dwordx4 v7, s[20:23], s35 offen offset:1024 lds
    s_add_u32 s35, s35, 31744
    buffer_load_dwordx4 v7, s[20:23], s35 offen offset:2048 lds
    s_add_u32 s35, s35, 31744
    buffer_load_dwordx4 v7, s[20:23], s35 offen offset:3072 lds
    v_add_u32 v20, 131072, v18
    v_xor_b32 v21, 32, v20
    v_xor_b32 v22, 64, v20
    v_xor_b32 v23, 96, v20
    ds_read_b128 v[80:83], v20
    ds_read_b128 v[84:87], v21
    ds_read_b128 v[88:91], v22
    ds_read_b128 v[92:95], v23
    s_waitcnt vmcnt(8)
    s_waitcnt lgkmcnt(0)
    s_barrier
    s_add_u32 s34, s29, 768
    s_add_u32 m0, s38, 131072
    s_nop 0
    buffer_load_dwordx4 v16, s[16:19], s34 offen offset:0 lds
    s_add_u32 s34, s34, 9216
    buffer_load_dwordx4 v17, s[16:19], s34 offen offset:1024 lds
    s_add_u32 s34, s34, 9216
    buffer_load_dwordx4 v16, s[16:19], s34 offen offset:2048 lds
    s_add_u32 s34, s34, 9216
    buffer_load_dwordx4 v17, s[16:19], s34 offen offset:3072 lds
    s_add_u32 s35, s30, 3145728
    s_add_u32 m0, s38, 147456
    s_nop 0
    buffer_load_dwordx4 v7, s[20:23], s35 offen offset:0 lds
    s_add_u32 s35, s35, 31744
    buffer_load_dwordx4 v7, s[20:23], s35 offen offset:1024 lds
    s_add_u32 s35, s35, 31744
    buffer_load_dwordx4 v7, s[20:23], s35 offen offset:2048 lds
    s_add_u32 s35, s35, 31744
    buffer_load_dwordx4 v7, s[20:23], s35 offen offset:3072 lds
    v_add_u32 v20, 32768, v18
    v_xor_b32 v21, 32, v20
    v_xor_b32 v22, 64, v20
    v_xor_b32 v23, 96, v20
    ds_read_b128 v[96:99], v20
    ds_read_b128 v[100:103], v21
    ds_read_b128 v[104:107], v22
    ds_read_b128 v[108:111], v23
    s_waitcnt vmcnt(8)
    s_waitcnt lgkmcnt(0)
    s_barrier
    s_add_u32 s34, s29, 896
    s_add_u32 m0, s38, 32768
    s_nop 0
    buffer_load_dwordx4 v16, s[16:19], s34 offen offset:0 lds
    s_add_u32 s34, s34, 9216
    buffer_load_dwordx4 v17, s[16:19], s34 offen offset:1024 lds
    s_add_u32 s34, s34, 9216
    buffer_load_dwordx4 v16, s[16:19], s34 offen offset:2048 lds
    s_add_u32 s34, s34, 9216
    buffer_load_dwordx4 v17, s[16:19], s34 offen offset:3072 lds
    s_add_u32 s35, s30, 3670016
    s_add_u32 m0, s38, 81920
    s_nop 0
    buffer_load_dwordx4 v7, s[20:23], s35 offen offset:0 lds
    s_add_u32 s35, s35, 31744
    buffer_load_dwordx4 v7, s[20:23], s35 offen offset:1024 lds
    s_add_u32 s35, s35, 31744
    buffer_load_dwordx4 v7, s[20:23], s35 offen offset:2048 lds
    s_add_u32 s35, s35, 31744
    buffer_load_dwordx4 v7, s[20:23], s35 offen offset:3072 lds
    v_add_u32 v20, 98304, v18
    v_xor_b32 v21, 32, v20
    v_xor_b32 v22, 64, v20
    v_xor_b32 v23, 96, v20
    ds_read_b128 v[112:115], v20
    ds_read_b128 v[116:119], v21
    ds_read_b128 v[120:123], v22
    ds_read_b128 v[124:127], v23
    s_waitcnt vmcnt(8)
    s_waitcnt lgkmcnt(0)
    s_barrier
    s_add_u32 s34, s29, 1024
    s_add_u32 m0, s38, 98304
    s_nop 0
    buffer_load_dwordx4 v16, s[16:19], s34 offen offset:0 lds
    s_add_u32 s34, s34, 9216
    buffer_load_dwordx4 v17, s[16:19], s34 offen offset:1024 lds
    s_add_u32 s34, s34, 9216
    buffer_load_dwordx4 v16, s[16:19], s34 offen offset:2048 lds
    s_add_u32 s34, s34, 9216
    buffer_load_dwordx4 v17, s[16:19], s34 offen offset:3072 lds
    s_add_u32 s35, s30, 4194304
    s_add_u32 m0, s38, 114688
    s_nop 0
    buffer_load_dwordx4 v7, s[20:23], s35 offen offset:0 lds
    s_add_u32 s35, s35, 31744
    buffer_load_dwordx4 v7, s[20:23], s35 offen offset:1024 lds
    s_add_u32 s35, s35, 31744
    buffer_load_dwordx4 v7, s[20:23], s35 offen offset:2048 lds
    s_add_u32 s35, s35, 31744
    buffer_load_dwordx4 v7, s[20:23], s35 offen offset:3072 lds
    v_add_u32 v20, 131072, v18
    v_xor_b32 v21, 32, v20
    v_xor_b32 v22, 64, v20
    v_xor_b32 v23, 96, v20
    ds_read_b128 v[128:131], v20
    ds_read_b128 v[132:135], v21
    ds_read_b128 v[136:139], v22
    ds_read_b128 v[140:143], v23
    s_waitcnt vmcnt(8)
    s_waitcnt lgkmcnt(0)
    s_barrier
    s_add_u32 s34, s29, 1152
    s_add_u32 m0, s38, 131072
    s_nop 0
    buffer_load_dwordx4 v16, s[16:19], s34 offen offset:0 lds
    s_add_u32 s34, s34, 9216
    buffer_load_dwordx4 v17, s[16:19], s34 offen offset:1024 lds
    s_add_u32 s34, s34, 9216
    buffer_load_dwordx4 v16, s[16:19], s34 offen offset:2048 lds
    s_add_u32 s34, s34, 9216
    buffer_load_dwordx4 v17, s[16:19], s34 offen offset:3072 lds
    s_add_u32 s35, s30, 4718592
    s_add_u32 m0, s38, 147456
    s_nop 0
    buffer_load_dwordx4 v7, s[20:23], s35 offen offset:0 lds
    s_add_u32 s35, s35, 31744
    buffer_load_dwordx4 v7, s[20:23], s35 offen offset:1024 lds
    s_add_u32 s35, s35, 31744
    buffer_load_dwordx4 v7, s[20:23], s35 offen offset:2048 lds
    s_add_u32 s35, s35, 31744
    buffer_load_dwordx4 v7, s[20:23], s35 offen offset:3072 lds
    v_add_u32 v20, 32768, v18
    v_xor_b32 v21, 32, v20
    v_xor_b32 v22, 64, v20
    v_xor_b32 v23, 96, v20
    ds_read_b128 v[144:147], v20
    ds_read_b128 v[148:151], v21
    ds_read_b128 v[152:155], v22
    ds_read_b128 v[156:159], v23
    s_waitcnt vmcnt(8)
    s_waitcnt lgkmcnt(0)
    s_barrier
    s_add_u32 m0, s38, 32768
    s_add_u32 s34, s28, 32768
    buffer_load_dwordx4 v2, s[8:11], s34 offen offset:0 nt lds
    buffer_load_dwordx4 v3, s[8:11], s34 offen offset:1024 nt lds
    buffer_load_dwordx4 v4, s[8:11], s34 offen offset:2048 nt lds
    buffer_load_dwordx4 v5, s[8:11], s34 offen offset:3072 nt lds
    s_add_u32 m0, s38, 81920
    s_add_u32 s34, s28, 32768
    buffer_load_dwordx4 v6, s[12:15], s34 offen offset:0 nt lds
    buffer_load_dwordx4 v6, s[12:15], s34 offen offset:1024 nt lds
    buffer_load_dwordx4 v6, s[12:15], s34 offen offset:2048 nt lds
    buffer_load_dwordx4 v6, s[12:15], s34 offen offset:3072 nt lds
    v_add_u32 v20, 98304, v18
    v_xor_b32 v21, 32, v20
    v_xor_b32 v22, 64, v20
    v_xor_b32 v23, 96, v20
    ds_read_b128 v[160:163], v20
    ds_read_b128 v[164:167], v21
    ds_read_b128 v[168:171], v22
    ds_read_b128 v[172:175], v23
    s_waitcnt vmcnt(8)
    s_waitcnt lgkmcnt(0)
    s_barrier
    s_add_u32 s35, s30, 4096
    s_add_u32 m0, s38, 114688
    s_nop 0
    buffer_load_dwordx4 v7, s[20:23], s35 offen offset:0 lds
    s_add_u32 s35, s35, 31744
    buffer_load_dwordx4 v7, s[20:23], s35 offen offset:1024 lds
    s_add_u32 s35, s35, 31744
    buffer_load_dwordx4 v7, s[20:23], s35 offen offset:2048 lds
    s_add_u32 s35, s35, 31744
    buffer_load_dwordx4 v7, s[20:23], s35 offen offset:3072 lds
    v_add_u32 v20, 131072, v18
    v_xor_b32 v21, 32, v20
    v_xor_b32 v22, 64, v20
    v_xor_b32 v23, 96, v20
    ds_read_b128 v[176:179], v20
    ds_read_b128 v[180:183], v21
    ds_read_b128 v[184:187], v22
    ds_read_b128 v[188:191], v23
    s_waitcnt vmcnt(63)
    s_waitcnt lgkmcnt(0)
    s_barrier
    s_add_u32 s35, s30, 528384
    s_add_u32 m0, s38, 131072
    s_nop 0
    buffer_load_dwordx4 v7, s[20:23], s35 offen offset:0 lds
    s_add_u32 s35, s35, 31744
    buffer_load_dwordx4 v7, s[20:23], s35 offen offset:1024 lds
    s_add_u32 s35, s35, 31744
    buffer_load_dwordx4 v7, s[20:23], s35 offen offset:2048 lds
    s_add_u32 s35, s35, 31744
    buffer_load_dwordx4 v7, s[20:23], s35 offen offset:3072 lds
    s_add_u32 s35, s30, 1052672
    s_add_u32 m0, s38, 147456
    s_nop 0
    buffer_load_dwordx4 v7, s[20:23], s35 offen offset:0 lds
    s_add_u32 s35, s35, 31744
    buffer_load_dwordx4 v7, s[20:23], s35 offen offset:1024 lds
    s_add_u32 s35, s35, 31744
    buffer_load_dwordx4 v7, s[20:23], s35 offen offset:2048 lds
    s_add_u32 s35, s35, 31744
    buffer_load_dwordx4 v7, s[20:23], s35 offen offset:3072 lds
    s_waitcnt vmcnt(63)
    s_barrier
    s_add_u32 m0, s38, 0
    s_add_u32 s34, s28, 49152
    buffer_load_dwordx4 v2, s[8:11], s34 offen offset:0 nt lds
    buffer_load_dwordx4 v3, s[8:11], s34 offen offset:1024 nt lds
    buffer_load_dwordx4 v4, s[8:11], s34 offen offset:2048 nt lds
    buffer_load_dwordx4 v5, s[8:11], s34 offen offset:3072 nt lds
    s_add_u32 m0, s38, 98304
    s_add_u32 s34, s28, 49152
    buffer_load_dwordx4 v6, s[12:15], s34 offen offset:0 nt lds
    buffer_load_dwordx4 v6, s[12:15], s34 offen offset:1024 nt lds
    buffer_load_dwordx4 v6, s[12:15], s34 offen offset:2048 nt lds
    buffer_load_dwordx4 v6, s[12:15], s34 offen offset:3072 nt lds
    s_waitcnt vmcnt(16)
    s_barrier
    s_add_u32 m0, s38, 16384
    s_add_u32 s34, s28, 65536
    buffer_load_dwordx4 v2, s[8:11], s34 offen offset:0 nt lds
    buffer_load_dwordx4 v3, s[8:11], s34 offen offset:1024 nt lds
    buffer_load_dwordx4 v4, s[8:11], s34 offen offset:2048 nt lds
    buffer_load_dwordx4 v5, s[8:11], s34 offen offset:3072 nt lds
    s_add_u32 m0, s38, 49152
    s_add_u32 s34, s28, 65536
    buffer_load_dwordx4 v6, s[12:15], s34 offen offset:0 nt lds
    buffer_load_dwordx4 v6, s[12:15], s34 offen offset:1024 nt lds
    buffer_load_dwordx4 v6, s[12:15], s34 offen offset:2048 nt lds
    buffer_load_dwordx4 v6, s[12:15], s34 offen offset:3072 nt lds
    v_add_u32 v12, 114688, v8
    v_add_u32 v13, 114688, v9
    v_add_u32 v14, 114688, v10
    v_add_u32 v15, 114688, v11
    ds_read_b64_tr_b16 v[16:17], v12 offset:0
    ds_read_b64_tr_b16 v[18:19], v12 offset:1024
    ds_read_b64_tr_b16 v[20:21], v13 offset:0
    ds_read_b64_tr_b16 v[22:23], v13 offset:1024
    ds_read_b64_tr_b16 v[24:25], v14 offset:0
    ds_read_b64_tr_b16 v[26:27], v14 offset:1024
    ds_read_b64_tr_b16 v[28:29], v15 offset:0
    ds_read_b64_tr_b16 v[30:31], v15 offset:1024
    s_waitcnt lgkmcnt(6)
    v_mfma_f32_32x32x16_bf16 v[192:207], v[16:19], v[32:35], v[192:207]
    ds_read_b64_tr_b16 v[16:17], v12 offset:4096
    ds_read_b64_tr_b16 v[18:19], v12 offset:5120
    s_waitcnt lgkmcnt(6)
    v_mfma_f32_32x32x16_bf16 v[208:223], v[20:23], v[32:35], v[208:223]
    ds_read_b64_tr_b16 v[20:21], v13 offset:4096
    ds_read_b64_tr_b16 v[22:23], v13 offset:5120
    s_waitcnt lgkmcnt(6)
    v_mfma_f32_32x32x16_bf16 v[224:239], v[24:27], v[32:35], v[224:239]
    ds_read_b64_tr_b16 v[24:25], v14 offset:4096
    ds_read_b64_tr_b16 v[26:27], v14 offset:5120
    s_waitcnt lgkmcnt(6)
    v_mfma_f32_32x32x16_bf16 v[240:255], v[28:31], v[32:35], v[240:255]
    ds_read_b64_tr_b16 v[28:29], v15 offset:4096
    ds_read_b64_tr_b16 v[30:31], v15 offset:5120
    s_waitcnt lgkmcnt(6)
    v_mfma_f32_32x32x16_bf16 v[192:207], v[16:19], v[36:39], v[192:207]
    ds_read_b64_tr_b16 v[16:17], v12 offset:8192
    ds_read_b64_tr_b16 v[18:19], v12 offset:9216
    s_waitcnt lgkmcnt(6)
    v_mfma_f32_32x32x16_bf16 v[208:223], v[20:23], v[36:39], v[208:223]
    ds_read_b64_tr_b16 v[20:21], v13 offset:8192
    ds_read_b64_tr_b16 v[22:23], v13 offset:9216
    s_waitcnt lgkmcnt(6)
    v_mfma_f32_32x32x16_bf16 v[224:239], v[24:27], v[36:39], v[224:239]
    ds_read_b64_tr_b16 v[24:25], v14 offset:8192
    ds_read_b64_tr_b16 v[26:27], v14 offset:9216
    s_waitcnt lgkmcnt(6)
    v_mfma_f32_32x32x16_bf16 v[240:255], v[28:31], v[36:39], v[240:255]
    ds_read_b64_tr_b16 v[28:29], v15 offset:8192
    ds_read_b64_tr_b16 v[30:31], v15 offset:9216
    s_waitcnt lgkmcnt(6)
    v_mfma_f32_32x32x16_bf16 v[192:207], v[16:19], v[40:43], v[192:207]
    ds_read_b64_tr_b16 v[16:17], v12 offset:12288
    ds_read_b64_tr_b16 v[18:19], v12 offset:13312
    s_waitcnt lgkmcnt(6)
    v_mfma_f32_32x32x16_bf16 v[208:223], v[20:23], v[40:43], v[208:223]
    ds_read_b64_tr_b16 v[20:21], v13 offset:12288
    ds_read_b64_tr_b16 v[22:23], v13 offset:13312
    s_waitcnt lgkmcnt(6)
    v_mfma_f32_32x32x16_bf16 v[224:239], v[24:27], v[40:43], v[224:239]
    ds_read_b64_tr_b16 v[24:25], v14 offset:12288
    ds_read_b64_tr_b16 v[26:27], v14 offset:13312
    s_waitcnt lgkmcnt(6)
    v_mfma_f32_32x32x16_bf16 v[240:255], v[28:31], v[40:43], v[240:255]
    ds_read_b64_tr_b16 v[28:29], v15 offset:12288
    ds_read_b64_tr_b16 v[30:31], v15 offset:13312
    s_waitcnt lgkmcnt(6)
    v_mfma_f32_32x32x16_bf16 v[192:207], v[16:19], v[44:47], v[192:207]
    s_waitcnt lgkmcnt(4)
    v_mfma_f32_32x32x16_bf16 v[208:223], v[20:23], v[44:47], v[208:223]
    s_waitcnt lgkmcnt(2)
    v_mfma_f32_32x32x16_bf16 v[224:239], v[24:27], v[44:47], v[224:239]
    s_waitcnt lgkmcnt(0)
    v_mfma_f32_32x32x16_bf16 v[240:255], v[28:31], v[44:47], v[240:255]
    s_waitcnt vmcnt(8)
    s_barrier
    s_add_u32 m0, s38, 32768
    s_add_u32 s34, s28, 81920
    buffer_load_dwordx4 v2, s[8:11], s34 offen offset:0 nt lds
    buffer_load_dwordx4 v3, s[8:11], s34 offen offset:1024 nt lds
    buffer_load_dwordx4 v4, s[8:11], s34 offen offset:2048 nt lds
    buffer_load_dwordx4 v5, s[8:11], s34 offen offset:3072 nt lds
    s_add_u32 m0, s38, 65536
    s_add_u32 s34, s28, 81920
    buffer_load_dwordx4 v6, s[12:15], s34 offen offset:0 nt lds
    buffer_load_dwordx4 v6, s[12:15], s34 offen offset:1024 nt lds
    buffer_load_dwordx4 v6, s[12:15], s34 offen offset:2048 nt lds
    buffer_load_dwordx4 v6, s[12:15], s34 offen offset:3072 nt lds
    s_add_u32 s35, s30, 1576960
    s_add_u32 m0, s38, 114688
    s_nop 0
    buffer_load_dwordx4 v7, s[20:23], s35 offen offset:0 lds
    s_add_u32 s35, s35, 31744
    buffer_load_dwordx4 v7, s[20:23], s35 offen offset:1024 lds
    s_add_u32 s35, s35, 31744
    buffer_load_dwordx4 v7, s[20:23], s35 offen offset:2048 lds
    s_add_u32 s35, s35, 31744
    buffer_load_dwordx4 v7, s[20:23], s35 offen offset:3072 lds
    v_add_u32 v12, 131072, v8
    v_add_u32 v13, 131072, v9
    v_add_u32 v14, 131072, v10
    v_add_u32 v15, 131072, v11
    ds_read_b64_tr_b16 v[16:17], v12 offset:0
    ds_read_b64_tr_b16 v[18:19], v12 offset:1024
    ds_read_b64_tr_b16 v[20:21], v13 offset:0
    ds_read_b64_tr_b16 v[22:23], v13 offset:1024
    ds_read_b64_tr_b16 v[24:25], v14 offset:0
    ds_read_b64_tr_b16 v[26:27], v14 offset:1024
    ds_read_b64_tr_b16 v[28:29], v15 offset:0
    ds_read_b64_tr_b16 v[30:31], v15 offset:1024
    ds_read_b64_tr_b16 v[32:33], v12 offset:4096
    ds_read_b64_tr_b16 v[34:35], v12 offset:5120
    ds_read_b64_tr_b16 v[36:37], v13 offset:4096
    ds_read_b64_tr_b16 v[38:39], v13 offset:5120
    ds_read_b64_tr_b16 v[40:41], v14 offset:4096
    ds_read_b64_tr_b16 v[42:43], v14 offset:5120
    s_waitcnt lgkmcnt(12)
    v_mfma_f32_32x32x16_bf16 v[192:207], v[16:19], v[48:51], v[192:207]
    ds_read_b64_tr_b16 v[44:45], v15 offset:4096
    ds_read_b64_tr_b16 v[46:47], v15 offset:5120
    s_waitcnt lgkmcnt(12)
    v_mfma_f32_32x32x16_bf16 v[208:223], v[20:23], v[48:51], v[208:223]
    ds_read_b64_tr_b16 v[16:17], v12 offset:8192
    ds_read_b64_tr_b16 v[18:19], v12 offset:9216
    s_waitcnt lgkmcnt(12)
    v_mfma_f32_32x32x16_bf16 v[224:239], v[24:27], v[48:51], v[224:239]
    ds_read_b64_tr_b16 v[20:21], v13 offset:8192
    ds_read_b64_tr_b16 v[22:23], v13 offset:9216
    s_waitcnt lgkmcnt(12)
    v_mfma_f32_32x32x16_bf16 v[240:255], v[28:31], v[48:51], v[240:255]
    ds_read_b64_tr_b16 v[24:25], v14 offset:8192
    ds_read_b64_tr_b16 v[26:27], v14 offset:9216
    s_waitcnt lgkmcnt(12)
    v_mfma_f32_32x32x16_bf16 v[192:207], v[32:35], v[52:55], v[192:207]
    ds_read_b64_tr_b16 v[28:29], v15 offset:8192
    ds_read_b64_tr_b16 v[30:31], v15 offset:9216
    s_waitcnt lgkmcnt(12)
    v_mfma_f32_32x32x16_bf16 v[208:223], v[36:39], v[52:55], v[208:223]
    ds_read_b64_tr_b16 v[32:33], v12 offset:12288
    ds_read_b64_tr_b16 v[34:35], v12 offset:13312
    s_waitcnt lgkmcnt(12)
    v_mfma_f32_32x32x16_bf16 v[224:239], v[40:43], v[52:55], v[224:239]
    ds_read_b64_tr_b16 v[36:37], v13 offset:12288
    ds_read_b64_tr_b16 v[38:39], v13 offset:13312
    s_waitcnt lgkmcnt(12)
    v_mfma_f32_32x32x16_bf16 v[240:255], v[44:47], v[52:55], v[240:255]
    ds_read_b64_tr_b16 v[40:41], v14 offset:12288
    ds_read_b64_tr_b16 v[42:43], v14 offset:13312
    s_waitcnt lgkmcnt(12)
    v_mfma_f32_32x32x16_bf16 v[192:207], v[16:19], v[56:59], v[192:207]
    ds_read_b64_tr_b16 v[44:45], v15 offset:12288
    ds_read_b64_tr_b16 v[46:47], v15 offset:13312
    s_waitcnt lgkmcnt(12)
    v_mfma_f32_32x32x16_bf16 v[208:223], v[20:23], v[56:59], v[208:223]
    s_waitcnt lgkmcnt(10)
    v_mfma_f32_32x32x16_bf16 v[224:239], v[24:27], v[56:59], v[224:239]
    s_waitcnt lgkmcnt(8)
    v_mfma_f32_32x32x16_bf16 v[240:255], v[28:31], v[56:59], v[240:255]
    s_waitcnt lgkmcnt(6)
    v_mfma_f32_32x32x16_bf16 v[192:207], v[32:35], v[60:63], v[192:207]
    s_waitcnt lgkmcnt(4)
    v_mfma_f32_32x32x16_bf16 v[208:223], v[36:39], v[60:63], v[208:223]
    s_waitcnt lgkmcnt(2)
    v_mfma_f32_32x32x16_bf16 v[224:239], v[40:43], v[60:63], v[224:239]
    s_waitcnt lgkmcnt(0)
    v_mfma_f32_32x32x16_bf16 v[240:255], v[44:47], v[60:63], v[240:255]
    s_waitcnt vmcnt(12)
    s_barrier
    s_add_u32 m0, s38, 0
    s_add_u32 s34, s28, 98304
    buffer_load_dwordx4 v2, s[8:11], s34 offen offset:0 nt lds
    buffer_load_dwordx4 v3, s[8:11], s34 offen offset:1024 nt lds
    buffer_load_dwordx4 v4, s[8:11], s34 offen offset:2048 nt lds
    buffer_load_dwordx4 v5, s[8:11], s34 offen offset:3072 nt lds
    s_add_u32 m0, s38, 81920
    s_add_u32 s34, s28, 98304
    buffer_load_dwordx4 v6, s[12:15], s34 offen offset:0 nt lds
    buffer_load_dwordx4 v6, s[12:15], s34 offen offset:1024 nt lds
    buffer_load_dwordx4 v6, s[12:15], s34 offen offset:2048 nt lds
    buffer_load_dwordx4 v6, s[12:15], s34 offen offset:3072 nt lds
    s_add_u32 s35, s30, 2101248
    s_add_u32 m0, s38, 131072
    s_nop 0
    buffer_load_dwordx4 v7, s[20:23], s35 offen offset:0 lds
    s_add_u32 s35, s35, 31744
    buffer_load_dwordx4 v7, s[20:23], s35 offen offset:1024 lds
    s_add_u32 s35, s35, 31744
    buffer_load_dwordx4 v7, s[20:23], s35 offen offset:2048 lds
    s_add_u32 s35, s35, 31744
    buffer_load_dwordx4 v7, s[20:23], s35 offen offset:3072 lds
    v_add_u32 v12, 147456, v8
    v_add_u32 v13, 147456, v9
    v_add_u32 v14, 147456, v10
    v_add_u32 v15, 147456, v11
    ds_read_b64_tr_b16 v[16:17], v12 offset:0
    ds_read_b64_tr_b16 v[18:19], v12 offset:1024
    ds_read_b64_tr_b16 v[20:21], v13 offset:0
    ds_read_b64_tr_b16 v[22:23], v13 offset:1024
    ds_read_b64_tr_b16 v[24:25], v14 offset:0
    ds_read_b64_tr_b16 v[26:27], v14 offset:1024
    ds_read_b64_tr_b16 v[28:29], v15 offset:0
    ds_read_b64_tr_b16 v[30:31], v15 offset:1024
    ds_read_b64_tr_b16 v[48:49], v12 offset:4096
    ds_read_b64_tr_b16 v[50:51], v12 offset:5120
    ds_read_b64_tr_b16 v[52:53], v13 offset:4096
    ds_read_b64_tr_b16 v[54:55], v13 offset:5120
    ds_read_b64_tr_b16 v[56:57], v14 offset:4096
    ds_read_b64_tr_b16 v[58:59], v14 offset:5120
    s_waitcnt lgkmcnt(12)
    v_mfma_f32_32x32x16_bf16 v[192:207], v[16:19], v[64:67], v[192:207]
    ds_read_b64_tr_b16 v[60:61], v15 offset:4096
    ds_read_b64_tr_b16 v[62:63], v15 offset:5120
    s_waitcnt lgkmcnt(12)
    v_mfma_f32_32x32x16_bf16 v[208:223], v[20:23], v[64:67], v[208:223]
    ds_read_b64_tr_b16 v[32:33], v12 offset:8192
    ds_read_b64_tr_b16 v[34:35], v12 offset:9216
    s_waitcnt lgkmcnt(12)
    v_mfma_f32_32x32x16_bf16 v[224:239], v[24:27], v[64:67], v[224:239]
    ds_read_b64_tr_b16 v[36:37], v13 offset:8192
    ds_read_b64_tr_b16 v[38:39], v13 offset:9216
    s_waitcnt lgkmcnt(12)
    v_mfma_f32_32x32x16_bf16 v[240:255], v[28:31], v[64:67], v[240:255]
    ds_read_b64_tr_b16 v[40:41], v14 offset:8192
    ds_read_b64_tr_b16 v[42:43], v14 offset:9216
    s_waitcnt lgkmcnt(12)
    v_mfma_f32_32x32x16_bf16 v[192:207], v[48:51], v[68:71], v[192:207]
    ds_read_b64_tr_b16 v[44:45], v15 offset:8192
    ds_read_b64_tr_b16 v[46:47], v15 offset:9216
    s_waitcnt lgkmcnt(12)
    v_mfma_f32_32x32x16_bf16 v[208:223], v[52:55], v[68:71], v[208:223]
    ds_read_b64_tr_b16 v[16:17], v12 offset:12288
    ds_read_b64_tr_b16 v[18:19], v12 offset:13312
    s_waitcnt lgkmcnt(12)
    v_mfma_f32_32x32x16_bf16 v[224:239], v[56:59], v[68:71], v[224:239]
    ds_read_b64_tr_b16 v[20:21], v13 offset:12288
    ds_read_b64_tr_b16 v[22:23], v13 offset:13312
    s_waitcnt lgkmcnt(12)
    v_mfma_f32_32x32x16_bf16 v[240:255], v[60:63], v[68:71], v[240:255]
    ds_read_b64_tr_b16 v[24:25], v14 offset:12288
    ds_read_b64_tr_b16 v[26:27], v14 offset:13312
    s_waitcnt lgkmcnt(12)
    v_mfma_f32_32x32x16_bf16 v[192:207], v[32:35], v[72:75], v[192:207]
    ds_read_b64_tr_b16 v[28:29], v15 offset:12288
    ds_read_b64_tr_b16 v[30:31], v15 offset:13312
    s_waitcnt lgkmcnt(12)
    v_mfma_f32_32x32x16_bf16 v[208:223], v[36:39], v[72:75], v[208:223]
    s_waitcnt lgkmcnt(10)
    v_mfma_f32_32x32x16_bf16 v[224:239], v[40:43], v[72:75], v[224:239]
    s_waitcnt lgkmcnt(8)
    v_mfma_f32_32x32x16_bf16 v[240:255], v[44:47], v[72:75], v[240:255]
    s_waitcnt lgkmcnt(6)
    v_mfma_f32_32x32x16_bf16 v[192:207], v[16:19], v[76:79], v[192:207]
    s_waitcnt lgkmcnt(4)
    v_mfma_f32_32x32x16_bf16 v[208:223], v[20:23], v[76:79], v[208:223]
    s_waitcnt lgkmcnt(2)
    v_mfma_f32_32x32x16_bf16 v[224:239], v[24:27], v[76:79], v[224:239]
    s_waitcnt lgkmcnt(0)
    v_mfma_f32_32x32x16_bf16 v[240:255], v[28:31], v[76:79], v[240:255]
    s_waitcnt vmcnt(12)
    s_barrier
    s_add_u32 m0, s38, 16384
    s_add_u32 s34, s28, 114688
    buffer_load_dwordx4 v2, s[8:11], s34 offen offset:0 nt lds
    buffer_load_dwordx4 v3, s[8:11], s34 offen offset:1024 nt lds
    buffer_load_dwordx4 v4, s[8:11], s34 offen offset:2048 nt lds
    buffer_load_dwordx4 v5, s[8:11], s34 offen offset:3072 nt lds
    s_add_u32 m0, s38, 98304
    s_add_u32 s34, s28, 114688
    buffer_load_dwordx4 v6, s[12:15], s34 offen offset:0 nt lds
    buffer_load_dwordx4 v6, s[12:15], s34 offen offset:1024 nt lds
    buffer_load_dwordx4 v6, s[12:15], s34 offen offset:2048 nt lds
    buffer_load_dwordx4 v6, s[12:15], s34 offen offset:3072 nt lds
    s_add_u32 s35, s30, 2625536
    s_add_u32 m0, s38, 147456
    s_nop 0
    buffer_load_dwordx4 v7, s[20:23], s35 offen offset:0 lds
    s_add_u32 s35, s35, 31744
    buffer_load_dwordx4 v7, s[20:23], s35 offen offset:1024 lds
    s_add_u32 s35, s35, 31744
    buffer_load_dwordx4 v7, s[20:23], s35 offen offset:2048 lds
    s_add_u32 s35, s35, 31744
    buffer_load_dwordx4 v7, s[20:23], s35 offen offset:3072 lds
    v_add_u32 v12, 114688, v8
    v_add_u32 v13, 114688, v9
    v_add_u32 v14, 114688, v10
    v_add_u32 v15, 114688, v11
    ds_read_b64_tr_b16 v[16:17], v12 offset:0
    ds_read_b64_tr_b16 v[18:19], v12 offset:1024
    ds_read_b64_tr_b16 v[20:21], v13 offset:0
    ds_read_b64_tr_b16 v[22:23], v13 offset:1024
    ds_read_b64_tr_b16 v[24:25], v14 offset:0
    ds_read_b64_tr_b16 v[26:27], v14 offset:1024
    ds_read_b64_tr_b16 v[28:29], v15 offset:0
    ds_read_b64_tr_b16 v[30:31], v15 offset:1024
    ds_read_b64_tr_b16 v[64:65], v12 offset:4096
    ds_read_b64_tr_b16 v[66:67], v12 offset:5120
    ds_read_b64_tr_b16 v[68:69], v13 offset:4096
    ds_read_b64_tr_b16 v[70:71], v13 offset:5120
    ds_read_b64_tr_b16 v[72:73], v14 offset:4096
    ds_read_b64_tr_b16 v[74:75], v14 offset:5120
    s_waitcnt lgkmcnt(12)
    v_mfma_f32_32x32x16_bf16 v[192:207], v[16:19], v[80:83], v[192:207]
    ds_read_b64_tr_b16 v[76:77], v15 offset:4096
    ds_read_b64_tr_b16 v[78:79], v15 offset:5120
    s_waitcnt lgkmcnt(12)
    v_mfma_f32_32x32x16_bf16 v[208:223], v[20:23], v[80:83], v[208:223]
    ds_read_b64_tr_b16 v[48:49], v12 offset:8192
    ds_read_b64_tr_b16 v[50:51], v12 offset:9216
    s_waitcnt lgkmcnt(12)
    v_mfma_f32_32x32x16_bf16 v[224:239], v[24:27], v[80:83], v[224:239]
    ds_read_b64_tr_b16 v[52:53], v13 offset:8192
    ds_read_b64_tr_b16 v[54:55], v13 offset:9216
    s_waitcnt lgkmcnt(12)
    v_mfma_f32_32x32x16_bf16 v[240:255], v[28:31], v[80:83], v[240:255]
    ds_read_b64_tr_b16 v[56:57], v14 offset:8192
    ds_read_b64_tr_b16 v[58:59], v14 offset:9216
    s_waitcnt lgkmcnt(12)
    v_mfma_f32_32x32x16_bf16 v[192:207], v[64:67], v[84:87], v[192:207]
    ds_read_b64_tr_b16 v[60:61], v15 offset:8192
    ds_read_b64_tr_b16 v[62:63], v15 offset:9216
    s_waitcnt lgkmcnt(12)
    v_mfma_f32_32x32x16_bf16 v[208:223], v[68:71], v[84:87], v[208:223]
    ds_read_b64_tr_b16 v[16:17], v12 offset:12288
    ds_read_b64_tr_b16 v[18:19], v12 offset:13312
    s_waitcnt lgkmcnt(12)
    v_mfma_f32_32x32x16_bf16 v[224:239], v[72:75], v[84:87], v[224:239]
    ds_read_b64_tr_b16 v[20:21], v13 offset:12288
    ds_read_b64_tr_b16 v[22:23], v13 offset:13312
    s_waitcnt lgkmcnt(12)
    v_mfma_f32_32x32x16_bf16 v[240:255], v[76:79], v[84:87], v[240:255]
    ds_read_b64_tr_b16 v[24:25], v14 offset:12288
    ds_read_b64_tr_b16 v[26:27], v14 offset:13312
    s_waitcnt lgkmcnt(12)
    v_mfma_f32_32x32x16_bf16 v[192:207], v[48:51], v[88:91], v[192:207]
    ds_read_b64_tr_b16 v[28:29], v15 offset:12288
    ds_read_b64_tr_b16 v[30:31], v15 offset:13312
    s_waitcnt lgkmcnt(12)
    v_mfma_f32_32x32x16_bf16 v[208:223], v[52:55], v[88:91], v[208:223]
    s_waitcnt lgkmcnt(10)
    v_mfma_f32_32x32x16_bf16 v[224:239], v[56:59], v[88:91], v[224:239]
    s_waitcnt lgkmcnt(8)
    v_mfma_f32_32x32x16_bf16 v[240:255], v[60:63], v[88:91], v[240:255]
    s_waitcnt lgkmcnt(6)
    v_mfma_f32_32x32x16_bf16 v[192:207], v[16:19], v[92:95], v[192:207]
    s_waitcnt lgkmcnt(4)
    v_mfma_f32_32x32x16_bf16 v[208:223], v[20:23], v[92:95], v[208:223]
    s_waitcnt lgkmcnt(2)
    v_mfma_f32_32x32x16_bf16 v[224:239], v[24:27], v[92:95], v[224:239]
    s_waitcnt lgkmcnt(0)
    v_mfma_f32_32x32x16_bf16 v[240:255], v[28:31], v[92:95], v[240:255]
    s_waitcnt vmcnt(12)
    s_barrier
    s_add_u32 m0, s38, 32768
    s_add_u32 s34, s28, 131072
    buffer_load_dwordx4 v2, s[8:11], s34 offen offset:0 nt lds
    buffer_load_dwordx4 v3, s[8:11], s34 offen offset:1024 nt lds
    buffer_load_dwordx4 v4, s[8:11], s34 offen offset:2048 nt lds
    buffer_load_dwordx4 v5, s[8:11], s34 offen offset:3072 nt lds
    s_add_u32 m0, s38, 49152
    s_add_u32 s34, s28, 131072
    buffer_load_dwordx4 v6, s[12:15], s34 offen offset:0 nt lds
    buffer_load_dwordx4 v6, s[12:15], s34 offen offset:1024 nt lds
    buffer_load_dwordx4 v6, s[12:15], s34 offen offset:2048 nt lds
    buffer_load_dwordx4 v6, s[12:15], s34 offen offset:3072 nt lds
    s_add_u32 s35, s30, 3149824
    s_add_u32 m0, s38, 114688
    s_nop 0
    buffer_load_dwordx4 v7, s[20:23], s35 offen offset:0 lds
    s_add_u32 s35, s35, 31744
    buffer_load_dwordx4 v7, s[20:23], s35 offen offset:1024 lds
    s_add_u32 s35, s35, 31744
    buffer_load_dwordx4 v7, s[20:23], s35 offen offset:2048 lds
    s_add_u32 s35, s35, 31744
    buffer_load_dwordx4 v7, s[20:23], s35 offen offset:3072 lds
    v_add_u32 v12, 131072, v8
    v_add_u32 v13, 131072, v9
    v_add_u32 v14, 131072, v10
    v_add_u32 v15, 131072, v11
    ds_read_b64_tr_b16 v[16:17], v12 offset:0
    ds_read_b64_tr_b16 v[18:19], v12 offset:1024
    ds_read_b64_tr_b16 v[20:21], v13 offset:0
    ds_read_b64_tr_b16 v[22:23], v13 offset:1024
    ds_read_b64_tr_b16 v[24:25], v14 offset:0
    ds_read_b64_tr_b16 v[26:27], v14 offset:1024
    ds_read_b64_tr_b16 v[28:29], v15 offset:0
    ds_read_b64_tr_b16 v[30:31], v15 offset:1024
    ds_read_b64_tr_b16 v[80:81], v12 offset:4096
    ds_read_b64_tr_b16 v[82:83], v12 offset:5120
    ds_read_b64_tr_b16 v[84:85], v13 offset:4096
    ds_read_b64_tr_b16 v[86:87], v13 offset:5120
    ds_read_b64_tr_b16 v[88:89], v14 offset:4096
    ds_read_b64_tr_b16 v[90:91], v14 offset:5120
    s_waitcnt lgkmcnt(12)
    v_mfma_f32_32x32x16_bf16 v[192:207], v[16:19], v[96:99], v[192:207]
    ds_read_b64_tr_b16 v[92:93], v15 offset:4096
    ds_read_b64_tr_b16 v[94:95], v15 offset:5120
    s_waitcnt lgkmcnt(12)
    v_mfma_f32_32x32x16_bf16 v[208:223], v[20:23], v[96:99], v[208:223]
    ds_read_b64_tr_b16 v[64:65], v12 offset:8192
    ds_read_b64_tr_b16 v[66:67], v12 offset:9216
    s_waitcnt lgkmcnt(12)
    v_mfma_f32_32x32x16_bf16 v[224:239], v[24:27], v[96:99], v[224:239]
    ds_read_b64_tr_b16 v[68:69], v13 offset:8192
    ds_read_b64_tr_b16 v[70:71], v13 offset:9216
    s_waitcnt lgkmcnt(12)
    v_mfma_f32_32x32x16_bf16 v[240:255], v[28:31], v[96:99], v[240:255]
    ds_read_b64_tr_b16 v[72:73], v14 offset:8192
    ds_read_b64_tr_b16 v[74:75], v14 offset:9216
    s_waitcnt lgkmcnt(12)
    v_mfma_f32_32x32x16_bf16 v[192:207], v[80:83], v[100:103], v[192:207]
    ds_read_b64_tr_b16 v[76:77], v15 offset:8192
    ds_read_b64_tr_b16 v[78:79], v15 offset:9216
    s_waitcnt lgkmcnt(12)
    v_mfma_f32_32x32x16_bf16 v[208:223], v[84:87], v[100:103], v[208:223]
    ds_read_b64_tr_b16 v[16:17], v12 offset:12288
    ds_read_b64_tr_b16 v[18:19], v12 offset:13312
    s_waitcnt lgkmcnt(12)
    v_mfma_f32_32x32x16_bf16 v[224:239], v[88:91], v[100:103], v[224:239]
    ds_read_b64_tr_b16 v[20:21], v13 offset:12288
    ds_read_b64_tr_b16 v[22:23], v13 offset:13312
    s_waitcnt lgkmcnt(12)
    v_mfma_f32_32x32x16_bf16 v[240:255], v[92:95], v[100:103], v[240:255]
    ds_read_b64_tr_b16 v[24:25], v14 offset:12288
    ds_read_b64_tr_b16 v[26:27], v14 offset:13312
    s_waitcnt lgkmcnt(12)
    v_mfma_f32_32x32x16_bf16 v[192:207], v[64:67], v[104:107], v[192:207]
    ds_read_b64_tr_b16 v[28:29], v15 offset:12288
    ds_read_b64_tr_b16 v[30:31], v15 offset:13312
    s_waitcnt lgkmcnt(12)
    v_mfma_f32_32x32x16_bf16 v[208:223], v[68:71], v[104:107], v[208:223]
    s_waitcnt lgkmcnt(10)
    v_mfma_f32_32x32x16_bf16 v[224:239], v[72:75], v[104:107], v[224:239]
    s_waitcnt lgkmcnt(8)
    v_mfma_f32_32x32x16_bf16 v[240:255], v[76:79], v[104:107], v[240:255]
    s_waitcnt lgkmcnt(6)
    v_mfma_f32_32x32x16_bf16 v[192:207], v[16:19], v[108:111], v[192:207]
    s_waitcnt lgkmcnt(4)
    v_mfma_f32_32x32x16_bf16 v[208:223], v[20:23], v[108:111], v[208:223]
    s_waitcnt lgkmcnt(2)
    v_mfma_f32_32x32x16_bf16 v[224:239], v[24:27], v[108:111], v[224:239]
    s_waitcnt lgkmcnt(0)
    v_mfma_f32_32x32x16_bf16 v[240:255], v[28:31], v[108:111], v[240:255]
    s_waitcnt vmcnt(12)
    s_barrier
    s_add_u32 m0, s38, 0
    s_add_u32 s34, s28, 147456
    buffer_load_dwordx4 v2, s[8:11], s34 offen offset:0 nt lds
    buffer_load_dwordx4 v3, s[8:11], s34 offen offset:1024 nt lds
    buffer_load_dwordx4 v4, s[8:11], s34 offen offset:2048 nt lds
    buffer_load_dwordx4 v5, s[8:11], s34 offen offset:3072 nt lds
    s_add_u32 m0, s38, 65536
    s_add_u32 s34, s28, 147456
    buffer_load_dwordx4 v6, s[12:15], s34 offen offset:0 nt lds
    buffer_load_dwordx4 v6, s[12:15], s34 offen offset:1024 nt lds
    buffer_load_dwordx4 v6, s[12:15], s34 offen offset:2048 nt lds
    buffer_load_dwordx4 v6, s[12:15], s34 offen offset:3072 nt lds
    s_add_u32 s35, s30, 3674112
    s_add_u32 m0, s38, 131072
    s_nop 0
    buffer_load_dwordx4 v7, s[20:23], s35 offen offset:0 lds
    s_add_u32 s35, s35, 31744
    buffer_load_dwordx4 v7, s[20:23], s35 offen offset:1024 lds
    s_add_u32 s35, s35, 31744
    buffer_load_dwordx4 v7, s[20:23], s35 offen offset:2048 lds
    s_add_u32 s35, s35, 31744
    buffer_load_dwordx4 v7, s[20:23], s35 offen offset:3072 lds
    v_add_u32 v12, 147456, v8
    v_add_u32 v13, 147456, v9
    v_add_u32 v14, 147456, v10
    v_add_u32 v15, 147456, v11
    ds_read_b64_tr_b16 v[16:17], v12 offset:0
    ds_read_b64_tr_b16 v[18:19], v12 offset:1024
    ds_read_b64_tr_b16 v[20:21], v13 offset:0
    ds_read_b64_tr_b16 v[22:23], v13 offset:1024
    ds_read_b64_tr_b16 v[24:25], v14 offset:0
    ds_read_b64_tr_b16 v[26:27], v14 offset:1024
    ds_read_b64_tr_b16 v[28:29], v15 offset:0
    ds_read_b64_tr_b16 v[30:31], v15 offset:1024
    ds_read_b64_tr_b16 v[96:97], v12 offset:4096
    ds_read_b64_tr_b16 v[98:99], v12 offset:5120
    ds_read_b64_tr_b16 v[100:101], v13 offset:4096
    ds_read_b64_tr_b16 v[102:103], v13 offset:5120
    ds_read_b64_tr_b16 v[104:105], v14 offset:4096
    ds_read_b64_tr_b16 v[106:107], v14 offset:5120
    s_waitcnt lgkmcnt(12)
    v_mfma_f32_32x32x16_bf16 v[192:207], v[16:19], v[112:115], v[192:207]
    ds_read_b64_tr_b16 v[108:109], v15 offset:4096
    ds_read_b64_tr_b16 v[110:111], v15 offset:5120
    s_waitcnt lgkmcnt(12)
    v_mfma_f32_32x32x16_bf16 v[208:223], v[20:23], v[112:115], v[208:223]
    ds_read_b64_tr_b16 v[80:81], v12 offset:8192
    ds_read_b64_tr_b16 v[82:83], v12 offset:9216
    s_waitcnt lgkmcnt(12)
    v_mfma_f32_32x32x16_bf16 v[224:239], v[24:27], v[112:115], v[224:239]
    ds_read_b64_tr_b16 v[84:85], v13 offset:8192
    ds_read_b64_tr_b16 v[86:87], v13 offset:9216
    s_waitcnt lgkmcnt(12)
    v_mfma_f32_32x32x16_bf16 v[240:255], v[28:31], v[112:115], v[240:255]
    ds_read_b64_tr_b16 v[88:89], v14 offset:8192
    ds_read_b64_tr_b16 v[90:91], v14 offset:9216
    s_waitcnt lgkmcnt(12)
    v_mfma_f32_32x32x16_bf16 v[192:207], v[96:99], v[116:119], v[192:207]
    ds_read_b64_tr_b16 v[92:93], v15 offset:8192
    ds_read_b64_tr_b16 v[94:95], v15 offset:9216
    s_waitcnt lgkmcnt(12)
    v_mfma_f32_32x32x16_bf16 v[208:223], v[100:103], v[116:119], v[208:223]
    ds_read_b64_tr_b16 v[16:17], v12 offset:12288
    ds_read_b64_tr_b16 v[18:19], v12 offset:13312
    s_waitcnt lgkmcnt(12)
    v_mfma_f32_32x32x16_bf16 v[224:239], v[104:107], v[116:119], v[224:239]
    ds_read_b64_tr_b16 v[20:21], v13 offset:12288
    ds_read_b64_tr_b16 v[22:23], v13 offset:13312
    s_waitcnt lgkmcnt(12)
    v_mfma_f32_32x32x16_bf16 v[240:255], v[108:111], v[116:119], v[240:255]
    ds_read_b64_tr_b16 v[24:25], v14 offset:12288
    ds_read_b64_tr_b16 v[26:27], v14 offset:13312
    s_waitcnt lgkmcnt(12)
    v_mfma_f32_32x32x16_bf16 v[192:207], v[80:83], v[120:123], v[192:207]
    ds_read_b64_tr_b16 v[28:29], v15 offset:12288
    ds_read_b64_tr_b16 v[30:31], v15 offset:13312
    s_waitcnt lgkmcnt(12)
    v_mfma_f32_32x32x16_bf16 v[208:223], v[84:87], v[120:123], v[208:223]
    s_waitcnt lgkmcnt(10)
    v_mfma_f32_32x32x16_bf16 v[224:239], v[88:91], v[120:123], v[224:239]
    s_waitcnt lgkmcnt(8)
    v_mfma_f32_32x32x16_bf16 v[240:255], v[92:95], v[120:123], v[240:255]
    s_waitcnt lgkmcnt(6)
    v_mfma_f32_32x32x16_bf16 v[192:207], v[16:19], v[124:127], v[192:207]
    s_waitcnt lgkmcnt(4)
    v_mfma_f32_32x32x16_bf16 v[208:223], v[20:23], v[124:127], v[208:223]
    s_waitcnt lgkmcnt(2)
    v_mfma_f32_32x32x16_bf16 v[224:239], v[24:27], v[124:127], v[224:239]
    s_waitcnt lgkmcnt(0)
    v_mfma_f32_32x32x16_bf16 v[240:255], v[28:31], v[124:127], v[240:255]
    s_waitcnt vmcnt(12)
    s_barrier
    s_add_u32 m0, s38, 16384
    s_add_u32 s34, s28, 163840
    buffer_load_dwordx4 v2, s[8:11], s34 offen offset:0 nt lds
    buffer_load_dwordx4 v3, s[8:11], s34 offen offset:1024 nt lds
    buffer_load_dwordx4 v4, s[8:11], s34 offen offset:2048 nt lds
    buffer_load_dwordx4 v5, s[8:11], s34 offen offset:3072 nt lds
    s_add_u32 m0, s38, 81920
    s_add_u32 s34, s28, 163840
    buffer_load_dwordx4 v6, s[12:15], s34 offen offset:0 nt lds
    buffer_load_dwordx4 v6, s[12:15], s34 offen offset:1024 nt lds
    buffer_load_dwordx4 v6, s[12:15], s34 offen offset:2048 nt lds
    buffer_load_dwordx4 v6, s[12:15], s34 offen offset:3072 nt lds
    s_add_u32 s35, s30, 4198400
    s_add_u32 m0, s38, 147456
    s_nop 0
    buffer_load_dwordx4 v7, s[20:23], s35 offen offset:0 lds
    s_add_u32 s35, s35, 31744
    buffer_load_dwordx4 v7, s[20:23], s35 offen offset:1024 lds
    s_add_u32 s35, s35, 31744
    buffer_load_dwordx4 v7, s[20:23], s35 offen offset:2048 lds
    s_add_u32 s35, s35, 31744
    buffer_load_dwordx4 v7, s[20:23], s35 offen offset:3072 lds
    v_add_u32 v12, 114688, v8
    v_add_u32 v13, 114688, v9
    v_add_u32 v14, 114688, v10
    v_add_u32 v15, 114688, v11
    ds_read_b64_tr_b16 v[16:17], v12 offset:0
    ds_read_b64_tr_b16 v[18:19], v12 offset:1024
    ds_read_b64_tr_b16 v[20:21], v13 offset:0
    ds_read_b64_tr_b16 v[22:23], v13 offset:1024
    ds_read_b64_tr_b16 v[24:25], v14 offset:0
    ds_read_b64_tr_b16 v[26:27], v14 offset:1024
    ds_read_b64_tr_b16 v[28:29], v15 offset:0
    ds_read_b64_tr_b16 v[30:31], v15 offset:1024
    ds_read_b64_tr_b16 v[112:113], v12 offset:4096
    ds_read_b64_tr_b16 v[114:115], v12 offset:5120
    ds_read_b64_tr_b16 v[116:117], v13 offset:4096
    ds_read_b64_tr_b16 v[118:119], v13 offset:5120
    ds_read_b64_tr_b16 v[120:121], v14 offset:4096
    ds_read_b64_tr_b16 v[122:123], v14 offset:5120
    s_waitcnt lgkmcnt(12)
    v_mfma_f32_32x32x16_bf16 v[192:207], v[16:19], v[128:131], v[192:207]
    ds_read_b64_tr_b16 v[124:125], v15 offset:4096
    ds_read_b64_tr_b16 v[126:127], v15 offset:5120
    s_waitcnt lgkmcnt(12)
    v_mfma_f32_32x32x16_bf16 v[208:223], v[20:23], v[128:131], v[208:223]
    ds_read_b64_tr_b16 v[96:97], v12 offset:8192
    ds_read_b64_tr_b16 v[98:99], v12 offset:9216
    s_waitcnt lgkmcnt(12)
    v_mfma_f32_32x32x16_bf16 v[224:239], v[24:27], v[128:131], v[224:239]
    ds_read_b64_tr_b16 v[100:101], v13 offset:8192
    ds_read_b64_tr_b16 v[102:103], v13 offset:9216
    s_waitcnt lgkmcnt(12)
    v_mfma_f32_32x32x16_bf16 v[240:255], v[28:31], v[128:131], v[240:255]
    ds_read_b64_tr_b16 v[104:105], v14 offset:8192
    ds_read_b64_tr_b16 v[106:107], v14 offset:9216
    s_waitcnt lgkmcnt(12)
    v_mfma_f32_32x32x16_bf16 v[192:207], v[112:115], v[132:135], v[192:207]
    ds_read_b64_tr_b16 v[108:109], v15 offset:8192
    ds_read_b64_tr_b16 v[110:111], v15 offset:9216
    s_waitcnt lgkmcnt(12)
    v_mfma_f32_32x32x16_bf16 v[208:223], v[116:119], v[132:135], v[208:223]
    ds_read_b64_tr_b16 v[16:17], v12 offset:12288
    ds_read_b64_tr_b16 v[18:19], v12 offset:13312
    s_waitcnt lgkmcnt(12)
    v_mfma_f32_32x32x16_bf16 v[224:239], v[120:123], v[132:135], v[224:239]
    ds_read_b64_tr_b16 v[20:21], v13 offset:12288
    ds_read_b64_tr_b16 v[22:23], v13 offset:13312
    s_waitcnt lgkmcnt(12)
    v_mfma_f32_32x32x16_bf16 v[240:255], v[124:127], v[132:135], v[240:255]
    ds_read_b64_tr_b16 v[24:25], v14 offset:12288
    ds_read_b64_tr_b16 v[26:27], v14 offset:13312
    s_waitcnt lgkmcnt(12)
    v_mfma_f32_32x32x16_bf16 v[192:207], v[96:99], v[136:139], v[192:207]
    ds_read_b64_tr_b16 v[28:29], v15 offset:12288
    ds_read_b64_tr_b16 v[30:31], v15 offset:13312
    s_waitcnt lgkmcnt(12)
    v_mfma_f32_32x32x16_bf16 v[208:223], v[100:103], v[136:139], v[208:223]
    s_waitcnt lgkmcnt(10)
    v_mfma_f32_32x32x16_bf16 v[224:239], v[104:107], v[136:139], v[224:239]
    s_waitcnt lgkmcnt(8)
    v_mfma_f32_32x32x16_bf16 v[240:255], v[108:111], v[136:139], v[240:255]
    s_waitcnt lgkmcnt(6)
    v_mfma_f32_32x32x16_bf16 v[192:207], v[16:19], v[140:143], v[192:207]
    s_waitcnt lgkmcnt(4)
    v_mfma_f32_32x32x16_bf16 v[208:223], v[20:23], v[140:143], v[208:223]
    s_waitcnt lgkmcnt(2)
    v_mfma_f32_32x32x16_bf16 v[224:239], v[24:27], v[140:143], v[224:239]
    s_waitcnt lgkmcnt(0)
    v_mfma_f32_32x32x16_bf16 v[240:255], v[28:31], v[140:143], v[240:255]
    s_waitcnt vmcnt(12)
    s_barrier
    s_add_u32 m0, s38, 32768
    s_add_u32 s34, s28, 180224
    buffer_load_dwordx4 v2, s[8:11], s34 offen offset:0 nt lds
    buffer_load_dwordx4 v3, s[8:11], s34 offen offset:1024 nt lds
    buffer_load_dwordx4 v4, s[8:11], s34 offen offset:2048 nt lds
    buffer_load_dwordx4 v5, s[8:11], s34 offen offset:3072 nt lds
    s_add_u32 m0, s38, 98304
    s_add_u32 s34, s28, 180224
    buffer_load_dwordx4 v6, s[12:15], s34 offen offset:0 nt lds
    buffer_load_dwordx4 v6, s[12:15], s34 offen offset:1024 nt lds
    buffer_load_dwordx4 v6, s[12:15], s34 offen offset:2048 nt lds
    buffer_load_dwordx4 v6, s[12:15], s34 offen offset:3072 nt lds
    s_add_u32 s35, s30, 4722688
    s_add_u32 m0, s38, 114688
    s_nop 0
    buffer_load_dwordx4 v7, s[20:23], s35 offen offset:0 lds
    s_add_u32 s35, s35, 31744
    buffer_load_dwordx4 v7, s[20:23], s35 offen offset:1024 lds
    s_add_u32 s35, s35, 31744
    buffer_load_dwordx4 v7, s[20:23], s35 offen offset:2048 lds
    s_add_u32 s35, s35, 31744
    buffer_load_dwordx4 v7, s[20:23], s35 offen offset:3072 lds
    v_add_u32 v12, 131072, v8
    v_add_u32 v13, 131072, v9
    v_add_u32 v14, 131072, v10
    v_add_u32 v15, 131072, v11
    ds_read_b64_tr_b16 v[16:17], v12 offset:0
    ds_read_b64_tr_b16 v[18:19], v12 offset:1024
    ds_read_b64_tr_b16 v[20:21], v13 offset:0
    ds_read_b64_tr_b16 v[22:23], v13 offset:1024
    ds_read_b64_tr_b16 v[24:25], v14 offset:0
    ds_read_b64_tr_b16 v[26:27], v14 offset:1024
    ds_read_b64_tr_b16 v[28:29], v15 offset:0
    ds_read_b64_tr_b16 v[30:31], v15 offset:1024
    ds_read_b64_tr_b16 v[128:129], v12 offset:4096
    ds_read_b64_tr_b16 v[130:131], v12 offset:5120
    ds_read_b64_tr_b16 v[132:133], v13 offset:4096
    ds_read_b64_tr_b16 v[134:135], v13 offset:5120
    ds_read_b64_tr_b16 v[136:137], v14 offset:4096
    ds_read_b64_tr_b16 v[138:139], v14 offset:5120
    s_waitcnt lgkmcnt(12)
    v_mfma_f32_32x32x16_bf16 v[192:207], v[16:19], v[144:147], v[192:207]
    ds_read_b64_tr_b16 v[140:141], v15 offset:4096
    ds_read_b64_tr_b16 v[142:143], v15 offset:5120
    s_waitcnt lgkmcnt(12)
    v_mfma_f32_32x32x16_bf16 v[208:223], v[20:23], v[144:147], v[208:223]
    ds_read_b64_tr_b16 v[112:113], v12 offset:8192
    ds_read_b64_tr_b16 v[114:115], v12 offset:9216
    s_waitcnt lgkmcnt(12)
    v_mfma_f32_32x32x16_bf16 v[224:239], v[24:27], v[144:147], v[224:239]
    ds_read_b64_tr_b16 v[116:117], v13 offset:8192
    ds_read_b64_tr_b16 v[118:119], v13 offset:9216
    s_waitcnt lgkmcnt(12)
    v_mfma_f32_32x32x16_bf16 v[240:255], v[28:31], v[144:147], v[240:255]
    ds_read_b64_tr_b16 v[120:121], v14 offset:8192
    ds_read_b64_tr_b16 v[122:123], v14 offset:9216
    s_waitcnt lgkmcnt(12)
    v_mfma_f32_32x32x16_bf16 v[192:207], v[128:131], v[148:151], v[192:207]
    ds_read_b64_tr_b16 v[124:125], v15 offset:8192
    ds_read_b64_tr_b16 v[126:127], v15 offset:9216
    s_waitcnt lgkmcnt(12)
    v_mfma_f32_32x32x16_bf16 v[208:223], v[132:135], v[148:151], v[208:223]
    ds_read_b64_tr_b16 v[16:17], v12 offset:12288
    ds_read_b64_tr_b16 v[18:19], v12 offset:13312
    s_waitcnt lgkmcnt(12)
    v_mfma_f32_32x32x16_bf16 v[224:239], v[136:139], v[148:151], v[224:239]
    ds_read_b64_tr_b16 v[20:21], v13 offset:12288
    ds_read_b64_tr_b16 v[22:23], v13 offset:13312
    s_waitcnt lgkmcnt(12)
    v_mfma_f32_32x32x16_bf16 v[240:255], v[140:143], v[148:151], v[240:255]
    ds_read_b64_tr_b16 v[24:25], v14 offset:12288
    ds_read_b64_tr_b16 v[26:27], v14 offset:13312
    s_waitcnt lgkmcnt(12)
    v_mfma_f32_32x32x16_bf16 v[192:207], v[112:115], v[152:155], v[192:207]
    ds_read_b64_tr_b16 v[28:29], v15 offset:12288
    ds_read_b64_tr_b16 v[30:31], v15 offset:13312
    s_waitcnt lgkmcnt(12)
    v_mfma_f32_32x32x16_bf16 v[208:223], v[116:119], v[152:155], v[208:223]
    s_waitcnt lgkmcnt(10)
    v_mfma_f32_32x32x16_bf16 v[224:239], v[120:123], v[152:155], v[224:239]
    s_waitcnt lgkmcnt(8)
    v_mfma_f32_32x32x16_bf16 v[240:255], v[124:127], v[152:155], v[240:255]
    s_waitcnt lgkmcnt(6)
    v_mfma_f32_32x32x16_bf16 v[192:207], v[16:19], v[156:159], v[192:207]
    s_waitcnt lgkmcnt(4)
    v_mfma_f32_32x32x16_bf16 v[208:223], v[20:23], v[156:159], v[208:223]
    s_waitcnt lgkmcnt(2)
    v_mfma_f32_32x32x16_bf16 v[224:239], v[24:27], v[156:159], v[224:239]
    s_waitcnt lgkmcnt(0)
    v_mfma_f32_32x32x16_bf16 v[240:255], v[28:31], v[156:159], v[240:255]
    s_waitcnt vmcnt(12)
    s_barrier
    s_add_u32 m0, s38, 0
    s_add_u32 s34, s28, 196608
    buffer_load_dwordx4 v2, s[8:11], s34 offen offset:0 nt lds
    buffer_load_dwordx4 v3, s[8:11], s34 offen offset:1024 nt lds
    buffer_load_dwordx4 v4, s[8:11], s34 offen offset:2048 nt lds
    buffer_load_dwordx4 v5, s[8:11], s34 offen offset:3072 nt lds
    s_add_u32 m0, s38, 49152
    s_add_u32 s34, s28, 196608
    buffer_load_dwordx4 v6, s[12:15], s34 offen offset:0 nt lds
    buffer_load_dwordx4 v6, s[12:15], s34 offen offset:1024 nt lds
    buffer_load_dwordx4 v6, s[12:15], s34 offen offset:2048 nt lds
    buffer_load_dwordx4 v6, s[12:15], s34 offen offset:3072 nt lds
    v_add_u32 v12, 147456, v8
    v_add_u32 v13, 147456, v9
    v_add_u32 v14, 147456, v10
    v_add_u32 v15, 147456, v11
    ds_read_b64_tr_b16 v[16:17], v12 offset:0
    ds_read_b64_tr_b16 v[18:19], v12 offset:1024
    ds_read_b64_tr_b16 v[20:21], v13 offset:0
    ds_read_b64_tr_b16 v[22:23], v13 offset:1024
    ds_read_b64_tr_b16 v[24:25], v14 offset:0
    ds_read_b64_tr_b16 v[26:27], v14 offset:1024
    ds_read_b64_tr_b16 v[28:29], v15 offset:0
    ds_read_b64_tr_b16 v[30:31], v15 offset:1024
    ds_read_b64_tr_b16 v[144:145], v12 offset:4096
    ds_read_b64_tr_b16 v[146:147], v12 offset:5120
    ds_read_b64_tr_b16 v[148:149], v13 offset:4096
    ds_read_b64_tr_b16 v[150:151], v13 offset:5120
    ds_read_b64_tr_b16 v[152:153], v14 offset:4096
    ds_read_b64_tr_b16 v[154:155], v14 offset:5120
    s_waitcnt lgkmcnt(12)
    v_mfma_f32_32x32x16_bf16 v[192:207], v[16:19], v[160:163], v[192:207]
    ds_read_b64_tr_b16 v[156:157], v15 offset:4096
    ds_read_b64_tr_b16 v[158:159], v15 offset:5120
    s_waitcnt lgkmcnt(12)
    v_mfma_f32_32x32x16_bf16 v[208:223], v[20:23], v[160:163], v[208:223]
    ds_read_b64_tr_b16 v[128:129], v12 offset:8192
    ds_read_b64_tr_b16 v[130:131], v12 offset:9216
    s_waitcnt lgkmcnt(12)
    v_mfma_f32_32x32x16_bf16 v[224:239], v[24:27], v[160:163], v[224:239]
    ds_read_b64_tr_b16 v[132:133], v13 offset:8192
    ds_read_b64_tr_b16 v[134:135], v13 offset:9216
    s_waitcnt lgkmcnt(12)
    v_mfma_f32_32x32x16_bf16 v[240:255], v[28:31], v[160:163], v[240:255]
    ds_read_b64_tr_b16 v[136:137], v14 offset:8192
    ds_read_b64_tr_b16 v[138:139], v14 offset:9216
    s_waitcnt lgkmcnt(12)
    v_mfma_f32_32x32x16_bf16 v[192:207], v[144:147], v[164:167], v[192:207]
    ds_read_b64_tr_b16 v[140:141], v15 offset:8192
    ds_read_b64_tr_b16 v[142:143], v15 offset:9216
    s_waitcnt lgkmcnt(12)
    v_mfma_f32_32x32x16_bf16 v[208:223], v[148:151], v[164:167], v[208:223]
    ds_read_b64_tr_b16 v[16:17], v12 offset:12288
    ds_read_b64_tr_b16 v[18:19], v12 offset:13312
    s_waitcnt lgkmcnt(12)
    v_mfma_f32_32x32x16_bf16 v[224:239], v[152:155], v[164:167], v[224:239]
    ds_read_b64_tr_b16 v[20:21], v13 offset:12288
    ds_read_b64_tr_b16 v[22:23], v13 offset:13312
    s_waitcnt lgkmcnt(12)
    v_mfma_f32_32x32x16_bf16 v[240:255], v[156:159], v[164:167], v[240:255]
    ds_read_b64_tr_b16 v[24:25], v14 offset:12288
    ds_read_b64_tr_b16 v[26:27], v14 offset:13312
    s_waitcnt lgkmcnt(12)
    v_mfma_f32_32x32x16_bf16 v[192:207], v[128:131], v[168:171], v[192:207]
    ds_read_b64_tr_b16 v[28:29], v15 offset:12288
    ds_read_b64_tr_b16 v[30:31], v15 offset:13312
    s_waitcnt lgkmcnt(12)
    v_mfma_f32_32x32x16_bf16 v[208:223], v[132:135], v[168:171], v[208:223]
    s_waitcnt lgkmcnt(10)
    v_mfma_f32_32x32x16_bf16 v[224:239], v[136:139], v[168:171], v[224:239]
    s_waitcnt lgkmcnt(8)
    v_mfma_f32_32x32x16_bf16 v[240:255], v[140:143], v[168:171], v[240:255]
    s_waitcnt lgkmcnt(6)
    v_mfma_f32_32x32x16_bf16 v[192:207], v[16:19], v[172:175], v[192:207]
    s_waitcnt lgkmcnt(4)
    v_mfma_f32_32x32x16_bf16 v[208:223], v[20:23], v[172:175], v[208:223]
    s_waitcnt lgkmcnt(2)
    v_mfma_f32_32x32x16_bf16 v[224:239], v[24:27], v[172:175], v[224:239]
    s_waitcnt lgkmcnt(0)
    v_mfma_f32_32x32x16_bf16 v[240:255], v[28:31], v[172:175], v[240:255]
    s_waitcnt vmcnt(8)
    s_barrier
    s_add_u32 m0, s38, 16384
    s_add_u32 s34, s28, 212992
    buffer_load_dwordx4 v2, s[8:11], s34 offen offset:0 nt lds
    buffer_load_dwordx4 v3, s[8:11], s34 offen offset:1024 nt lds
    buffer_load_dwordx4 v4, s[8:11], s34 offen offset:2048 nt lds
    buffer_load_dwordx4 v5, s[8:11], s34 offen offset:3072 nt lds
    s_add_u32 m0, s38, 65536
    s_add_u32 s34, s28, 212992
    buffer_load_dwordx4 v6, s[12:15], s34 offen offset:0 nt lds
    buffer_load_dwordx4 v6, s[12:15], s34 offen offset:1024 nt lds
    buffer_load_dwordx4 v6, s[12:15], s34 offen offset:2048 nt lds
    buffer_load_dwordx4 v6, s[12:15], s34 offen offset:3072 nt lds
    v_add_u32 v12, 114688, v8
    v_add_u32 v13, 114688, v9
    v_add_u32 v14, 114688, v10
    v_add_u32 v15, 114688, v11
    ds_read_b64_tr_b16 v[16:17], v12 offset:0
    ds_read_b64_tr_b16 v[18:19], v12 offset:1024
    ds_read_b64_tr_b16 v[20:21], v13 offset:0
    ds_read_b64_tr_b16 v[22:23], v13 offset:1024
    ds_read_b64_tr_b16 v[24:25], v14 offset:0
    ds_read_b64_tr_b16 v[26:27], v14 offset:1024
    ds_read_b64_tr_b16 v[28:29], v15 offset:0
    ds_read_b64_tr_b16 v[30:31], v15 offset:1024
    ds_read_b64_tr_b16 v[160:161], v12 offset:4096
    ds_read_b64_tr_b16 v[162:163], v12 offset:5120
    ds_read_b64_tr_b16 v[164:165], v13 offset:4096
    ds_read_b64_tr_b16 v[166:167], v13 offset:5120
    ds_read_b64_tr_b16 v[168:169], v14 offset:4096
    ds_read_b64_tr_b16 v[170:171], v14 offset:5120
    s_waitcnt lgkmcnt(12)
    v_mfma_f32_32x32x16_bf16 v[192:207], v[16:19], v[176:179], v[192:207]
    ds_read_b64_tr_b16 v[172:173], v15 offset:4096
    ds_read_b64_tr_b16 v[174:175], v15 offset:5120
    s_waitcnt lgkmcnt(12)
    v_mfma_f32_32x32x16_bf16 v[208:223], v[20:23], v[176:179], v[208:223]
    ds_read_b64_tr_b16 v[144:145], v12 offset:8192
    ds_read_b64_tr_b16 v[146:147], v12 offset:9216
    s_waitcnt lgkmcnt(12)
    v_mfma_f32_32x32x16_bf16 v[224:239], v[24:27], v[176:179], v[224:239]
    ds_read_b64_tr_b16 v[148:149], v13 offset:8192
    ds_read_b64_tr_b16 v[150:151], v13 offset:9216
    s_waitcnt lgkmcnt(12)
    v_mfma_f32_32x32x16_bf16 v[240:255], v[28:31], v[176:179], v[240:255]
    ds_read_b64_tr_b16 v[152:153], v14 offset:8192
    ds_read_b64_tr_b16 v[154:155], v14 offset:9216
    s_waitcnt lgkmcnt(12)
    v_mfma_f32_32x32x16_bf16 v[192:207], v[160:163], v[180:183], v[192:207]
    ds_read_b64_tr_b16 v[156:157], v15 offset:8192
    ds_read_b64_tr_b16 v[158:159], v15 offset:9216
    s_waitcnt lgkmcnt(12)
    v_mfma_f32_32x32x16_bf16 v[208:223], v[164:167], v[180:183], v[208:223]
    ds_read_b64_tr_b16 v[16:17], v12 offset:12288
    ds_read_b64_tr_b16 v[18:19], v12 offset:13312
    s_waitcnt lgkmcnt(12)
    v_mfma_f32_32x32x16_bf16 v[224:239], v[168:171], v[180:183], v[224:239]
    ds_read_b64_tr_b16 v[20:21], v13 offset:12288
    ds_read_b64_tr_b16 v[22:23], v13 offset:13312
    s_waitcnt lgkmcnt(12)
    v_mfma_f32_32x32x16_bf16 v[240:255], v[172:175], v[180:183], v[240:255]
    ds_read_b64_tr_b16 v[24:25], v14 offset:12288
    ds_read_b64_tr_b16 v[26:27], v14 offset:13312
    s_waitcnt lgkmcnt(12)
    v_mfma_f32_32x32x16_bf16 v[192:207], v[144:147], v[184:187], v[192:207]
    ds_read_b64_tr_b16 v[28:29], v15 offset:12288
    ds_read_b64_tr_b16 v[30:31], v15 offset:13312
    s_waitcnt lgkmcnt(12)
    v_mfma_f32_32x32x16_bf16 v[208:223], v[148:151], v[184:187], v[208:223]
    s_waitcnt lgkmcnt(10)
    v_mfma_f32_32x32x16_bf16 v[224:239], v[152:155], v[184:187], v[224:239]
    s_waitcnt lgkmcnt(8)
    v_mfma_f32_32x32x16_bf16 v[240:255], v[156:159], v[184:187], v[240:255]
    s_waitcnt lgkmcnt(6)
    v_mfma_f32_32x32x16_bf16 v[192:207], v[16:19], v[188:191], v[192:207]
    s_waitcnt lgkmcnt(4)
    v_mfma_f32_32x32x16_bf16 v[208:223], v[20:23], v[188:191], v[208:223]
    s_waitcnt lgkmcnt(2)
    v_mfma_f32_32x32x16_bf16 v[224:239], v[24:27], v[188:191], v[224:239]
    s_waitcnt lgkmcnt(0)
    v_mfma_f32_32x32x16_bf16 v[240:255], v[28:31], v[188:191], v[240:255]
    s_waitcnt vmcnt(8)
    s_barrier
    s_add_u32 m0, s38, 32768
    s_add_u32 s34, s28, 229376
    buffer_load_dwordx4 v2, s[8:11], s34 offen offset:0 nt lds
    buffer_load_dwordx4 v3, s[8:11], s34 offen offset:1024 nt lds
    buffer_load_dwordx4 v4, s[8:11], s34 offen offset:2048 nt lds
    buffer_load_dwordx4 v5, s[8:11], s34 offen offset:3072 nt lds
    s_add_u32 m0, s38, 81920
    s_add_u32 s34, s28, 229376
    buffer_load_dwordx4 v6, s[12:15], s34 offen offset:0 nt lds
    buffer_load_dwordx4 v6, s[12:15], s34 offen offset:1024 nt lds
    buffer_load_dwordx4 v6, s[12:15], s34 offen offset:2048 nt lds
    buffer_load_dwordx4 v6, s[12:15], s34 offen offset:3072 nt lds
    s_nop 15
    v_mul_f32 v192, s33, v192
    v_mul_f32 v193, s33, v193
    v_cvt_pk_bf16_f32 v32, v192, v193
    v_mul_f32 v194, s33, v194
    v_mul_f32 v195, s33, v195
    v_cvt_pk_bf16_f32 v33, v194, v195
    v_mul_f32 v196, s33, v196
    v_mul_f32 v197, s33, v197
    v_cvt_pk_bf16_f32 v34, v196, v197
    v_mul_f32 v198, s33, v198
    v_mul_f32 v199, s33, v199
    v_cvt_pk_bf16_f32 v35, v198, v199
    v_mul_f32 v200, s33, v200
    v_mul_f32 v201, s33, v201
    v_cvt_pk_bf16_f32 v36, v200, v201
    v_mul_f32 v202, s33, v202
    v_mul_f32 v203, s33, v203
    v_cvt_pk_bf16_f32 v37, v202, v203
    v_mul_f32 v204, s33, v204
    v_mul_f32 v205, s33, v205
    v_cvt_pk_bf16_f32 v38, v204, v205
    v_mul_f32 v206, s33, v206
    v_mul_f32 v207, s33, v207
    v_cvt_pk_bf16_f32 v39, v206, v207
    v_mul_f32 v208, s33, v208
    v_mul_f32 v209, s33, v209
    v_cvt_pk_bf16_f32 v40, v208, v209
    v_mul_f32 v210, s33, v210
    v_mul_f32 v211, s33, v211
    v_cvt_pk_bf16_f32 v41, v210, v211
    v_mul_f32 v212, s33, v212
    v_mul_f32 v213, s33, v213
    v_cvt_pk_bf16_f32 v42, v212, v213
    v_mul_f32 v214, s33, v214
    v_mul_f32 v215, s33, v215
    v_cvt_pk_bf16_f32 v43, v214, v215
    v_mul_f32 v216, s33, v216
    v_mul_f32 v217, s33, v217
    v_cvt_pk_bf16_f32 v44, v216, v217
    v_mul_f32 v218, s33, v218
    v_mul_f32 v219, s33, v219
    v_cvt_pk_bf16_f32 v45, v218, v219
    v_mul_f32 v220, s33, v220
    v_mul_f32 v221, s33, v221
    v_cvt_pk_bf16_f32 v46, v220, v221
    v_mul_f32 v222, s33, v222
    v_mul_f32 v223, s33, v223
    v_cvt_pk_bf16_f32 v47, v222, v223
    v_mul_f32 v224, s33, v224
    v_mul_f32 v225, s33, v225
    v_cvt_pk_bf16_f32 v48, v224, v225
    v_mul_f32 v226, s33, v226
    v_mul_f32 v227, s33, v227
    v_cvt_pk_bf16_f32 v49, v226, v227
    v_mul_f32 v228, s33, v228
    v_mul_f32 v229, s33, v229
    v_cvt_pk_bf16_f32 v50, v228, v229
    v_mul_f32 v230, s33, v230
    v_mul_f32 v231, s33, v231
    v_cvt_pk_bf16_f32 v51, v230, v231
    v_mul_f32 v232, s33, v232
    v_mul_f32 v233, s33, v233
    v_cvt_pk_bf16_f32 v52, v232, v233
    v_mul_f32 v234, s33, v234
    v_mul_f32 v235, s33, v235
    v_cvt_pk_bf16_f32 v53, v234, v235
    v_mul_f32 v236, s33, v236
    v_mul_f32 v237, s33, v237
    v_cvt_pk_bf16_f32 v54, v236, v237
    v_mul_f32 v238, s33, v238
    v_mul_f32 v239, s33, v239
    v_cvt_pk_bf16_f32 v55, v238, v239
    v_mul_f32 v240, s33, v240
    v_mul_f32 v241, s33, v241
    v_cvt_pk_bf16_f32 v56, v240, v241
    v_mul_f32 v242, s33, v242
    v_mul_f32 v243, s33, v243
    v_cvt_pk_bf16_f32 v57, v242, v243
    v_mul_f32 v244, s33, v244
    v_mul_f32 v245, s33, v245
    v_cvt_pk_bf16_f32 v58, v244, v245
    v_mul_f32 v246, s33, v246
    v_mul_f32 v247, s33, v247
    v_cvt_pk_bf16_f32 v59, v246, v247
    v_mul_f32 v248, s33, v248
    v_mul_f32 v249, s33, v249
    v_cvt_pk_bf16_f32 v60, v248, v249
    v_mul_f32 v250, s33, v250
    v_mul_f32 v251, s33, v251
    v_cvt_pk_bf16_f32 v61, v250, v251
    v_mul_f32 v252, s33, v252
    v_mul_f32 v253, s33, v253
    v_cvt_pk_bf16_f32 v62, v252, v253
    v_mul_f32 v254, s33, v254
    v_mul_f32 v255, s33, v255
    v_cvt_pk_bf16_f32 v63, v254, v255
    s_lshl_b32 s34, s5, 13
    s_add_u32 s34, s34, 131072
    v_lshlrev_b32 v12, 4, v1
    v_add_u32 v12, s34, v12
    ds_write_b128 v12, v[32:35] offset:0
    ds_write_b128 v12, v[36:39] offset:1024
    ds_write_b128 v12, v[40:43] offset:2048
    ds_write_b128 v12, v[44:47] offset:3072
    ds_write_b128 v12, v[48:51] offset:4096
    ds_write_b128 v12, v[52:55] offset:5120
    ds_write_b128 v12, v[56:59] offset:6144
    ds_write_b128 v12, v[60:63] offset:7168
    s_waitcnt lgkmcnt(0)
    s_waitcnt vmcnt(8)
    s_barrier
    s_add_u32 m0, s38, 0
    s_add_u32 s34, s28, 245760
    buffer_load_dwordx4 v2, s[8:11], s34 offen offset:0 nt lds
    buffer_load_dwordx4 v3, s[8:11], s34 offen offset:1024 nt lds
    buffer_load_dwordx4 v4, s[8:11], s34 offen offset:2048 nt lds
    buffer_load_dwordx4 v5, s[8:11], s34 offen offset:3072 nt lds
    s_add_u32 m0, s38, 98304
    s_add_u32 s34, s28, 245760
    buffer_load_dwordx4 v6, s[12:15], s34 offen offset:0 nt lds
    buffer_load_dwordx4 v6, s[12:15], s34 offen offset:1024 nt lds
    buffer_load_dwordx4 v6, s[12:15], s34 offen offset:2048 nt lds
    buffer_load_dwordx4 v6, s[12:15], s34 offen offset:3072 nt lds
    s_waitcnt vmcnt(8)
    s_barrier
    s_add_u32 m0, s38, 16384
    s_add_u32 s34, s28, 4194304
    buffer_load_dwordx4 v2, s[8:11], s34 offen offset:0 nt lds
    buffer_load_dwordx4 v3, s[8:11], s34 offen offset:1024 nt lds
    buffer_load_dwordx4 v4, s[8:11], s34 offen offset:2048 nt lds
    buffer_load_dwordx4 v5, s[8:11], s34 offen offset:3072 nt lds
    s_add_u32 m0, s38, 49152
    s_add_u32 s34, s28, 4194304
    buffer_load_dwordx4 v6, s[12:15], s34 offen offset:0 nt lds
    buffer_load_dwordx4 v6, s[12:15], s34 offen offset:1024 nt lds
    buffer_load_dwordx4 v6, s[12:15], s34 offen offset:2048 nt lds
    buffer_load_dwordx4 v6, s[12:15], s34 offen offset:3072 nt lds
    s_waitcnt vmcnt(8)
    s_barrier
    s_add_u32 m0, s38, 32768
    s_add_u32 s34, s28, 4210688
    buffer_load_dwordx4 v2, s[8:11], s34 offen offset:0 nt lds
    buffer_load_dwordx4 v3, s[8:11], s34 offen offset:1024 nt lds
    buffer_load_dwordx4 v4, s[8:11], s34 offen offset:2048 nt lds
    buffer_load_dwordx4 v5, s[8:11], s34 offen offset:3072 nt lds
    s_add_u32 m0, s38, 65536
    s_add_u32 s34, s28, 4210688
    buffer_load_dwordx4 v6, s[12:15], s34 offen offset:0 nt lds
    buffer_load_dwordx4 v6, s[12:15], s34 offen offset:1024 nt lds
    buffer_load_dwordx4 v6, s[12:15], s34 offen offset:2048 nt lds
    buffer_load_dwordx4 v6, s[12:15], s34 offen offset:3072 nt lds
    s_waitcnt vmcnt(8)
    s_barrier
    s_add_u32 m0, s38, 0
    s_add_u32 s34, s28, 4227072
    buffer_load_dwordx4 v2, s[8:11], s34 offen offset:0 nt lds
    buffer_load_dwordx4 v3, s[8:11], s34 offen offset:1024 nt lds
    buffer_load_dwordx4 v4, s[8:11], s34 offen offset:2048 nt lds
    buffer_load_dwordx4 v5, s[8:11], s34 offen offset:3072 nt lds
    s_add_u32 m0, s38, 81920
    s_add_u32 s34, s28, 4227072
    buffer_load_dwordx4 v6, s[12:15], s34 offen offset:0 nt lds
    buffer_load_dwordx4 v6, s[12:15], s34 offen offset:1024 nt lds
    buffer_load_dwordx4 v6, s[12:15], s34 offen offset:2048 nt lds
    buffer_load_dwordx4 v6, s[12:15], s34 offen offset:3072 nt lds
    s_waitcnt vmcnt(8)
    s_barrier
    s_add_u32 m0, s38, 16384
    s_add_u32 s34, s28, 4243456
    buffer_load_dwordx4 v2, s[8:11], s34 offen offset:0 nt lds
    buffer_load_dwordx4 v3, s[8:11], s34 offen offset:1024 nt lds
    buffer_load_dwordx4 v4, s[8:11], s34 offen offset:2048 nt lds
    buffer_load_dwordx4 v5, s[8:11], s34 offen offset:3072 nt lds
    s_add_u32 m0, s38, 98304
    s_add_u32 s34, s28, 4243456
    buffer_load_dwordx4 v6, s[12:15], s34 offen offset:0 nt lds
    buffer_load_dwordx4 v6, s[12:15], s34 offen offset:1024 nt lds
    buffer_load_dwordx4 v6, s[12:15], s34 offen offset:2048 nt lds
    buffer_load_dwordx4 v6, s[12:15], s34 offen offset:3072 nt lds
    v_mov_b32 v10, 124928
    v_mov_b32 v11, 0
    ds_write_b32 v10, v11
    s_waitcnt lgkmcnt(0)
    s_waitcnt vmcnt(8)
    s_barrier
    s_cmp_eq_u32 s5, 0
    s_cbranch_scc0 L_sig_a
    s_and_b32 s34, s97, 31
    s_lshl_b32 s35, 1, s34
    s_lshr_b32 s34, s97, 5
    s_lshl_b32 s34, s34, 4
    v_mov_b32 v15, s35
    v_mov_b32 v13, s34
    s_mov_b64 exec, 1
    buffer_atomic_or v15, v13, s[84:87], 0 offen sc1
    s_mov_b64 exec, -1
L_sig_a:
    s_add_u32 m0, s38, 32768
    s_add_u32 s34, s28, 4259840
    buffer_load_dwordx4 v2, s[8:11], s34 offen offset:0 nt lds
    buffer_load_dwordx4 v3, s[8:11], s34 offen offset:1024 nt lds
    buffer_load_dwordx4 v4, s[8:11], s34 offen offset:2048 nt lds
    buffer_load_dwordx4 v5, s[8:11], s34 offen offset:3072 nt lds
    s_add_u32 m0, s38, 49152
    s_add_u32 s34, s28, 4259840
    buffer_load_dwordx4 v6, s[12:15], s34 offen offset:0 nt lds
    buffer_load_dwordx4 v6, s[12:15], s34 offen offset:1024 nt lds
    buffer_load_dwordx4 v6, s[12:15], s34 offen offset:2048 nt lds
    buffer_load_dwordx4 v6, s[12:15], s34 offen offset:3072 nt lds
    s_waitcnt vmcnt(8)
    s_barrier
    s_add_u32 m0, s38, 0
    s_add_u32 s34, s28, 4276224
    buffer_load_dwordx4 v2, s[8:11], s34 offen offset:0 nt lds
    buffer_load_dwordx4 v3, s[8:11], s34 offen offset:1024 nt lds
    buffer_load_dwordx4 v4, s[8:11], s34 offen offset:2048 nt lds
    buffer_load_dwordx4 v5, s[8:11], s34 offen offset:3072 nt lds
    s_add_u32 m0, s38, 65536
    s_add_u32 s34, s28, 4276224
    buffer_load_dwordx4 v6, s[12:15], s34 offen offset:0 nt lds
    buffer_load_dwordx4 v6, s[12:15], s34 offen offset:1024 nt lds
    buffer_load_dwordx4 v6, s[12:15], s34 offen offset:2048 nt lds
    buffer_load_dwordx4 v6, s[12:15], s34 offen offset:3072 nt lds
    s_waitcnt vmcnt(8)
    s_barrier
    s_add_u32 m0, s38, 16384
    s_add_u32 s34, s28, 4292608
    buffer_load_dwordx4 v2, s[8:11], s34 offen offset:0 nt lds
    buffer_load_dwordx4 v3, s[8:11], s34 offen offset:1024 nt lds
    buffer_load_dwordx4 v4, s[8:11], s34 offen offset:2048 nt lds
    buffer_load_dwordx4 v5, s[8:11], s34 offen offset:3072 nt lds
    s_add_u32 m0, s38, 81920
    s_add_u32 s34, s28, 4292608
    buffer_load_dwordx4 v6, s[12:15], s34 offen offset:0 nt lds
    buffer_load_dwordx4 v6, s[12:15], s34 offen offset:1024 nt lds
    buffer_load_dwordx4 v6, s[12:15], s34 offen offset:2048 nt lds
    buffer_load_dwordx4 v6, s[12:15], s34 offen offset:3072 nt lds
    s_waitcnt vmcnt(8)
    s_barrier
    s_add_u32 m0, s38, 32768
    s_add_u32 s34, s28, 4308992
    buffer_load_dwordx4 v2, s[8:11], s34 offen offset:0 nt lds
    buffer_load_dwordx4 v3, s[8:11], s34 offen offset:1024 nt lds
    buffer_load_dwordx4 v4, s[8:11], s34 offen offset:2048 nt lds
    buffer_load_dwordx4 v5, s[8:11], s34 offen offset:3072 nt lds
    s_add_u32 m0, s38, 98304
    s_add_u32 s34, s28, 4308992
    buffer_load_dwordx4 v6, s[12:15], s34 offen offset:0 nt lds
    buffer_load_dwordx4 v6, s[12:15], s34 offen offset:1024 nt lds
    buffer_load_dwordx4 v6, s[12:15], s34 offen offset:2048 nt lds
    buffer_load_dwordx4 v6, s[12:15], s34 offen offset:3072 nt lds
    s_waitcnt vmcnt(8)
    s_barrier
    s_add_u32 m0, s38, 0
    s_add_u32 s34, s28, 4325376
    buffer_load_dwordx4 v2, s[8:11], s34 offen offset:0 nt lds
    buffer_load_dwordx4 v3, s[8:11], s34 offen offset:1024 nt lds
    buffer_load_dwordx4 v4, s[8:11], s34 offen offset:2048 nt lds
    buffer_load_dwordx4 v5, s[8:11], s34 offen offset:3072 nt lds
    s_add_u32 m0, s38, 49152
    s_add_u32 s34, s28, 4325376
    buffer_load_dwordx4 v6, s[12:15], s34 offen offset:0 nt lds
    buffer_load_dwordx4 v6, s[12:15], s34 offen offset:1024 nt lds
    buffer_load_dwordx4 v6, s[12:15], s34 offen offset:2048 nt lds
    buffer_load_dwordx4 v6, s[12:15], s34 offen offset:3072 nt lds
    s_waitcnt vmcnt(8)
    s_barrier
    s_add_u32 m0, s38, 16384
    s_add_u32 s34, s28, 4341760
    buffer_load_dwordx4 v2, s[8:11], s34 offen offset:0 nt lds
    buffer_load_dwordx4 v3, s[8:11], s34 offen offset:1024 nt lds
    buffer_load_dwordx4 v4, s[8:11], s34 offen offset:2048 nt lds
    buffer_load_dwordx4 v5, s[8:11], s34 offen offset:3072 nt lds
    s_add_u32 m0, s38, 65536
    s_add_u32 s34, s28, 4341760
    buffer_load_dwordx4 v6, s[12:15], s34 offen offset:0 nt lds
    buffer_load_dwordx4 v6, s[12:15], s34 offen offset:1024 nt lds
    buffer_load_dwordx4 v6, s[12:15], s34 offen offset:2048 nt lds
    buffer_load_dwordx4 v6, s[12:15], s34 offen offset:3072 nt lds
    s_waitcnt vmcnt(8)
    s_barrier
    s_add_u32 m0, s38, 32768
    s_add_u32 s34, s28, 4358144
    buffer_load_dwordx4 v2, s[8:11], s34 offen offset:0 nt lds
    buffer_load_dwordx4 v3, s[8:11], s34 offen offset:1024 nt lds
    buffer_load_dwordx4 v4, s[8:11], s34 offen offset:2048 nt lds
    buffer_load_dwordx4 v5, s[8:11], s34 offen offset:3072 nt lds
    s_add_u32 m0, s38, 81920
    s_add_u32 s34, s28, 4358144
    buffer_load_dwordx4 v6, s[12:15], s34 offen offset:0 nt lds
    buffer_load_dwordx4 v6, s[12:15], s34 offen offset:1024 nt lds
    buffer_load_dwordx4 v6, s[12:15], s34 offen offset:2048 nt lds
    buffer_load_dwordx4 v6, s[12:15], s34 offen offset:3072 nt lds
    s_waitcnt vmcnt(8)
    s_barrier
    s_add_u32 m0, s38, 0
    s_add_u32 s34, s28, 4374528
    buffer_load_dwordx4 v2, s[8:11], s34 offen offset:0 nt lds
    buffer_load_dwordx4 v3, s[8:11], s34 offen offset:1024 nt lds
    buffer_load_dwordx4 v4, s[8:11], s34 offen offset:2048 nt lds
    buffer_load_dwordx4 v5, s[8:11], s34 offen offset:3072 nt lds
    s_add_u32 m0, s38, 98304
    s_add_u32 s34, s28, 4374528
    buffer_load_dwordx4 v6, s[12:15], s34 offen offset:0 nt lds
    buffer_load_dwordx4 v6, s[12:15], s34 offen offset:1024 nt lds
    buffer_load_dwordx4 v6, s[12:15], s34 offen offset:2048 nt lds
    buffer_load_dwordx4 v6, s[12:15], s34 offen offset:3072 nt lds
    s_waitcnt vmcnt(8)
    s_barrier
    s_add_u32 m0, s38, 16384
    s_add_u32 s34, s28, 4390912
    buffer_load_dwordx4 v2, s[8:11], s34 offen offset:0 nt lds
    buffer_load_dwordx4 v3, s[8:11], s34 offen offset:1024 nt lds
    buffer_load_dwordx4 v4, s[8:11], s34 offen offset:2048 nt lds
    buffer_load_dwordx4 v5, s[8:11], s34 offen offset:3072 nt lds
    s_add_u32 m0, s38, 49152
    s_add_u32 s34, s28, 4390912
    buffer_load_dwordx4 v6, s[12:15], s34 offen offset:0 nt lds
    buffer_load_dwordx4 v6, s[12:15], s34 offen offset:1024 nt lds
    buffer_load_dwordx4 v6, s[12:15], s34 offen offset:2048 nt lds
    buffer_load_dwordx4 v6, s[12:15], s34 offen offset:3072 nt lds
    s_waitcnt vmcnt(8)
    s_barrier
    s_add_u32 m0, s38, 32768
    s_add_u32 s34, s28, 4407296
    buffer_load_dwordx4 v2, s[8:11], s34 offen offset:0 nt lds
    buffer_load_dwordx4 v3, s[8:11], s34 offen offset:1024 nt lds
    buffer_load_dwordx4 v4, s[8:11], s34 offen offset:2048 nt lds
    buffer_load_dwordx4 v5, s[8:11], s34 offen offset:3072 nt lds
    s_add_u32 m0, s38, 65536
    s_add_u32 s34, s28, 4407296
    buffer_load_dwordx4 v6, s[12:15], s34 offen offset:0 nt lds
    buffer_load_dwordx4 v6, s[12:15], s34 offen offset:1024 nt lds
    buffer_load_dwordx4 v6, s[12:15], s34 offen offset:2048 nt lds
    buffer_load_dwordx4 v6, s[12:15], s34 offen offset:3072 nt lds
    s_waitcnt vmcnt(8)
    s_barrier
    s_add_u32 m0, s38, 0
    s_add_u32 s34, s28, 4423680
    buffer_load_dwordx4 v2, s[8:11], s34 offen offset:0 nt lds
    buffer_load_dwordx4 v3, s[8:11], s34 offen offset:1024 nt lds
    buffer_load_dwordx4 v4, s[8:11], s34 offen offset:2048 nt lds
    buffer_load_dwordx4 v5, s[8:11], s34 offen offset:3072 nt lds
    s_add_u32 m0, s38, 81920
    s_add_u32 s34, s28, 4423680
    buffer_load_dwordx4 v6, s[12:15], s34 offen offset:0 nt lds
    buffer_load_dwordx4 v6, s[12:15], s34 offen offset:1024 nt lds
    buffer_load_dwordx4 v6, s[12:15], s34 offen offset:2048 nt lds
    buffer_load_dwordx4 v6, s[12:15], s34 offen offset:3072 nt lds
    s_waitcnt vmcnt(8)
    s_barrier
    s_add_u32 m0, s38, 16384
    s_add_u32 s34, s28, 4440064
    buffer_load_dwordx4 v2, s[8:11], s34 offen offset:0 nt lds
    buffer_load_dwordx4 v3, s[8:11], s34 offen offset:1024 nt lds
    buffer_load_dwordx4 v4, s[8:11], s34 offen offset:2048 nt lds
    buffer_load_dwordx4 v5, s[8:11], s34 offen offset:3072 nt lds
    s_add_u32 m0, s38, 98304
    s_add_u32 s34, s28, 4440064
    buffer_load_dwordx4 v6, s[12:15], s34 offen offset:0 nt lds
    buffer_load_dwordx4 v6, s[12:15], s34 offen offset:1024 nt lds
    buffer_load_dwordx4 v6, s[12:15], s34 offen offset:2048 nt lds
    buffer_load_dwordx4 v6, s[12:15], s34 offen offset:3072 nt lds
    s_lshr_b32 s34, s90, 1
    s_lshl_b32 s34, s34, 4
    v_mov_b32 v14, s34
    buffer_load_dword v13, v14, s[84:87], 0 offen sc1
    s_waitcnt vmcnt(9)
    s_barrier

    v_add_u32 v10, 0, v1
    v_mul_u32_u24 v11, 6554, v10
    v_lshrrev_b32 v11, 16, v11
    v_mul_u32_u24 v12, 10, v11
    v_sub_u32 v12, v10, v12
    v_mul_u32_u24 v11, 1280, v11
    v_lshl_add_u32 v11, v12, 4, v11
    v_subrev_u32 v2, 0, v11

    v_add_u32 v10, 64, v1
    v_mul_u32_u24 v11, 6554, v10
    v_lshrrev_b32 v11, 16, v11
    v_mul_u32_u24 v12, 10, v11
    v_sub_u32 v12, v10, v12
    v_mul_u32_u24 v11, 1280, v11
    v_lshl_add_u32 v11, v12, 4, v11
    v_subrev_u32 v3, 1024, v11

    v_add_u32 v10, 128, v1
    v_mul_u32_u24 v11, 6554, v10
    v_lshrrev_b32 v11, 16, v11
    v_mul_u32_u24 v12, 10, v11
    v_sub_u32 v12, v10, v12
    v_mul_u32_u24 v11, 1280, v11
    v_lshl_add_u32 v11, v12, 4, v11
    v_subrev_u32 v4, 2048, v11

    v_add_u32 v10, 192, v1
    v_mul_u32_u24 v11, 6554, v10
    v_lshrrev_b32 v11, 16, v11
    v_mul_u32_u24 v12, 10, v11
    v_sub_u32 v12, v10, v12
    v_mul_u32_u24 v11, 1280, v11
    v_lshl_add_u32 v11, v12, 4, v11
    v_subrev_u32 v5, 3072, v11

    v_add_u32 v10, 256, v1
    v_mul_u32_u24 v11, 6554, v10
    v_lshrrev_b32 v11, 16, v11
    v_mul_u32_u24 v12, 10, v11
    v_sub_u32 v12, v10, v12
    v_mul_u32_u24 v11, 1280, v11
    v_lshl_add_u32 v11, v12, 4, v11
    v_subrev_u32 v6, 0, v11

    v_lshrrev_b32 v10, 4, v1
    v_bfe_u32 v11, v1, 2, 2
    v_lshl_add_u32 v10, v10, 2, v11
    v_mul_u32_u24 v10, 160, v10
    v_and_b32 v11, 3, v1
    v_lshl_add_u32 v8, v11, 3, v10

    v_lshlrev_b32 v7, 4, v1
    v_mov_b64 v[32:33], 0
    v_mov_b64 v[34:35], 0
    v_mov_b64 v[36:37], 0
    v_mov_b64 v[38:39], 0
    v_mov_b64 v[40:41], 0
    v_mov_b64 v[42:43], 0
    v_mov_b64 v[44:45], 0
    v_mov_b64 v[46:47], 0
    v_mov_b64 v[48:49], 0
    v_mov_b64 v[50:51], 0
    v_mov_b64 v[52:53], 0
    v_mov_b64 v[54:55], 0
    v_mov_b64 v[56:57], 0
    v_mov_b64 v[58:59], 0
    v_mov_b64 v[60:61], 0
    v_mov_b64 v[62:63], 0
    v_mov_b64 v[64:65], 0
    v_mov_b64 v[66:67], 0
    v_mov_b64 v[68:69], 0
    v_mov_b64 v[70:71], 0
    v_mov_b64 v[72:73], 0
    v_mov_b64 v[74:75], 0
    v_mov_b64 v[76:77], 0
    v_mov_b64 v[78:79], 0
    v_mov_b64 v[80:81], 0
    v_mov_b64 v[82:83], 0
    v_mov_b64 v[84:85], 0
    v_mov_b64 v[86:87], 0
    v_mov_b64 v[88:89], 0
    v_mov_b64 v[90:91], 0
    v_mov_b64 v[92:93], 0
    v_mov_b64 v[94:95], 0
    v_mov_b64 v[96:97], 0
    v_mov_b64 v[98:99], 0
    v_mov_b64 v[100:101], 0
    v_mov_b64 v[102:103], 0
    v_mov_b64 v[104:105], 0
    v_mov_b64 v[106:107], 0
    v_mov_b64 v[108:109], 0
    v_mov_b64 v[110:111], 0
    s_mul_i32 s36, s5, 10
    s_add_u32 s36, s36, 24

    s_mul_i32 s89, s36, 40960
    s_mul_i32 s35, s91, 160
    s_add_u32 s89, s89, s35
    s_lshr_b32 s35, s90, 1
    s_lshl_b32 s35, s35, 7
    s_add_u32 s35, s35, s36
    s_lshl_b32 s88, s35, 13
    s_and_b32 s35, s90, 1
    s_lshl_b32 s35, s35, 12
    s_add_u32 s88, s88, s35

    s_mul_i32 s93, s5, 12288
    s_add_u32 s93, s93, 114688
    s_add_u32 s94, s93, 5120
    s_waitcnt vmcnt(0)
    v_readfirstlane_b32 s34, v13
    s_nop 1
    s_and_b32 s34, s34, 0xffff
    s_cmp_eq_u32 s34, 0xffff
    s_cbranch_scc1 L_polld_p1r
    s_mov_b32 s96, 0
L_poll_p1r:
    buffer_load_dword v13, v14, s[84:87], 0 offen sc1
    s_waitcnt vmcnt(0)
    v_readfirstlane_b32 s34, v13
    s_nop 1
    s_and_b32 s34, s34, 0xffff
    s_cmp_eq_u32 s34, 0xffff
    s_cbranch_scc1 L_polld_p1r
    s_sleep 16
    s_add_u32 s96, s96, 1
    s_cmp_lt_u32 s96, 0x40000
    s_cbranch_scc1 L_poll_p1r
L_polld_p1r:
    s_mov_b32 m0, s93
    s_nop 0
    buffer_load_dwordx4 v2, s[76:79], s89 offen offset:0 lds
    buffer_load_dwordx4 v3, s[76:79], s89 offen offset:1024 lds
    buffer_load_dwordx4 v4, s[76:79], s89 offen offset:2048 lds
    buffer_load_dwordx4 v5, s[76:79], s89 offen offset:3072 lds
    s_add_u32 m0, s93, 4096
    s_nop 0
    buffer_load_dwordx4 v6, s[76:79], s89 offen lds
    s_add_u32 s89, s89, 40960
    buffer_load_dwordx4 v[112:115], v7, s[24:27], s88 offen offset:0 sc1
    buffer_load_dwordx4 v[116:119], v7, s[24:27], s88 offen offset:1024 sc1
    buffer_load_dwordx4 v[120:123], v7, s[24:27], s88 offen offset:2048 sc1
    buffer_load_dwordx4 v[124:127], v7, s[24:27], s88 offen offset:3072 sc1
    s_add_u32 s88, s88, 8192
    s_waitcnt vmcnt(10)
    s_barrier
    s_mov_b32 m0, s94
    s_nop 0
    buffer_load_dwordx4 v2, s[76:79], s89 offen offset:0 lds
    buffer_load_dwordx4 v3, s[76:79], s89 offen offset:1024 lds
    buffer_load_dwordx4 v4, s[76:79], s89 offen offset:2048 lds
    buffer_load_dwordx4 v5, s[76:79], s89 offen offset:3072 lds
    s_add_u32 m0, s94, 4096
    s_nop 0
    buffer_load_dwordx4 v6, s[76:79], s89 offen lds
    s_add_u32 s89, s89, 40960
    buffer_load_dwordx4 v[128:131], v7, s[24:27], s88 offen offset:0 sc1
    buffer_load_dwordx4 v[132:135], v7, s[24:27], s88 offen offset:1024 sc1
    buffer_load_dwordx4 v[136:139], v7, s[24:27], s88 offen offset:2048 sc1
    buffer_load_dwordx4 v[140:143], v7, s[24:27], s88 offen offset:3072 sc1
    s_add_u32 s88, s88, 8192
    s_barrier
    s_waitcnt vmcnt(9)
    v_add_u32 v10, s93, v8
    ds_read_b64_tr_b16 v[160:161], v10 offset:0
    ds_read_b64_tr_b16 v[162:163], v10 offset:2560
    ds_read_b64_tr_b16 v[164:165], v10 offset:32
    ds_read_b64_tr_b16 v[166:167], v10 offset:2592
    ds_read_b64_tr_b16 v[168:169], v10 offset:64
    ds_read_b64_tr_b16 v[170:171], v10 offset:2624
    ds_read_b64_tr_b16 v[172:173], v10 offset:96
    ds_read_b64_tr_b16 v[174:175], v10 offset:2656
    ds_read_b64_tr_b16 v[176:177], v10 offset:128
    ds_read_b64_tr_b16 v[178:179], v10 offset:2688
    s_waitcnt lgkmcnt(8)
    v_mfma_f32_16x16x32_bf16 v[32:35], v[160:163], v[112:115], v[32:35]
    v_mfma_f32_16x16x32_bf16 v[52:55], v[160:163], v[116:119], v[52:55]
    v_mfma_f32_16x16x32_bf16 v[72:75], v[160:163], v[120:123], v[72:75]
    v_mfma_f32_16x16x32_bf16 v[92:95], v[160:163], v[124:127], v[92:95]
    s_waitcnt lgkmcnt(6)
    v_mfma_f32_16x16x32_bf16 v[36:39], v[164:167], v[112:115], v[36:39]
    v_mfma_f32_16x16x32_bf16 v[56:59], v[164:167], v[116:119], v[56:59]
    v_mfma_f32_16x16x32_bf16 v[76:79], v[164:167], v[120:123], v[76:79]
    v_mfma_f32_16x16x32_bf16 v[96:99], v[164:167], v[124:127], v[96:99]
    s_waitcnt lgkmcnt(4)
    v_mfma_f32_16x16x32_bf16 v[40:43], v[168:171], v[112:115], v[40:43]
    v_mfma_f32_16x16x32_bf16 v[60:63], v[168:171], v[116:119], v[60:63]
    v_mfma_f32_16x16x32_bf16 v[80:83], v[168:171], v[120:123], v[80:83]
    v_mfma_f32_16x16x32_bf16 v[100:103], v[168:171], v[124:127], v[100:103]
    s_waitcnt lgkmcnt(2)
    v_mfma_f32_16x16x32_bf16 v[44:47], v[172:175], v[112:115], v[44:47]
    v_mfma_f32_16x16x32_bf16 v[64:67], v[172:175], v[116:119], v[64:67]
    v_mfma_f32_16x16x32_bf16 v[84:87], v[172:175], v[120:123], v[84:87]
    v_mfma_f32_16x16x32_bf16 v[104:107], v[172:175], v[124:127], v[104:107]
    s_waitcnt lgkmcnt(0)
    v_mfma_f32_16x16x32_bf16 v[48:51], v[176:179], v[112:115], v[48:51]
    v_mfma_f32_16x16x32_bf16 v[68:71], v[176:179], v[116:119], v[68:71]
    v_mfma_f32_16x16x32_bf16 v[88:91], v[176:179], v[120:123], v[88:91]
    v_mfma_f32_16x16x32_bf16 v[108:111], v[176:179], v[124:127], v[108:111]
    s_mov_b32 m0, s93
    s_nop 0
    buffer_load_dwordx4 v2, s[76:79], s89 offen offset:0 lds
    buffer_load_dwordx4 v3, s[76:79], s89 offen offset:1024 lds
    buffer_load_dwordx4 v4, s[76:79], s89 offen offset:2048 lds
    buffer_load_dwordx4 v5, s[76:79], s89 offen offset:3072 lds
    s_add_u32 m0, s93, 4096
    s_nop 0
    buffer_load_dwordx4 v6, s[76:79], s89 offen lds
    s_add_u32 s89, s89, 40960
    buffer_load_dwordx4 v[144:147], v7, s[24:27], s88 offen offset:0 sc1
    buffer_load_dwordx4 v[148:151], v7, s[24:27], s88 offen offset:1024 sc1
    buffer_load_dwordx4 v[152:155], v7, s[24:27], s88 offen offset:2048 sc1
    buffer_load_dwordx4 v[156:159], v7, s[24:27], s88 offen offset:3072 sc1
    s_add_u32 s88, s88, 8192
    s_waitcnt vmcnt(9)
    v_add_u32 v10, s94, v8
    ds_read_b64_tr_b16 v[180:181], v10 offset:0
    ds_read_b64_tr_b16 v[182:183], v10 offset:2560
    ds_read_b64_tr_b16 v[184:185], v10 offset:32
    ds_read_b64_tr_b16 v[186:187], v10 offset:2592
    ds_read_b64_tr_b16 v[188:189], v10 offset:64
    ds_read_b64_tr_b16 v[190:191], v10 offset:2624
    ds_read_b64_tr_b16 v[192:193], v10 offset:96
    ds_read_b64_tr_b16 v[194:195], v10 offset:2656
    ds_read_b64_tr_b16 v[196:197], v10 offset:128
    ds_read_b64_tr_b16 v[198:199], v10 offset:2688
    s_waitcnt lgkmcnt(8)
    v_mfma_f32_16x16x32_bf16 v[32:35], v[180:183], v[128:131], v[32:35]
    v_mfma_f32_16x16x32_bf16 v[52:55], v[180:183], v[132:135], v[52:55]
    v_mfma_f32_16x16x32_bf16 v[72:75], v[180:183], v[136:139], v[72:75]
    v_mfma_f32_16x16x32_bf16 v[92:95], v[180:183], v[140:143], v[92:95]
    s_waitcnt lgkmcnt(6)
    v_mfma_f32_16x16x32_bf16 v[36:39], v[184:187], v[128:131], v[36:39]
    v_mfma_f32_16x16x32_bf16 v[56:59], v[184:187], v[132:135], v[56:59]
    v_mfma_f32_16x16x32_bf16 v[76:79], v[184:187], v[136:139], v[76:79]
    v_mfma_f32_16x16x32_bf16 v[96:99], v[184:187], v[140:143], v[96:99]
    s_waitcnt lgkmcnt(4)
    v_mfma_f32_16x16x32_bf16 v[40:43], v[188:191], v[128:131], v[40:43]
    v_mfma_f32_16x16x32_bf16 v[60:63], v[188:191], v[132:135], v[60:63]
    v_mfma_f32_16x16x32_bf16 v[80:83], v[188:191], v[136:139], v[80:83]
    v_mfma_f32_16x16x32_bf16 v[100:103], v[188:191], v[140:143], v[100:103]
    s_waitcnt lgkmcnt(2)
    v_mfma_f32_16x16x32_bf16 v[44:47], v[192:195], v[128:131], v[44:47]
    v_mfma_f32_16x16x32_bf16 v[64:67], v[192:195], v[132:135], v[64:67]
    v_mfma_f32_16x16x32_bf16 v[84:87], v[192:195], v[136:139], v[84:87]
    v_mfma_f32_16x16x32_bf16 v[104:107], v[192:195], v[140:143], v[104:107]
    s_waitcnt lgkmcnt(0)
    v_mfma_f32_16x16x32_bf16 v[48:51], v[196:199], v[128:131], v[48:51]
    v_mfma_f32_16x16x32_bf16 v[68:71], v[196:199], v[132:135], v[68:71]
    v_mfma_f32_16x16x32_bf16 v[88:91], v[196:199], v[136:139], v[88:91]
    v_mfma_f32_16x16x32_bf16 v[108:111], v[196:199], v[140:143], v[108:111]
    s_mov_b32 m0, s94
    s_nop 0
    buffer_load_dwordx4 v2, s[76:79], s89 offen offset:0 lds
    buffer_load_dwordx4 v3, s[76:79], s89 offen offset:1024 lds
    buffer_load_dwordx4 v4, s[76:79], s89 offen offset:2048 lds
    buffer_load_dwordx4 v5, s[76:79], s89 offen offset:3072 lds
    s_add_u32 m0, s94, 4096
    s_nop 0
    buffer_load_dwordx4 v6, s[76:79], s89 offen lds
    s_add_u32 s89, s89, 40960
    buffer_load_dwordx4 v[112:115], v7, s[24:27], s88 offen offset:0 sc1
    buffer_load_dwordx4 v[116:119], v7, s[24:27], s88 offen offset:1024 sc1
    buffer_load_dwordx4 v[120:123], v7, s[24:27], s88 offen offset:2048 sc1
    buffer_load_dwordx4 v[124:127], v7, s[24:27], s88 offen offset:3072 sc1
    s_add_u32 s88, s88, 8192
    s_waitcnt vmcnt(9)
    v_add_u32 v10, s93, v8
    ds_read_b64_tr_b16 v[160:161], v10 offset:0
    ds_read_b64_tr_b16 v[162:163], v10 offset:2560
    ds_read_b64_tr_b16 v[164:165], v10 offset:32
    ds_read_b64_tr_b16 v[166:167], v10 offset:2592
    ds_read_b64_tr_b16 v[168:169], v10 offset:64
    ds_read_b64_tr_b16 v[170:171], v10 offset:2624
    ds_read_b64_tr_b16 v[172:173], v10 offset:96
    ds_read_b64_tr_b16 v[174:175], v10 offset:2656
    ds_read_b64_tr_b16 v[176:177], v10 offset:128
    ds_read_b64_tr_b16 v[178:179], v10 offset:2688
    s_waitcnt lgkmcnt(8)
    v_mfma_f32_16x16x32_bf16 v[32:35], v[160:163], v[144:147], v[32:35]
    v_mfma_f32_16x16x32_bf16 v[52:55], v[160:163], v[148:151], v[52:55]
    v_mfma_f32_16x16x32_bf16 v[72:75], v[160:163], v[152:155], v[72:75]
    v_mfma_f32_16x16x32_bf16 v[92:95], v[160:163], v[156:159], v[92:95]
    s_waitcnt lgkmcnt(6)
    v_mfma_f32_16x16x32_bf16 v[36:39], v[164:167], v[144:147], v[36:39]
    v_mfma_f32_16x16x32_bf16 v[56:59], v[164:167], v[148:151], v[56:59]
    v_mfma_f32_16x16x32_bf16 v[76:79], v[164:167], v[152:155], v[76:79]
    v_mfma_f32_16x16x32_bf16 v[96:99], v[164:167], v[156:159], v[96:99]
    s_waitcnt lgkmcnt(4)
    v_mfma_f32_16x16x32_bf16 v[40:43], v[168:171], v[144:147], v[40:43]
    v_mfma_f32_16x16x32_bf16 v[60:63], v[168:171], v[148:151], v[60:63]
    v_mfma_f32_16x16x32_bf16 v[80:83], v[168:171], v[152:155], v[80:83]
    v_mfma_f32_16x16x32_bf16 v[100:103], v[168:171], v[156:159], v[100:103]
    s_waitcnt lgkmcnt(2)
    v_mfma_f32_16x16x32_bf16 v[44:47], v[172:175], v[144:147], v[44:47]
    v_mfma_f32_16x16x32_bf16 v[64:67], v[172:175], v[148:151], v[64:67]
    v_mfma_f32_16x16x32_bf16 v[84:87], v[172:175], v[152:155], v[84:87]
    v_mfma_f32_16x16x32_bf16 v[104:107], v[172:175], v[156:159], v[104:107]
    s_waitcnt lgkmcnt(0)
    v_mfma_f32_16x16x32_bf16 v[48:51], v[176:179], v[144:147], v[48:51]
    v_mfma_f32_16x16x32_bf16 v[68:71], v[176:179], v[148:151], v[68:71]
    v_mfma_f32_16x16x32_bf16 v[88:91], v[176:179], v[152:155], v[88:91]
    v_mfma_f32_16x16x32_bf16 v[108:111], v[176:179], v[156:159], v[108:111]
    s_waitcnt vmcnt(0)
    v_add_u32 v10, s94, v8
    ds_read_b64_tr_b16 v[180:181], v10 offset:0
    ds_read_b64_tr_b16 v[182:183], v10 offset:2560
    ds_read_b64_tr_b16 v[184:185], v10 offset:32
    ds_read_b64_tr_b16 v[186:187], v10 offset:2592
    ds_read_b64_tr_b16 v[188:189], v10 offset:64
    ds_read_b64_tr_b16 v[190:191], v10 offset:2624
    ds_read_b64_tr_b16 v[192:193], v10 offset:96
    ds_read_b64_tr_b16 v[194:195], v10 offset:2656
    ds_read_b64_tr_b16 v[196:197], v10 offset:128
    ds_read_b64_tr_b16 v[198:199], v10 offset:2688
    s_waitcnt lgkmcnt(8)
    v_mfma_f32_16x16x32_bf16 v[32:35], v[180:183], v[112:115], v[32:35]
    v_mfma_f32_16x16x32_bf16 v[52:55], v[180:183], v[116:119], v[52:55]
    v_mfma_f32_16x16x32_bf16 v[72:75], v[180:183], v[120:123], v[72:75]
    v_mfma_f32_16x16x32_bf16 v[92:95], v[180:183], v[124:127], v[92:95]
    s_waitcnt lgkmcnt(6)
    v_mfma_f32_16x16x32_bf16 v[36:39], v[184:187], v[112:115], v[36:39]
    v_mfma_f32_16x16x32_bf16 v[56:59], v[184:187], v[116:119], v[56:59]
    v_mfma_f32_16x16x32_bf16 v[76:79], v[184:187], v[120:123], v[76:79]
    v_mfma_f32_16x16x32_bf16 v[96:99], v[184:187], v[124:127], v[96:99]
    s_waitcnt lgkmcnt(4)
    v_mfma_f32_16x16x32_bf16 v[40:43], v[188:191], v[112:115], v[40:43]
    v_mfma_f32_16x16x32_bf16 v[60:63], v[188:191], v[116:119], v[60:63]
    v_mfma_f32_16x16x32_bf16 v[80:83], v[188:191], v[120:123], v[80:83]
    v_mfma_f32_16x16x32_bf16 v[100:103], v[188:191], v[124:127], v[100:103]
    s_waitcnt lgkmcnt(2)
    v_mfma_f32_16x16x32_bf16 v[44:47], v[192:195], v[112:115], v[44:47]
    v_mfma_f32_16x16x32_bf16 v[64:67], v[192:195], v[116:119], v[64:67]
    v_mfma_f32_16x16x32_bf16 v[84:87], v[192:195], v[120:123], v[84:87]
    v_mfma_f32_16x16x32_bf16 v[104:107], v[192:195], v[124:127], v[104:107]
    s_waitcnt lgkmcnt(0)
    v_mfma_f32_16x16x32_bf16 v[48:51], v[196:199], v[112:115], v[48:51]
    v_mfma_f32_16x16x32_bf16 v[68:71], v[196:199], v[116:119], v[68:71]
    v_mfma_f32_16x16x32_bf16 v[88:91], v[196:199], v[120:123], v[88:91]
    v_mfma_f32_16x16x32_bf16 v[108:111], v[196:199], v[124:127], v[108:111]
    s_barrier
    s_lshr_b32 s34, s90, 1
    s_lshl_b32 s34, s34, 4
    v_mov_b32 v14, s34
    s_mul_i32 s36, s5, 10
    s_add_u32 s36, s36, 28

    s_mul_i32 s89, s36, 40960
    s_mul_i32 s35, s91, 160
    s_add_u32 s89, s89, s35
    s_lshr_b32 s35, s90, 1
    s_lshl_b32 s35, s35, 7
    s_add_u32 s35, s35, s36
    s_lshl_b32 s88, s35, 13
    s_and_b32 s35, s90, 1
    s_lshl_b32 s35, s35, 12
    s_add_u32 s88, s88, s35

    s_mov_b32 s98, s89
    s_mov_b32 s99, s88
    s_and_b32 s92, s91, 3
    s_lshl_b32 s92, s92, 1
    s_and_b32 s37, s90, 7
    s_add_u32 s92, s92, s37
    s_mov_b32 s97, s92
    s_cmp_ge_u32 s92, 6
    s_cselect_b32 s37, 6, 0
    s_sub_u32 s92, s92, s37
    s_cmp_ge_u32 s92, 6
    s_cselect_b32 s37, 6, 0
    s_sub_u32 s92, s92, s37
    s_mul_i32 s93, s3, 20480
    s_add_u32 s94, s93, 5120
    s_add_u32 s95, s93, 10240
    s_add_u32 s100, s93, 15360
    s_add_u32 s36, s92, 0
    s_cmp_ge_u32 s36, 6
    s_cselect_b32 s37, 6, 0
    s_sub_u32 s36, s36, s37
    s_mul_i32 s89, s36, 40960
    s_add_u32 s89, s89, s98
    s_mov_b32 m0, s93
    s_nop 0
    buffer_load_dwordx4 v2, s[76:79], s89 offen lds
    buffer_load_dwordx4 v3, s[76:79], s89 offen offset:1024 lds
    buffer_load_dwordx4 v4, s[76:79], s89 offen offset:2048 lds
    buffer_load_dwordx4 v5, s[76:79], s89 offen offset:3072 lds
    s_add_u32 m0, s93, 4096
    s_nop 0
    buffer_load_dwordx4 v6, s[76:79], s89 offen lds
    s_add_u32 s36, s92, 1
    s_cmp_ge_u32 s36, 6
    s_cselect_b32 s37, 6, 0
    s_sub_u32 s36, s36, s37
    s_mul_i32 s89, s36, 40960
    s_add_u32 s89, s89, s98
    s_mov_b32 m0, s94
    s_nop 0
    buffer_load_dwordx4 v2, s[76:79], s89 offen lds
    buffer_load_dwordx4 v3, s[76:79], s89 offen offset:1024 lds
    buffer_load_dwordx4 v4, s[76:79], s89 offen offset:2048 lds
    buffer_load_dwordx4 v5, s[76:79], s89 offen offset:3072 lds
    s_add_u32 m0, s94, 4096
    s_nop 0
    buffer_load_dwordx4 v6, s[76:79], s89 offen lds
    s_add_u32 s36, s92, 2
    s_cmp_ge_u32 s36, 6
    s_cselect_b32 s37, 6, 0
    s_sub_u32 s36, s36, s37
    s_mul_i32 s89, s36, 40960
    s_add_u32 s89, s89, s98
    s_mov_b32 m0, s95
    s_nop 0
    buffer_load_dwordx4 v2, s[76:79], s89 offen lds
    buffer_load_dwordx4 v3, s[76:79], s89 offen offset:1024 lds
    buffer_load_dwordx4 v4, s[76:79], s89 offen offset:2048 lds
    buffer_load_dwordx4 v5, s[76:79], s89 offen offset:3072 lds
    s_add_u32 m0, s95, 4096
    s_nop 0
    buffer_load_dwordx4 v6, s[76:79], s89 offen lds
    s_add_u32 s36, s92, 3
    s_cmp_ge_u32 s36, 6
    s_cselect_b32 s37, 6, 0
    s_sub_u32 s36, s36, s37
    s_mul_i32 s89, s36, 40960
    s_add_u32 s89, s89, s98
    s_mov_b32 m0, s100
    s_nop 0
    buffer_load_dwordx4 v2, s[76:79], s89 offen lds
    buffer_load_dwordx4 v3, s[76:79], s89 offen offset:1024 lds
    buffer_load_dwordx4 v4, s[76:79], s89 offen offset:2048 lds
    buffer_load_dwordx4 v5, s[76:79], s89 offen offset:3072 lds
    s_add_u32 m0, s100, 4096
    s_nop 0
    buffer_load_dwordx4 v6, s[76:79], s89 offen lds
    s_mov_b32 s96, 0
L_poll_p1g1:
    buffer_load_dword v13, v14, s[84:87], 0 offen sc1
    s_waitcnt vmcnt(0)
    v_readfirstlane_b32 s34, v13
    s_nop 1
    s_and_b32 s34, s34, 0xffff
    s_cmp_eq_u32 s34, 0xffff
    s_cbranch_scc1 L_polld_p1g1
    s_sleep 16
    s_add_u32 s96, s96, 1
    s_cmp_lt_u32 s96, 0x40000
    s_cbranch_scc1 L_poll_p1g1
L_polld_p1g1:
    s_add_u32 s36, s92, 0
    s_cmp_ge_u32 s36, 6
    s_cselect_b32 s37, 6, 0
    s_sub_u32 s36, s36, s37
    s_lshl_b32 s88, s36, 13
    s_add_u32 s88, s88, s99
    buffer_load_dwordx4 v[112:115], v7, s[24:27], s88 offen offset:0 sc1
    buffer_load_dwordx4 v[116:119], v7, s[24:27], s88 offen offset:1024 sc1
    buffer_load_dwordx4 v[120:123], v7, s[24:27], s88 offen offset:2048 sc1
    buffer_load_dwordx4 v[124:127], v7, s[24:27], s88 offen offset:3072 sc1
    s_add_u32 s36, s92, 1
    s_cmp_ge_u32 s36, 6
    s_cselect_b32 s37, 6, 0
    s_sub_u32 s36, s36, s37
    s_lshl_b32 s88, s36, 13
    s_add_u32 s88, s88, s99
    buffer_load_dwordx4 v[128:131], v7, s[24:27], s88 offen offset:0 sc1
    buffer_load_dwordx4 v[132:135], v7, s[24:27], s88 offen offset:1024 sc1
    buffer_load_dwordx4 v[136:139], v7, s[24:27], s88 offen offset:2048 sc1
    buffer_load_dwordx4 v[140:143], v7, s[24:27], s88 offen offset:3072 sc1
    s_add_u32 s36, s92, 2
    s_cmp_ge_u32 s36, 6
    s_cselect_b32 s37, 6, 0
    s_sub_u32 s36, s36, s37
    s_lshl_b32 s88, s36, 13
    s_add_u32 s88, s88, s99
    buffer_load_dwordx4 v[144:147], v7, s[24:27], s88 offen offset:0 sc1
    buffer_load_dwordx4 v[148:151], v7, s[24:27], s88 offen offset:1024 sc1
    buffer_load_dwordx4 v[152:155], v7, s[24:27], s88 offen offset:2048 sc1
    buffer_load_dwordx4 v[156:159], v7, s[24:27], s88 offen offset:3072 sc1
    v_add_u32 v10, s93, v8
    ds_read_b64_tr_b16 v[176:177], v10 offset:0
    ds_read_b64_tr_b16 v[178:179], v10 offset:2560
    ds_read_b64_tr_b16 v[180:181], v10 offset:32
    ds_read_b64_tr_b16 v[182:183], v10 offset:2592
    ds_read_b64_tr_b16 v[184:185], v10 offset:64
    ds_read_b64_tr_b16 v[186:187], v10 offset:2624
    ds_read_b64_tr_b16 v[188:189], v10 offset:96
    ds_read_b64_tr_b16 v[190:191], v10 offset:2656
    ds_read_b64_tr_b16 v[192:193], v10 offset:128
    ds_read_b64_tr_b16 v[194:195], v10 offset:2688
    s_waitcnt vmcnt(8)
    s_waitcnt lgkmcnt(0)
    s_add_u32 s36, s92, 4
    s_cmp_ge_u32 s36, 6
    s_cselect_b32 s37, 6, 0
    s_sub_u32 s36, s36, s37
    s_mul_i32 s89, s36, 40960
    s_add_u32 s89, s89, s98
    s_add_u32 s36, s92, 3
    s_cmp_ge_u32 s36, 6
    s_cselect_b32 s37, 6, 0
    s_sub_u32 s36, s36, s37
    s_lshl_b32 s88, s36, 13
    s_add_u32 s88, s88, s99
    v_mfma_f32_16x16x32_bf16 v[32:35], v[176:179], v[112:115], v[32:35]
    v_add_u32 v11, s94, v8
    v_mfma_f32_16x16x32_bf16 v[52:55], v[176:179], v[116:119], v[52:55]
    s_mov_b32 m0, s93
    s_nop 0
    buffer_load_dwordx4 v2, s[76:79], s89 offen lds
    v_mfma_f32_16x16x32_bf16 v[72:75], v[176:179], v[120:123], v[72:75]
    ds_read_b64_tr_b16 v[196:197], v11 offset:0
    v_mfma_f32_16x16x32_bf16 v[92:95], v[176:179], v[124:127], v[92:95]
    buffer_load_dwordx4 v3, s[76:79], s89 offen offset:1024 lds
    v_mfma_f32_16x16x32_bf16 v[36:39], v[180:183], v[112:115], v[36:39]
    ds_read_b64_tr_b16 v[198:199], v11 offset:2560
    v_mfma_f32_16x16x32_bf16 v[56:59], v[180:183], v[116:119], v[56:59]
    buffer_load_dwordx4 v4, s[76:79], s89 offen offset:2048 lds
    v_mfma_f32_16x16x32_bf16 v[76:79], v[180:183], v[120:123], v[76:79]
    ds_read_b64_tr_b16 v[200:201], v11 offset:32
    v_mfma_f32_16x16x32_bf16 v[96:99], v[180:183], v[124:127], v[96:99]
    buffer_load_dwordx4 v5, s[76:79], s89 offen offset:3072 lds
    v_mfma_f32_16x16x32_bf16 v[40:43], v[184:187], v[112:115], v[40:43]
    ds_read_b64_tr_b16 v[202:203], v11 offset:2592
    v_mfma_f32_16x16x32_bf16 v[60:63], v[184:187], v[116:119], v[60:63]
    s_add_u32 m0, s93, 4096
    s_nop 0
    buffer_load_dwordx4 v6, s[76:79], s89 offen lds
    v_mfma_f32_16x16x32_bf16 v[80:83], v[184:187], v[120:123], v[80:83]
    ds_read_b64_tr_b16 v[204:205], v11 offset:64
    v_mfma_f32_16x16x32_bf16 v[100:103], v[184:187], v[124:127], v[100:103]
    buffer_load_dwordx4 v[160:163], v7, s[24:27], s88 offen offset:0 sc1
    v_mfma_f32_16x16x32_bf16 v[44:47], v[188:191], v[112:115], v[44:47]
    ds_read_b64_tr_b16 v[206:207], v11 offset:2624
    v_mfma_f32_16x16x32_bf16 v[64:67], v[188:191], v[116:119], v[64:67]
    buffer_load_dwordx4 v[164:167], v7, s[24:27], s88 offen offset:1024 sc1
    v_mfma_f32_16x16x32_bf16 v[84:87], v[188:191], v[120:123], v[84:87]
    ds_read_b64_tr_b16 v[208:209], v11 offset:96
    v_mfma_f32_16x16x32_bf16 v[104:107], v[188:191], v[124:127], v[104:107]
    buffer_load_dwordx4 v[168:171], v7, s[24:27], s88 offen offset:2048 sc1
    v_mfma_f32_16x16x32_bf16 v[48:51], v[192:195], v[112:115], v[48:51]
    ds_read_b64_tr_b16 v[210:211], v11 offset:2656
    v_mfma_f32_16x16x32_bf16 v[68:71], v[192:195], v[116:119], v[68:71]
    buffer_load_dwordx4 v[172:175], v7, s[24:27], s88 offen offset:3072 sc1
    v_mfma_f32_16x16x32_bf16 v[88:91], v[192:195], v[120:123], v[88:91]
    ds_read_b64_tr_b16 v[212:213], v11 offset:128
    v_mfma_f32_16x16x32_bf16 v[108:111], v[192:195], v[124:127], v[108:111]
    ds_read_b64_tr_b16 v[214:215], v11 offset:2688
    s_waitcnt vmcnt(13)
    s_waitcnt lgkmcnt(0)
    s_add_u32 s36, s92, 5
    s_cmp_ge_u32 s36, 6
    s_cselect_b32 s37, 6, 0
    s_sub_u32 s36, s36, s37
    s_mul_i32 s89, s36, 40960
    s_add_u32 s89, s89, s98
    s_add_u32 s36, s92, 4
    s_cmp_ge_u32 s36, 6
    s_cselect_b32 s37, 6, 0
    s_sub_u32 s36, s36, s37
    s_lshl_b32 s88, s36, 13
    s_add_u32 s88, s88, s99
    v_mfma_f32_16x16x32_bf16 v[32:35], v[196:199], v[128:131], v[32:35]
    v_add_u32 v10, s95, v8
    v_mfma_f32_16x16x32_bf16 v[52:55], v[196:199], v[132:135], v[52:55]
    s_mov_b32 m0, s94
    s_nop 0
    buffer_load_dwordx4 v2, s[76:79], s89 offen lds
    v_mfma_f32_16x16x32_bf16 v[72:75], v[196:199], v[136:139], v[72:75]
    ds_read_b64_tr_b16 v[176:177], v10 offset:0
    v_mfma_f32_16x16x32_bf16 v[92:95], v[196:199], v[140:143], v[92:95]
    buffer_load_dwordx4 v3, s[76:79], s89 offen offset:1024 lds
    v_mfma_f32_16x16x32_bf16 v[36:39], v[200:203], v[128:131], v[36:39]
    ds_read_b64_tr_b16 v[178:179], v10 offset:2560
    v_mfma_f32_16x16x32_bf16 v[56:59], v[200:203], v[132:135], v[56:59]
    buffer_load_dwordx4 v4, s[76:79], s89 offen offset:2048 lds
    v_mfma_f32_16x16x32_bf16 v[76:79], v[200:203], v[136:139], v[76:79]
    ds_read_b64_tr_b16 v[180:181], v10 offset:32
    v_mfma_f32_16x16x32_bf16 v[96:99], v[200:203], v[140:143], v[96:99]
    buffer_load_dwordx4 v5, s[76:79], s89 offen offset:3072 lds
    v_mfma_f32_16x16x32_bf16 v[40:43], v[204:207], v[128:131], v[40:43]
    ds_read_b64_tr_b16 v[182:183], v10 offset:2592
    v_mfma_f32_16x16x32_bf16 v[60:63], v[204:207], v[132:135], v[60:63]
    s_add_u32 m0, s94, 4096
    s_nop 0
    buffer_load_dwordx4 v6, s[76:79], s89 offen lds
    v_mfma_f32_16x16x32_bf16 v[80:83], v[204:207], v[136:139], v[80:83]
    ds_read_b64_tr_b16 v[184:185], v10 offset:64
    v_mfma_f32_16x16x32_bf16 v[100:103], v[204:207], v[140:143], v[100:103]
    buffer_load_dwordx4 v[112:115], v7, s[24:27], s88 offen offset:0 sc1
    v_mfma_f32_16x16x32_bf16 v[44:47], v[208:211], v[128:131], v[44:47]
    ds_read_b64_tr_b16 v[186:187], v10 offset:2624
    v_mfma_f32_16x16x32_bf16 v[64:67], v[208:211], v[132:135], v[64:67]
    buffer_load_dwordx4 v[116:119], v7, s[24:27], s88 offen offset:1024 sc1
    v_mfma_f32_16x16x32_bf16 v[84:87], v[208:211], v[136:139], v[84:87]
    ds_read_b64_tr_b16 v[188:189], v10 offset:96
    v_mfma_f32_16x16x32_bf16 v[104:107], v[208:211], v[140:143], v[104:107]
    buffer_load_dwordx4 v[120:123], v7, s[24:27], s88 offen offset:2048 sc1
    v_mfma_f32_16x16x32_bf16 v[48:51], v[212:215], v[128:131], v[48:51]
    ds_read_b64_tr_b16 v[190:191], v10 offset:2656
    v_mfma_f32_16x16x32_bf16 v[68:71], v[212:215], v[132:135], v[68:71]
    buffer_load_dwordx4 v[124:127], v7, s[24:27], s88 offen offset:3072 sc1
    v_mfma_f32_16x16x32_bf16 v[88:91], v[212:215], v[136:139], v[88:91]
    ds_read_b64_tr_b16 v[192:193], v10 offset:128
    v_mfma_f32_16x16x32_bf16 v[108:111], v[212:215], v[140:143], v[108:111]
    ds_read_b64_tr_b16 v[194:195], v10 offset:2688
    s_waitcnt vmcnt(18)
    s_waitcnt lgkmcnt(0)
    s_lshl_b32 s36, s3, 3
    s_add_u32 s36, s36, 64
    s_mul_i32 s98, s36, 40960
    s_mul_i32 s37, s91, 160
    s_add_u32 s98, s98, s37
    s_add_u32 s36, s97, 0
    s_and_b32 s36, s36, 7
    s_mul_i32 s89, s36, 40960
    s_add_u32 s89, s89, s98
    s_add_u32 s36, s92, 5
    s_cmp_ge_u32 s36, 6
    s_cselect_b32 s37, 6, 0
    s_sub_u32 s36, s36, s37
    s_lshl_b32 s88, s36, 13
    s_add_u32 s88, s88, s99
    v_mfma_f32_16x16x32_bf16 v[32:35], v[176:179], v[144:147], v[32:35]
    v_add_u32 v11, s100, v8
    v_mfma_f32_16x16x32_bf16 v[52:55], v[176:179], v[148:151], v[52:55]
    s_mov_b32 m0, s95
    s_nop 0
    buffer_load_dwordx4 v2, s[76:79], s89 offen lds
    v_mfma_f32_16x16x32_bf16 v[72:75], v[176:179], v[152:155], v[72:75]
    ds_read_b64_tr_b16 v[196:197], v11 offset:0
    v_mfma_f32_16x16x32_bf16 v[92:95], v[176:179], v[156:159], v[92:95]
    buffer_load_dwordx4 v3, s[76:79], s89 offen offset:1024 lds
    v_mfma_f32_16x16x32_bf16 v[36:39], v[180:183], v[144:147], v[36:39]
    ds_read_b64_tr_b16 v[198:199], v11 offset:2560
    v_mfma_f32_16x16x32_bf16 v[56:59], v[180:183], v[148:151], v[56:59]
    buffer_load_dwordx4 v4, s[76:79], s89 offen offset:2048 lds
    v_mfma_f32_16x16x32_bf16 v[76:79], v[180:183], v[152:155], v[76:79]
    ds_read_b64_tr_b16 v[200:201], v11 offset:32
    v_mfma_f32_16x16x32_bf16 v[96:99], v[180:183], v[156:159], v[96:99]
    buffer_load_dwordx4 v5, s[76:79], s89 offen offset:3072 lds
    v_mfma_f32_16x16x32_bf16 v[40:43], v[184:187], v[144:147], v[40:43]
    ds_read_b64_tr_b16 v[202:203], v11 offset:2592
    v_mfma_f32_16x16x32_bf16 v[60:63], v[184:187], v[148:151], v[60:63]
    s_add_u32 m0, s95, 4096
    s_nop 0
    buffer_load_dwordx4 v6, s[76:79], s89 offen lds
    v_mfma_f32_16x16x32_bf16 v[80:83], v[184:187], v[152:155], v[80:83]
    ds_read_b64_tr_b16 v[204:205], v11 offset:64
    v_mfma_f32_16x16x32_bf16 v[100:103], v[184:187], v[156:159], v[100:103]
    buffer_load_dwordx4 v[128:131], v7, s[24:27], s88 offen offset:0 sc1
    v_mfma_f32_16x16x32_bf16 v[44:47], v[188:191], v[144:147], v[44:47]
    ds_read_b64_tr_b16 v[206:207], v11 offset:2624
    v_mfma_f32_16x16x32_bf16 v[64:67], v[188:191], v[148:151], v[64:67]
    buffer_load_dwordx4 v[132:135], v7, s[24:27], s88 offen offset:1024 sc1
    v_mfma_f32_16x16x32_bf16 v[84:87], v[188:191], v[152:155], v[84:87]
    ds_read_b64_tr_b16 v[208:209], v11 offset:96
    v_mfma_f32_16x16x32_bf16 v[104:107], v[188:191], v[156:159], v[104:107]
    buffer_load_dwordx4 v[136:139], v7, s[24:27], s88 offen offset:2048 sc1
    v_mfma_f32_16x16x32_bf16 v[48:51], v[192:195], v[144:147], v[48:51]
    ds_read_b64_tr_b16 v[210:211], v11 offset:2656
    v_mfma_f32_16x16x32_bf16 v[68:71], v[192:195], v[148:151], v[68:71]
    buffer_load_dwordx4 v[140:143], v7, s[24:27], s88 offen offset:3072 sc1
    v_mfma_f32_16x16x32_bf16 v[88:91], v[192:195], v[152:155], v[88:91]
    ds_read_b64_tr_b16 v[212:213], v11 offset:128
    v_mfma_f32_16x16x32_bf16 v[108:111], v[192:195], v[156:159], v[108:111]
    ds_read_b64_tr_b16 v[214:215], v11 offset:2688
    s_waitcnt vmcnt(18)
    s_waitcnt lgkmcnt(0)
    s_add_u32 s36, s97, 1
    s_and_b32 s36, s36, 7
    s_mul_i32 s89, s36, 40960
    s_add_u32 s89, s89, s98
    v_mfma_f32_16x16x32_bf16 v[32:35], v[196:199], v[160:163], v[32:35]
    v_add_u32 v10, s93, v8
    v_mfma_f32_16x16x32_bf16 v[52:55], v[196:199], v[164:167], v[52:55]
    s_mov_b32 m0, s100
    s_nop 0
    buffer_load_dwordx4 v2, s[76:79], s89 offen lds
    v_mfma_f32_16x16x32_bf16 v[72:75], v[196:199], v[168:171], v[72:75]
    ds_read_b64_tr_b16 v[176:177], v10 offset:0
    v_mfma_f32_16x16x32_bf16 v[92:95], v[196:199], v[172:175], v[92:95]
    buffer_load_dwordx4 v3, s[76:79], s89 offen offset:1024 lds
    v_mfma_f32_16x16x32_bf16 v[36:39], v[200:203], v[160:163], v[36:39]
    ds_read_b64_tr_b16 v[178:179], v10 offset:2560
    v_mfma_f32_16x16x32_bf16 v[56:59], v[200:203], v[164:167], v[56:59]
    buffer_load_dwordx4 v4, s[76:79], s89 offen offset:2048 lds
    v_mfma_f32_16x16x32_bf16 v[76:79], v[200:203], v[168:171], v[76:79]
    ds_read_b64_tr_b16 v[180:181], v10 offset:32
    v_mfma_f32_16x16x32_bf16 v[96:99], v[200:203], v[172:175], v[96:99]
    buffer_load_dwordx4 v5, s[76:79], s89 offen offset:3072 lds
    v_mfma_f32_16x16x32_bf16 v[40:43], v[204:207], v[160:163], v[40:43]
    ds_read_b64_tr_b16 v[182:183], v10 offset:2592
    v_mfma_f32_16x16x32_bf16 v[60:63], v[204:207], v[164:167], v[60:63]
    s_add_u32 m0, s100, 4096
    s_nop 0
    buffer_load_dwordx4 v6, s[76:79], s89 offen lds
    v_mfma_f32_16x16x32_bf16 v[80:83], v[204:207], v[168:171], v[80:83]
    ds_read_b64_tr_b16 v[184:185], v10 offset:64
    v_mfma_f32_16x16x32_bf16 v[100:103], v[204:207], v[172:175], v[100:103]
    ds_read_b64_tr_b16 v[186:187], v10 offset:2624
    v_mfma_f32_16x16x32_bf16 v[44:47], v[208:211], v[160:163], v[44:47]
    ds_read_b64_tr_b16 v[188:189], v10 offset:96
    v_mfma_f32_16x16x32_bf16 v[64:67], v[208:211], v[164:167], v[64:67]
    ds_read_b64_tr_b16 v[190:191], v10 offset:2656
    v_mfma_f32_16x16x32_bf16 v[84:87], v[208:211], v[168:171], v[84:87]
    ds_read_b64_tr_b16 v[192:193], v10 offset:128
    v_mfma_f32_16x16x32_bf16 v[104:107], v[208:211], v[172:175], v[104:107]
    ds_read_b64_tr_b16 v[194:195], v10 offset:2688
    v_mfma_f32_16x16x32_bf16 v[48:51], v[212:215], v[160:163], v[48:51]
    v_mfma_f32_16x16x32_bf16 v[68:71], v[212:215], v[164:167], v[68:71]
    v_mfma_f32_16x16x32_bf16 v[88:91], v[212:215], v[168:171], v[88:91]
    v_mfma_f32_16x16x32_bf16 v[108:111], v[212:215], v[172:175], v[108:111]
    s_waitcnt vmcnt(14)
    s_waitcnt lgkmcnt(0)
    s_add_u32 s36, s97, 2
    s_and_b32 s36, s36, 7
    s_mul_i32 s89, s36, 40960
    s_add_u32 s89, s89, s98
    v_mfma_f32_16x16x32_bf16 v[32:35], v[176:179], v[112:115], v[32:35]
    v_add_u32 v11, s94, v8
    v_mfma_f32_16x16x32_bf16 v[52:55], v[176:179], v[116:119], v[52:55]
    s_mov_b32 m0, s93
    s_nop 0
    buffer_load_dwordx4 v2, s[76:79], s89 offen lds
    v_mfma_f32_16x16x32_bf16 v[72:75], v[176:179], v[120:123], v[72:75]
    ds_read_b64_tr_b16 v[196:197], v11 offset:0
    v_mfma_f32_16x16x32_bf16 v[92:95], v[176:179], v[124:127], v[92:95]
    buffer_load_dwordx4 v3, s[76:79], s89 offen offset:1024 lds
    v_mfma_f32_16x16x32_bf16 v[36:39], v[180:183], v[112:115], v[36:39]
    ds_read_b64_tr_b16 v[198:199], v11 offset:2560
    v_mfma_f32_16x16x32_bf16 v[56:59], v[180:183], v[116:119], v[56:59]
    buffer_load_dwordx4 v4, s[76:79], s89 offen offset:2048 lds
    v_mfma_f32_16x16x32_bf16 v[76:79], v[180:183], v[120:123], v[76:79]
    ds_read_b64_tr_b16 v[200:201], v11 offset:32
    v_mfma_f32_16x16x32_bf16 v[96:99], v[180:183], v[124:127], v[96:99]
    buffer_load_dwordx4 v5, s[76:79], s89 offen offset:3072 lds
    v_mfma_f32_16x16x32_bf16 v[40:43], v[184:187], v[112:115], v[40:43]
    ds_read_b64_tr_b16 v[202:203], v11 offset:2592
    v_mfma_f32_16x16x32_bf16 v[60:63], v[184:187], v[116:119], v[60:63]
    s_add_u32 m0, s93, 4096
    s_nop 0
    buffer_load_dwordx4 v6, s[76:79], s89 offen lds
    v_mfma_f32_16x16x32_bf16 v[80:83], v[184:187], v[120:123], v[80:83]
    ds_read_b64_tr_b16 v[204:205], v11 offset:64
    v_mfma_f32_16x16x32_bf16 v[100:103], v[184:187], v[124:127], v[100:103]
    ds_read_b64_tr_b16 v[206:207], v11 offset:2624
    v_mfma_f32_16x16x32_bf16 v[44:47], v[188:191], v[112:115], v[44:47]
    ds_read_b64_tr_b16 v[208:209], v11 offset:96
    v_mfma_f32_16x16x32_bf16 v[64:67], v[188:191], v[116:119], v[64:67]
    ds_read_b64_tr_b16 v[210:211], v11 offset:2656
    v_mfma_f32_16x16x32_bf16 v[84:87], v[188:191], v[120:123], v[84:87]
    ds_read_b64_tr_b16 v[212:213], v11 offset:128
    v_mfma_f32_16x16x32_bf16 v[104:107], v[188:191], v[124:127], v[104:107]
    ds_read_b64_tr_b16 v[214:215], v11 offset:2688
    v_mfma_f32_16x16x32_bf16 v[48:51], v[192:195], v[112:115], v[48:51]
    v_mfma_f32_16x16x32_bf16 v[68:71], v[192:195], v[116:119], v[68:71]
    v_mfma_f32_16x16x32_bf16 v[88:91], v[192:195], v[120:123], v[88:91]
    v_mfma_f32_16x16x32_bf16 v[108:111], v[192:195], v[124:127], v[108:111]
    s_waitcnt vmcnt(10)
    s_waitcnt lgkmcnt(0)
    s_add_u32 s36, s97, 3
    s_and_b32 s36, s36, 7
    s_mul_i32 s89, s36, 40960
    s_add_u32 s89, s89, s98
    v_mfma_f32_16x16x32_bf16 v[32:35], v[196:199], v[128:131], v[32:35]
    v_add_u32 v10, s95, v8
    v_mfma_f32_16x16x32_bf16 v[52:55], v[196:199], v[132:135], v[52:55]
    s_mov_b32 m0, s94
    s_nop 0
    buffer_load_dwordx4 v2, s[76:79], s89 offen lds
    v_mfma_f32_16x16x32_bf16 v[72:75], v[196:199], v[136:139], v[72:75]
    ds_read_b64_tr_b16 v[176:177], v10 offset:0
    v_mfma_f32_16x16x32_bf16 v[92:95], v[196:199], v[140:143], v[92:95]
    buffer_load_dwordx4 v3, s[76:79], s89 offen offset:1024 lds
    v_mfma_f32_16x16x32_bf16 v[36:39], v[200:203], v[128:131], v[36:39]
    ds_read_b64_tr_b16 v[178:179], v10 offset:2560
    v_mfma_f32_16x16x32_bf16 v[56:59], v[200:203], v[132:135], v[56:59]
    buffer_load_dwordx4 v4, s[76:79], s89 offen offset:2048 lds
    v_mfma_f32_16x16x32_bf16 v[76:79], v[200:203], v[136:139], v[76:79]
    ds_read_b64_tr_b16 v[180:181], v10 offset:32
    v_mfma_f32_16x16x32_bf16 v[96:99], v[200:203], v[140:143], v[96:99]
    buffer_load_dwordx4 v5, s[76:79], s89 offen offset:3072 lds
    v_mfma_f32_16x16x32_bf16 v[40:43], v[204:207], v[128:131], v[40:43]
    ds_read_b64_tr_b16 v[182:183], v10 offset:2592
    v_mfma_f32_16x16x32_bf16 v[60:63], v[204:207], v[132:135], v[60:63]
    s_add_u32 m0, s94, 4096
    s_nop 0
    buffer_load_dwordx4 v6, s[76:79], s89 offen lds
    v_mfma_f32_16x16x32_bf16 v[80:83], v[204:207], v[136:139], v[80:83]
    ds_read_b64_tr_b16 v[184:185], v10 offset:64
    v_mfma_f32_16x16x32_bf16 v[100:103], v[204:207], v[140:143], v[100:103]
    ds_read_b64_tr_b16 v[186:187], v10 offset:2624
    v_mfma_f32_16x16x32_bf16 v[44:47], v[208:211], v[128:131], v[44:47]
    ds_read_b64_tr_b16 v[188:189], v10 offset:96
    v_mfma_f32_16x16x32_bf16 v[64:67], v[208:211], v[132:135], v[64:67]
    ds_read_b64_tr_b16 v[190:191], v10 offset:2656
    v_mfma_f32_16x16x32_bf16 v[84:87], v[208:211], v[136:139], v[84:87]
    ds_read_b64_tr_b16 v[192:193], v10 offset:128
    v_mfma_f32_16x16x32_bf16 v[104:107], v[208:211], v[140:143], v[104:107]
    ds_read_b64_tr_b16 v[194:195], v10 offset:2688
    v_mfma_f32_16x16x32_bf16 v[48:51], v[212:215], v[128:131], v[48:51]
    v_mfma_f32_16x16x32_bf16 v[68:71], v[212:215], v[132:135], v[68:71]
    v_mfma_f32_16x16x32_bf16 v[88:91], v[212:215], v[136:139], v[88:91]
    v_mfma_f32_16x16x32_bf16 v[108:111], v[212:215], v[140:143], v[108:111]
    s_lshl_b32 s35, s3, 1
    s_add_u32 s35, s35, 16
    s_lshl_b32 s35, 3, s35
    s_mov_b32 s96, 0
L_poll_p2g1:
    buffer_load_dword v13, v14, s[84:87], 0 offen sc1
    s_waitcnt vmcnt(0)
    v_readfirstlane_b32 s34, v13
    s_nop 1
    s_and_b32 s34, s34, s35
    s_cmp_eq_u32 s34, s35
    s_cbranch_scc1 L_polld_p2g1
    s_sleep 16
    s_add_u32 s96, s96, 1
    s_cmp_lt_u32 s96, 0x40000
    s_cbranch_scc1 L_poll_p2g1
L_polld_p2g1:
    s_lshl_b32 s36, s3, 3
    s_add_u32 s36, s36, 64
    s_lshr_b32 s37, s90, 1
    s_lshl_b32 s37, s37, 7
    s_add_u32 s37, s37, s36
    s_lshl_b32 s99, s37, 13
    s_and_b32 s37, s90, 1
    s_lshl_b32 s37, s37, 12
    s_add_u32 s99, s99, s37
    s_add_u32 s36, s97, 0
    s_and_b32 s36, s36, 7
    s_lshl_b32 s88, s36, 13
    s_add_u32 s88, s88, s99
    buffer_load_dwordx4 v[144:147], v7, s[24:27], s88 offen offset:0 sc1
    buffer_load_dwordx4 v[148:151], v7, s[24:27], s88 offen offset:1024 sc1
    buffer_load_dwordx4 v[152:155], v7, s[24:27], s88 offen offset:2048 sc1
    buffer_load_dwordx4 v[156:159], v7, s[24:27], s88 offen offset:3072 sc1
    s_add_u32 s36, s97, 1
    s_and_b32 s36, s36, 7
    s_lshl_b32 s88, s36, 13
    s_add_u32 s88, s88, s99
    buffer_load_dwordx4 v[160:163], v7, s[24:27], s88 offen offset:0 sc1
    buffer_load_dwordx4 v[164:167], v7, s[24:27], s88 offen offset:1024 sc1
    buffer_load_dwordx4 v[168:171], v7, s[24:27], s88 offen offset:2048 sc1
    buffer_load_dwordx4 v[172:175], v7, s[24:27], s88 offen offset:3072 sc1
    s_add_u32 s36, s97, 2
    s_and_b32 s36, s36, 7
    s_lshl_b32 s88, s36, 13
    s_add_u32 s88, s88, s99
    buffer_load_dwordx4 v[112:115], v7, s[24:27], s88 offen offset:0 sc1
    buffer_load_dwordx4 v[116:119], v7, s[24:27], s88 offen offset:1024 sc1
    buffer_load_dwordx4 v[120:123], v7, s[24:27], s88 offen offset:2048 sc1
    buffer_load_dwordx4 v[124:127], v7, s[24:27], s88 offen offset:3072 sc1
    s_waitcnt vmcnt(8)
    s_waitcnt lgkmcnt(0)
    s_add_u32 s36, s97, 4
    s_and_b32 s36, s36, 7
    s_mul_i32 s89, s36, 40960
    s_add_u32 s89, s89, s98
    s_add_u32 s36, s97, 3
    s_and_b32 s36, s36, 7
    s_lshl_b32 s88, s36, 13
    s_add_u32 s88, s88, s99
    v_mfma_f32_16x16x32_bf16 v[32:35], v[176:179], v[144:147], v[32:35]
    v_add_u32 v11, s100, v8
    v_mfma_f32_16x16x32_bf16 v[52:55], v[176:179], v[148:151], v[52:55]
    s_mov_b32 m0, s95
    s_nop 0
    buffer_load_dwordx4 v2, s[76:79], s89 offen lds
    v_mfma_f32_16x16x32_bf16 v[72:75], v[176:179], v[152:155], v[72:75]
    ds_read_b64_tr_b16 v[196:197], v11 offset:0
    v_mfma_f32_16x16x32_bf16 v[92:95], v[176:179], v[156:159], v[92:95]
    buffer_load_dwordx4 v3, s[76:79], s89 offen offset:1024 lds
    v_mfma_f32_16x16x32_bf16 v[36:39], v[180:183], v[144:147], v[36:39]
    ds_read_b64_tr_b16 v[198:199], v11 offset:2560
    v_mfma_f32_16x16x32_bf16 v[56:59], v[180:183], v[148:151], v[56:59]
    buffer_load_dwordx4 v4, s[76:79], s89 offen offset:2048 lds
    v_mfma_f32_16x16x32_bf16 v[76:79], v[180:183], v[152:155], v[76:79]
    ds_read_b64_tr_b16 v[200:201], v11 offset:32
    v_mfma_f32_16x16x32_bf16 v[96:99], v[180:183], v[156:159], v[96:99]
    buffer_load_dwordx4 v5, s[76:79], s89 offen offset:3072 lds
    v_mfma_f32_16x16x32_bf16 v[40:43], v[184:187], v[144:147], v[40:43]
    ds_read_b64_tr_b16 v[202:203], v11 offset:2592
    v_mfma_f32_16x16x32_bf16 v[60:63], v[184:187], v[148:151], v[60:63]
    s_add_u32 m0, s95, 4096
    s_nop 0
    buffer_load_dwordx4 v6, s[76:79], s89 offen lds
    v_mfma_f32_16x16x32_bf16 v[80:83], v[184:187], v[152:155], v[80:83]
    ds_read_b64_tr_b16 v[204:205], v11 offset:64
    v_mfma_f32_16x16x32_bf16 v[100:103], v[184:187], v[156:159], v[100:103]
    buffer_load_dwordx4 v[128:131], v7, s[24:27], s88 offen offset:0 sc1
    v_mfma_f32_16x16x32_bf16 v[44:47], v[188:191], v[144:147], v[44:47]
    ds_read_b64_tr_b16 v[206:207], v11 offset:2624
    v_mfma_f32_16x16x32_bf16 v[64:67], v[188:191], v[148:151], v[64:67]
    buffer_load_dwordx4 v[132:135], v7, s[24:27], s88 offen offset:1024 sc1
    v_mfma_f32_16x16x32_bf16 v[84:87], v[188:191], v[152:155], v[84:87]
    ds_read_b64_tr_b16 v[208:209], v11 offset:96
    v_mfma_f32_16x16x32_bf16 v[104:107], v[188:191], v[156:159], v[104:107]
    buffer_load_dwordx4 v[136:139], v7, s[24:27], s88 offen offset:2048 sc1
    v_mfma_f32_16x16x32_bf16 v[48:51], v[192:195], v[144:147], v[48:51]
    ds_read_b64_tr_b16 v[210:211], v11 offset:2656
    v_mfma_f32_16x16x32_bf16 v[68:71], v[192:195], v[148:151], v[68:71]
    buffer_load_dwordx4 v[140:143], v7, s[24:27], s88 offen offset:3072 sc1
    v_mfma_f32_16x16x32_bf16 v[88:91], v[192:195], v[152:155], v[88:91]
    ds_read_b64_tr_b16 v[212:213], v11 offset:128
    v_mfma_f32_16x16x32_bf16 v[108:111], v[192:195], v[156:159], v[108:111]
    ds_read_b64_tr_b16 v[214:215], v11 offset:2688
    s_waitcnt vmcnt(13)
    s_waitcnt lgkmcnt(0)
    s_add_u32 s36, s97, 5
    s_and_b32 s36, s36, 7
    s_mul_i32 s89, s36, 40960
    s_add_u32 s89, s89, s98
    s_add_u32 s36, s97, 4
    s_and_b32 s36, s36, 7
    s_lshl_b32 s88, s36, 13
    s_add_u32 s88, s88, s99
    v_mfma_f32_16x16x32_bf16 v[32:35], v[196:199], v[160:163], v[32:35]
    v_add_u32 v10, s93, v8
    v_mfma_f32_16x16x32_bf16 v[52:55], v[196:199], v[164:167], v[52:55]
    s_mov_b32 m0, s100
    s_nop 0
    buffer_load_dwordx4 v2, s[76:79], s89 offen lds
    v_mfma_f32_16x16x32_bf16 v[72:75], v[196:199], v[168:171], v[72:75]
    ds_read_b64_tr_b16 v[176:177], v10 offset:0
    v_mfma_f32_16x16x32_bf16 v[92:95], v[196:199], v[172:175], v[92:95]
    buffer_load_dwordx4 v3, s[76:79], s89 offen offset:1024 lds
    v_mfma_f32_16x16x32_bf16 v[36:39], v[200:203], v[160:163], v[36:39]
    ds_read_b64_tr_b16 v[178:179], v10 offset:2560
    v_mfma_f32_16x16x32_bf16 v[56:59], v[200:203], v[164:167], v[56:59]
    buffer_load_dwordx4 v4, s[76:79], s89 offen offset:2048 lds
    v_mfma_f32_16x16x32_bf16 v[76:79], v[200:203], v[168:171], v[76:79]
    ds_read_b64_tr_b16 v[180:181], v10 offset:32
    v_mfma_f32_16x16x32_bf16 v[96:99], v[200:203], v[172:175], v[96:99]
    buffer_load_dwordx4 v5, s[76:79], s89 offen offset:3072 lds
    v_mfma_f32_16x16x32_bf16 v[40:43], v[204:207], v[160:163], v[40:43]
    ds_read_b64_tr_b16 v[182:183], v10 offset:2592
    v_mfma_f32_16x16x32_bf16 v[60:63], v[204:207], v[164:167], v[60:63]
    s_add_u32 m0, s100, 4096
    s_nop 0
    buffer_load_dwordx4 v6, s[76:79], s89 offen lds
    v_mfma_f32_16x16x32_bf16 v[80:83], v[204:207], v[168:171], v[80:83]
    ds_read_b64_tr_b16 v[184:185], v10 offset:64
    v_mfma_f32_16x16x32_bf16 v[100:103], v[204:207], v[172:175], v[100:103]
    buffer_load_dwordx4 v[144:147], v7, s[24:27], s88 offen offset:0 sc1
    v_mfma_f32_16x16x32_bf16 v[44:47], v[208:211], v[160:163], v[44:47]
    ds_read_b64_tr_b16 v[186:187], v10 offset:2624
    v_mfma_f32_16x16x32_bf16 v[64:67], v[208:211], v[164:167], v[64:67]
    buffer_load_dwordx4 v[148:151], v7, s[24:27], s88 offen offset:1024 sc1
    v_mfma_f32_16x16x32_bf16 v[84:87], v[208:211], v[168:171], v[84:87]
    ds_read_b64_tr_b16 v[188:189], v10 offset:96
    v_mfma_f32_16x16x32_bf16 v[104:107], v[208:211], v[172:175], v[104:107]
    buffer_load_dwordx4 v[152:155], v7, s[24:27], s88 offen offset:2048 sc1
    v_mfma_f32_16x16x32_bf16 v[48:51], v[212:215], v[160:163], v[48:51]
    ds_read_b64_tr_b16 v[190:191], v10 offset:2656
    v_mfma_f32_16x16x32_bf16 v[68:71], v[212:215], v[164:167], v[68:71]
    buffer_load_dwordx4 v[156:159], v7, s[24:27], s88 offen offset:3072 sc1
    v_mfma_f32_16x16x32_bf16 v[88:91], v[212:215], v[168:171], v[88:91]
    ds_read_b64_tr_b16 v[192:193], v10 offset:128
    v_mfma_f32_16x16x32_bf16 v[108:111], v[212:215], v[172:175], v[108:111]
    ds_read_b64_tr_b16 v[194:195], v10 offset:2688
    s_waitcnt vmcnt(18)
    s_waitcnt lgkmcnt(0)
    s_add_u32 s36, s97, 6
    s_and_b32 s36, s36, 7
    s_mul_i32 s89, s36, 40960
    s_add_u32 s89, s89, s98
    s_add_u32 s36, s97, 5
    s_and_b32 s36, s36, 7
    s_lshl_b32 s88, s36, 13
    s_add_u32 s88, s88, s99
    v_mfma_f32_16x16x32_bf16 v[32:35], v[176:179], v[112:115], v[32:35]
    v_add_u32 v11, s94, v8
    v_mfma_f32_16x16x32_bf16 v[52:55], v[176:179], v[116:119], v[52:55]
    s_mov_b32 m0, s93
    s_nop 0
    buffer_load_dwordx4 v2, s[76:79], s89 offen lds
    v_mfma_f32_16x16x32_bf16 v[72:75], v[176:179], v[120:123], v[72:75]
    ds_read_b64_tr_b16 v[196:197], v11 offset:0
    v_mfma_f32_16x16x32_bf16 v[92:95], v[176:179], v[124:127], v[92:95]
    buffer_load_dwordx4 v3, s[76:79], s89 offen offset:1024 lds
    v_mfma_f32_16x16x32_bf16 v[36:39], v[180:183], v[112:115], v[36:39]
    ds_read_b64_tr_b16 v[198:199], v11 offset:2560
    v_mfma_f32_16x16x32_bf16 v[56:59], v[180:183], v[116:119], v[56:59]
    buffer_load_dwordx4 v4, s[76:79], s89 offen offset:2048 lds
    v_mfma_f32_16x16x32_bf16 v[76:79], v[180:183], v[120:123], v[76:79]
    ds_read_b64_tr_b16 v[200:201], v11 offset:32
    v_mfma_f32_16x16x32_bf16 v[96:99], v[180:183], v[124:127], v[96:99]
    buffer_load_dwordx4 v5, s[76:79], s89 offen offset:3072 lds
    v_mfma_f32_16x16x32_bf16 v[40:43], v[184:187], v[112:115], v[40:43]
    ds_read_b64_tr_b16 v[202:203], v11 offset:2592
    v_mfma_f32_16x16x32_bf16 v[60:63], v[184:187], v[116:119], v[60:63]
    s_add_u32 m0, s93, 4096
    s_nop 0
    buffer_load_dwordx4 v6, s[76:79], s89 offen lds
    v_mfma_f32_16x16x32_bf16 v[80:83], v[184:187], v[120:123], v[80:83]
    ds_read_b64_tr_b16 v[204:205], v11 offset:64
    v_mfma_f32_16x16x32_bf16 v[100:103], v[184:187], v[124:127], v[100:103]
    buffer_load_dwordx4 v[160:163], v7, s[24:27], s88 offen offset:0 sc1
    v_mfma_f32_16x16x32_bf16 v[44:47], v[188:191], v[112:115], v[44:47]
    ds_read_b64_tr_b16 v[206:207], v11 offset:2624
    v_mfma_f32_16x16x32_bf16 v[64:67], v[188:191], v[116:119], v[64:67]
    buffer_load_dwordx4 v[164:167], v7, s[24:27], s88 offen offset:1024 sc1
    v_mfma_f32_16x16x32_bf16 v[84:87], v[188:191], v[120:123], v[84:87]
    ds_read_b64_tr_b16 v[208:209], v11 offset:96
    v_mfma_f32_16x16x32_bf16 v[104:107], v[188:191], v[124:127], v[104:107]
    buffer_load_dwordx4 v[168:171], v7, s[24:27], s88 offen offset:2048 sc1
    v_mfma_f32_16x16x32_bf16 v[48:51], v[192:195], v[112:115], v[48:51]
    ds_read_b64_tr_b16 v[210:211], v11 offset:2656
    v_mfma_f32_16x16x32_bf16 v[68:71], v[192:195], v[116:119], v[68:71]
    buffer_load_dwordx4 v[172:175], v7, s[24:27], s88 offen offset:3072 sc1
    v_mfma_f32_16x16x32_bf16 v[88:91], v[192:195], v[120:123], v[88:91]
    ds_read_b64_tr_b16 v[212:213], v11 offset:128
    v_mfma_f32_16x16x32_bf16 v[108:111], v[192:195], v[124:127], v[108:111]
    ds_read_b64_tr_b16 v[214:215], v11 offset:2688
    s_waitcnt vmcnt(18)
    s_waitcnt lgkmcnt(0)
    s_add_u32 s36, s97, 7
    s_and_b32 s36, s36, 7
    s_mul_i32 s89, s36, 40960
    s_add_u32 s89, s89, s98
    s_add_u32 s36, s97, 6
    s_and_b32 s36, s36, 7
    s_lshl_b32 s88, s36, 13
    s_add_u32 s88, s88, s99
    v_mfma_f32_16x16x32_bf16 v[32:35], v[196:199], v[128:131], v[32:35]
    v_add_u32 v10, s95, v8
    v_mfma_f32_16x16x32_bf16 v[52:55], v[196:199], v[132:135], v[52:55]
    s_mov_b32 m0, s94
    s_nop 0
    buffer_load_dwordx4 v2, s[76:79], s89 offen lds
    v_mfma_f32_16x16x32_bf16 v[72:75], v[196:199], v[136:139], v[72:75]
    ds_read_b64_tr_b16 v[176:177], v10 offset:0
    v_mfma_f32_16x16x32_bf16 v[92:95], v[196:199], v[140:143], v[92:95]
    buffer_load_dwordx4 v3, s[76:79], s89 offen offset:1024 lds
    v_mfma_f32_16x16x32_bf16 v[36:39], v[200:203], v[128:131], v[36:39]
    ds_read_b64_tr_b16 v[178:179], v10 offset:2560
    v_mfma_f32_16x16x32_bf16 v[56:59], v[200:203], v[132:135], v[56:59]
    buffer_load_dwordx4 v4, s[76:79], s89 offen offset:2048 lds
    v_mfma_f32_16x16x32_bf16 v[76:79], v[200:203], v[136:139], v[76:79]
    ds_read_b64_tr_b16 v[180:181], v10 offset:32
    v_mfma_f32_16x16x32_bf16 v[96:99], v[200:203], v[140:143], v[96:99]
    buffer_load_dwordx4 v5, s[76:79], s89 offen offset:3072 lds
    v_mfma_f32_16x16x32_bf16 v[40:43], v[204:207], v[128:131], v[40:43]
    ds_read_b64_tr_b16 v[182:183], v10 offset:2592
    v_mfma_f32_16x16x32_bf16 v[60:63], v[204:207], v[132:135], v[60:63]
    s_add_u32 m0, s94, 4096
    s_nop 0
    buffer_load_dwordx4 v6, s[76:79], s89 offen lds
    v_mfma_f32_16x16x32_bf16 v[80:83], v[204:207], v[136:139], v[80:83]
    ds_read_b64_tr_b16 v[184:185], v10 offset:64
    v_mfma_f32_16x16x32_bf16 v[100:103], v[204:207], v[140:143], v[100:103]
    buffer_load_dwordx4 v[112:115], v7, s[24:27], s88 offen offset:0 sc1
    v_mfma_f32_16x16x32_bf16 v[44:47], v[208:211], v[128:131], v[44:47]
    ds_read_b64_tr_b16 v[186:187], v10 offset:2624
    v_mfma_f32_16x16x32_bf16 v[64:67], v[208:211], v[132:135], v[64:67]
    buffer_load_dwordx4 v[116:119], v7, s[24:27], s88 offen offset:1024 sc1
    v_mfma_f32_16x16x32_bf16 v[84:87], v[208:211], v[136:139], v[84:87]
    ds_read_b64_tr_b16 v[188:189], v10 offset:96
    v_mfma_f32_16x16x32_bf16 v[104:107], v[208:211], v[140:143], v[104:107]
    buffer_load_dwordx4 v[120:123], v7, s[24:27], s88 offen offset:2048 sc1
    v_mfma_f32_16x16x32_bf16 v[48:51], v[212:215], v[128:131], v[48:51]
    ds_read_b64_tr_b16 v[190:191], v10 offset:2656
    v_mfma_f32_16x16x32_bf16 v[68:71], v[212:215], v[132:135], v[68:71]
    buffer_load_dwordx4 v[124:127], v7, s[24:27], s88 offen offset:3072 sc1
    v_mfma_f32_16x16x32_bf16 v[88:91], v[212:215], v[136:139], v[88:91]
    ds_read_b64_tr_b16 v[192:193], v10 offset:128
    v_mfma_f32_16x16x32_bf16 v[108:111], v[212:215], v[140:143], v[108:111]
    ds_read_b64_tr_b16 v[194:195], v10 offset:2688
    s_waitcnt vmcnt(18)
    s_waitcnt lgkmcnt(0)
    s_add_u32 s36, s97, 7
    s_and_b32 s36, s36, 7
    s_lshl_b32 s88, s36, 13
    s_add_u32 s88, s88, s99
    v_mfma_f32_16x16x32_bf16 v[32:35], v[176:179], v[144:147], v[32:35]
    v_add_u32 v11, s100, v8
    v_mfma_f32_16x16x32_bf16 v[52:55], v[176:179], v[148:151], v[52:55]
    buffer_load_dwordx4 v[128:131], v7, s[24:27], s88 offen offset:0 sc1
    v_mfma_f32_16x16x32_bf16 v[72:75], v[176:179], v[152:155], v[72:75]
    ds_read_b64_tr_b16 v[196:197], v11 offset:0
    v_mfma_f32_16x16x32_bf16 v[92:95], v[176:179], v[156:159], v[92:95]
    buffer_load_dwordx4 v[132:135], v7, s[24:27], s88 offen offset:1024 sc1
    v_mfma_f32_16x16x32_bf16 v[36:39], v[180:183], v[144:147], v[36:39]
    ds_read_b64_tr_b16 v[198:199], v11 offset:2560
    v_mfma_f32_16x16x32_bf16 v[56:59], v[180:183], v[148:151], v[56:59]
    buffer_load_dwordx4 v[136:139], v7, s[24:27], s88 offen offset:2048 sc1
    v_mfma_f32_16x16x32_bf16 v[76:79], v[180:183], v[152:155], v[76:79]
    ds_read_b64_tr_b16 v[200:201], v11 offset:32
    v_mfma_f32_16x16x32_bf16 v[96:99], v[180:183], v[156:159], v[96:99]
    buffer_load_dwordx4 v[140:143], v7, s[24:27], s88 offen offset:3072 sc1
    v_mfma_f32_16x16x32_bf16 v[40:43], v[184:187], v[144:147], v[40:43]
    ds_read_b64_tr_b16 v[202:203], v11 offset:2592
    v_mfma_f32_16x16x32_bf16 v[60:63], v[184:187], v[148:151], v[60:63]
    ds_read_b64_tr_b16 v[204:205], v11 offset:64
    v_mfma_f32_16x16x32_bf16 v[80:83], v[184:187], v[152:155], v[80:83]
    ds_read_b64_tr_b16 v[206:207], v11 offset:2624
    v_mfma_f32_16x16x32_bf16 v[100:103], v[184:187], v[156:159], v[100:103]
    ds_read_b64_tr_b16 v[208:209], v11 offset:96
    v_mfma_f32_16x16x32_bf16 v[44:47], v[188:191], v[144:147], v[44:47]
    ds_read_b64_tr_b16 v[210:211], v11 offset:2656
    v_mfma_f32_16x16x32_bf16 v[64:67], v[188:191], v[148:151], v[64:67]
    ds_read_b64_tr_b16 v[212:213], v11 offset:128
    v_mfma_f32_16x16x32_bf16 v[84:87], v[188:191], v[152:155], v[84:87]
    ds_read_b64_tr_b16 v[214:215], v11 offset:2688
    v_mfma_f32_16x16x32_bf16 v[104:107], v[188:191], v[156:159], v[104:107]
    v_mfma_f32_16x16x32_bf16 v[48:51], v[192:195], v[144:147], v[48:51]
    v_mfma_f32_16x16x32_bf16 v[68:71], v[192:195], v[148:151], v[68:71]
    v_mfma_f32_16x16x32_bf16 v[88:91], v[192:195], v[152:155], v[88:91]
    v_mfma_f32_16x16x32_bf16 v[108:111], v[192:195], v[156:159], v[108:111]
    s_waitcnt vmcnt(13)
    s_waitcnt lgkmcnt(0)
    v_mfma_f32_16x16x32_bf16 v[32:35], v[196:199], v[160:163], v[32:35]
    v_add_u32 v10, s93, v8
    v_mfma_f32_16x16x32_bf16 v[52:55], v[196:199], v[164:167], v[52:55]
    ds_read_b64_tr_b16 v[176:177], v10 offset:0
    v_mfma_f32_16x16x32_bf16 v[72:75], v[196:199], v[168:171], v[72:75]
    ds_read_b64_tr_b16 v[178:179], v10 offset:2560
    v_mfma_f32_16x16x32_bf16 v[92:95], v[196:199], v[172:175], v[92:95]
    ds_read_b64_tr_b16 v[180:181], v10 offset:32
    v_mfma_f32_16x16x32_bf16 v[36:39], v[200:203], v[160:163], v[36:39]
    ds_read_b64_tr_b16 v[182:183], v10 offset:2592
    v_mfma_f32_16x16x32_bf16 v[56:59], v[200:203], v[164:167], v[56:59]
    ds_read_b64_tr_b16 v[184:185], v10 offset:64
    v_mfma_f32_16x16x32_bf16 v[76:79], v[200:203], v[168:171], v[76:79]
    ds_read_b64_tr_b16 v[186:187], v10 offset:2624
    v_mfma_f32_16x16x32_bf16 v[96:99], v[200:203], v[172:175], v[96:99]
    ds_read_b64_tr_b16 v[188:189], v10 offset:96
    v_mfma_f32_16x16x32_bf16 v[40:43], v[204:207], v[160:163], v[40:43]
    ds_read_b64_tr_b16 v[190:191], v10 offset:2656
    v_mfma_f32_16x16x32_bf16 v[60:63], v[204:207], v[164:167], v[60:63]
    ds_read_b64_tr_b16 v[192:193], v10 offset:128
    v_mfma_f32_16x16x32_bf16 v[80:83], v[204:207], v[168:171], v[80:83]
    ds_read_b64_tr_b16 v[194:195], v10 offset:2688
    v_mfma_f32_16x16x32_bf16 v[100:103], v[204:207], v[172:175], v[100:103]
    v_mfma_f32_16x16x32_bf16 v[44:47], v[208:211], v[160:163], v[44:47]
    v_mfma_f32_16x16x32_bf16 v[64:67], v[208:211], v[164:167], v[64:67]
    v_mfma_f32_16x16x32_bf16 v[84:87], v[208:211], v[168:171], v[84:87]
    v_mfma_f32_16x16x32_bf16 v[104:107], v[208:211], v[172:175], v[104:107]
    v_mfma_f32_16x16x32_bf16 v[48:51], v[212:215], v[160:163], v[48:51]
    v_mfma_f32_16x16x32_bf16 v[68:71], v[212:215], v[164:167], v[68:71]
    v_mfma_f32_16x16x32_bf16 v[88:91], v[212:215], v[168:171], v[88:91]
    v_mfma_f32_16x16x32_bf16 v[108:111], v[212:215], v[172:175], v[108:111]
    s_waitcnt vmcnt(4)
    s_waitcnt lgkmcnt(0)
    v_mfma_f32_16x16x32_bf16 v[32:35], v[176:179], v[112:115], v[32:35]
    v_add_u32 v11, s94, v8
    v_mfma_f32_16x16x32_bf16 v[52:55], v[176:179], v[116:119], v[52:55]
    ds_read_b64_tr_b16 v[196:197], v11 offset:0
    v_mfma_f32_16x16x32_bf16 v[72:75], v[176:179], v[120:123], v[72:75]
    ds_read_b64_tr_b16 v[198:199], v11 offset:2560
    v_mfma_f32_16x16x32_bf16 v[92:95], v[176:179], v[124:127], v[92:95]
    ds_read_b64_tr_b16 v[200:201], v11 offset:32
    v_mfma_f32_16x16x32_bf16 v[36:39], v[180:183], v[112:115], v[36:39]
    ds_read_b64_tr_b16 v[202:203], v11 offset:2592
    v_mfma_f32_16x16x32_bf16 v[56:59], v[180:183], v[116:119], v[56:59]
    ds_read_b64_tr_b16 v[204:205], v11 offset:64
    v_mfma_f32_16x16x32_bf16 v[76:79], v[180:183], v[120:123], v[76:79]
    ds_read_b64_tr_b16 v[206:207], v11 offset:2624
    v_mfma_f32_16x16x32_bf16 v[96:99], v[180:183], v[124:127], v[96:99]
    ds_read_b64_tr_b16 v[208:209], v11 offset:96
    v_mfma_f32_16x16x32_bf16 v[40:43], v[184:187], v[112:115], v[40:43]
    ds_read_b64_tr_b16 v[210:211], v11 offset:2656
    v_mfma_f32_16x16x32_bf16 v[60:63], v[184:187], v[116:119], v[60:63]
    ds_read_b64_tr_b16 v[212:213], v11 offset:128
    v_mfma_f32_16x16x32_bf16 v[80:83], v[184:187], v[120:123], v[80:83]
    ds_read_b64_tr_b16 v[214:215], v11 offset:2688
    v_mfma_f32_16x16x32_bf16 v[100:103], v[184:187], v[124:127], v[100:103]
    v_mfma_f32_16x16x32_bf16 v[44:47], v[188:191], v[112:115], v[44:47]
    v_mfma_f32_16x16x32_bf16 v[64:67], v[188:191], v[116:119], v[64:67]
    v_mfma_f32_16x16x32_bf16 v[84:87], v[188:191], v[120:123], v[84:87]
    v_mfma_f32_16x16x32_bf16 v[104:107], v[188:191], v[124:127], v[104:107]
    v_mfma_f32_16x16x32_bf16 v[48:51], v[192:195], v[112:115], v[48:51]
    v_mfma_f32_16x16x32_bf16 v[68:71], v[192:195], v[116:119], v[68:71]
    v_mfma_f32_16x16x32_bf16 v[88:91], v[192:195], v[120:123], v[88:91]
    v_mfma_f32_16x16x32_bf16 v[108:111], v[192:195], v[124:127], v[108:111]
    s_waitcnt vmcnt(0)
    s_waitcnt lgkmcnt(0)
    v_mfma_f32_16x16x32_bf16 v[32:35], v[196:199], v[128:131], v[32:35]
    v_mfma_f32_16x16x32_bf16 v[52:55], v[196:199], v[132:135], v[52:55]
    v_mfma_f32_16x16x32_bf16 v[72:75], v[196:199], v[136:139], v[72:75]
    v_mfma_f32_16x16x32_bf16 v[92:95], v[196:199], v[140:143], v[92:95]
    v_mfma_f32_16x16x32_bf16 v[36:39], v[200:203], v[128:131], v[36:39]
    v_mfma_f32_16x16x32_bf16 v[56:59], v[200:203], v[132:135], v[56:59]
    v_mfma_f32_16x16x32_bf16 v[76:79], v[200:203], v[136:139], v[76:79]
    v_mfma_f32_16x16x32_bf16 v[96:99], v[200:203], v[140:143], v[96:99]
    v_mfma_f32_16x16x32_bf16 v[40:43], v[204:207], v[128:131], v[40:43]
    v_mfma_f32_16x16x32_bf16 v[60:63], v[204:207], v[132:135], v[60:63]
    v_mfma_f32_16x16x32_bf16 v[80:83], v[204:207], v[136:139], v[80:83]
    v_mfma_f32_16x16x32_bf16 v[100:103], v[204:207], v[140:143], v[100:103]
    v_mfma_f32_16x16x32_bf16 v[44:47], v[208:211], v[128:131], v[44:47]
    v_mfma_f32_16x16x32_bf16 v[64:67], v[208:211], v[132:135], v[64:67]
    v_mfma_f32_16x16x32_bf16 v[84:87], v[208:211], v[136:139], v[84:87]
    v_mfma_f32_16x16x32_bf16 v[104:107], v[208:211], v[140:143], v[104:107]
    v_mfma_f32_16x16x32_bf16 v[48:51], v[212:215], v[128:131], v[48:51]
    v_mfma_f32_16x16x32_bf16 v[68:71], v[212:215], v[132:135], v[68:71]
    v_mfma_f32_16x16x32_bf16 v[88:91], v[212:215], v[136:139], v[88:91]
    v_mfma_f32_16x16x32_bf16 v[108:111], v[212:215], v[140:143], v[108:111]
    s_nop 7
    s_waitcnt lgkmcnt(0)
    s_mul_i32 s34, s3, 20480
    v_lshlrev_b32 v10, 4, v1
    v_add_u32 v11, s34, v10
    ds_write_b128 v11, v[32:35] offset:0
    ds_write_b128 v11, v[36:39] offset:1024
    ds_write_b128 v11, v[40:43] offset:2048
    ds_write_b128 v11, v[44:47] offset:3072
    ds_write_b128 v11, v[48:51] offset:4096
    ds_write_b128 v11, v[52:55] offset:5120
    ds_write_b128 v11, v[56:59] offset:6144
    ds_write_b128 v11, v[60:63] offset:7168
    ds_write_b128 v11, v[64:67] offset:8192
    ds_write_b128 v11, v[68:71] offset:9216
    ds_write_b128 v11, v[72:75] offset:10240
    ds_write_b128 v11, v[76:79] offset:11264
    ds_write_b128 v11, v[80:83] offset:12288
    ds_write_b128 v11, v[84:87] offset:13312
    ds_write_b128 v11, v[88:91] offset:14336
    ds_write_b128 v11, v[92:95] offset:15360
    ds_write_b128 v11, v[96:99] offset:16384
    ds_write_b128 v11, v[100:103] offset:17408
    ds_write_b128 v11, v[104:107] offset:18432
    ds_write_b128 v11, v[108:111] offset:19456
    s_waitcnt lgkmcnt(0)
    s_barrier

    s_and_b32 s34, s3, 3
    s_mul_i32 s35, s34, 5120
    s_lshr_b32 s36, s3, 2
    s_mul_i32 s36, s36, 3072
    s_add_u32 s35, s35, s36
    v_add_u32 v11, s35, v10
    v_add_u32 v12, 61440, v11
    v_add_u32 v13, 122880, v11
    v_and_b32 v14, 15, v1
    s_lshl_b32 s36, s90, 6
    s_lshl_b32 s37, s34, 4
    s_add_u32 s36, s36, s37
    v_add_u32 v14, s36, v14
    v_mul_u32_u24 v14, 1280, v14
    v_lshrrev_b32 v15, 4, v1
    v_lshl_add_u32 v14, v15, 3, v14
    s_mul_i32 s36, s91, 160
    s_lshr_b32 s37, s3, 2
    s_mul_i32 s37, s37, 96
    s_add_u32 s36, s36, s37

    ds_read_b128 v[32:35], v11 offset:0
    ds_read_b128 v[36:39], v11 offset:20480
    ds_read_b128 v[40:43], v11 offset:40960
    ds_read_b128 v[44:47], v12 offset:0
    ds_read_b128 v[48:51], v12 offset:20480
    ds_read_b128 v[52:55], v12 offset:40960
    ds_read_b128 v[56:59], v13 offset:0
    ds_read_b128 v[60:63], v13 offset:20480
    ds_read_b128 v[64:67], v11 offset:1024
    ds_read_b128 v[68:71], v11 offset:21504
    ds_read_b128 v[72:75], v11 offset:41984
    ds_read_b128 v[76:79], v12 offset:1024
    ds_read_b128 v[80:83], v12 offset:21504
    ds_read_b128 v[84:87], v12 offset:41984
    ds_read_b128 v[88:91], v13 offset:1024
    ds_read_b128 v[92:95], v13 offset:21504
    s_waitcnt lgkmcnt(8)
    v_add_f32 v32, v32, v36
    v_add_f32 v33, v33, v37
    v_add_f32 v34, v34, v38
    v_add_f32 v35, v35, v39
    v_add_f32 v32, v32, v40
    v_add_f32 v33, v33, v41
    v_add_f32 v34, v34, v42
    v_add_f32 v35, v35, v43
    v_add_f32 v32, v32, v44
    v_add_f32 v33, v33, v45
    v_add_f32 v34, v34, v46
    v_add_f32 v35, v35, v47
    v_add_f32 v32, v32, v48
    v_add_f32 v33, v33, v49
    v_add_f32 v34, v34, v50
    v_add_f32 v35, v35, v51
    v_add_f32 v32, v32, v52
    v_add_f32 v33, v33, v53
    v_add_f32 v34, v34, v54
    v_add_f32 v35, v35, v55
    v_add_f32 v32, v32, v56
    v_add_f32 v33, v33, v57
    v_add_f32 v34, v34, v58
    v_add_f32 v35, v35, v59
    v_add_f32 v32, v32, v60
    v_add_f32 v33, v33, v61
    v_add_f32 v34, v34, v62
    v_add_f32 v35, v35, v63
    v_cvt_pk_bf16_f32 v36, v32, v33
    v_cvt_pk_bf16_f32 v37, v34, v35
    buffer_store_dwordx2 v[36:37], v14, s[80:83], s36 offen offset:0
    s_waitcnt lgkmcnt(0)
    v_add_f32 v64, v64, v68
    v_add_f32 v65, v65, v69
    v_add_f32 v66, v66, v70
    v_add_f32 v67, v67, v71
    v_add_f32 v64, v64, v72
    v_add_f32 v65, v65, v73
    v_add_f32 v66, v66, v74
    v_add_f32 v67, v67, v75
    v_add_f32 v64, v64, v76
    v_add_f32 v65, v65, v77
    v_add_f32 v66, v66, v78
    v_add_f32 v67, v67, v79
    v_add_f32 v64, v64, v80
    v_add_f32 v65, v65, v81
    v_add_f32 v66, v66, v82
    v_add_f32 v67, v67, v83
    v_add_f32 v64, v64, v84
    v_add_f32 v65, v65, v85
    v_add_f32 v66, v66, v86
    v_add_f32 v67, v67, v87
    v_add_f32 v64, v64, v88
    v_add_f32 v65, v65, v89
    v_add_f32 v66, v66, v90
    v_add_f32 v67, v67, v91
    v_add_f32 v64, v64, v92
    v_add_f32 v65, v65, v93
    v_add_f32 v66, v66, v94
    v_add_f32 v67, v67, v95
    v_cvt_pk_bf16_f32 v68, v64, v65
    v_cvt_pk_bf16_f32 v69, v66, v67
    buffer_store_dwordx2 v[68:69], v14, s[80:83], s36 offen offset:32
    s_cmp_ge_u32 s3, 4
    s_cbranch_scc1 L_fin_done_g1
    ds_read_b128 v[96:99], v11 offset:2048
    ds_read_b128 v[100:103], v11 offset:22528
    ds_read_b128 v[104:107], v11 offset:43008
    ds_read_b128 v[108:111], v12 offset:2048
    ds_read_b128 v[112:115], v12 offset:22528
    ds_read_b128 v[116:119], v12 offset:43008
    ds_read_b128 v[120:123], v13 offset:2048
    ds_read_b128 v[124:127], v13 offset:22528
    s_waitcnt lgkmcnt(0)
    v_add_f32 v96, v96, v100
    v_add_f32 v97, v97, v101
    v_add_f32 v98, v98, v102
    v_add_f32 v99, v99, v103
    v_add_f32 v96, v96, v104
    v_add_f32 v97, v97, v105
    v_add_f32 v98, v98, v106
    v_add_f32 v99, v99, v107
    v_add_f32 v96, v96, v108
    v_add_f32 v97, v97, v109
    v_add_f32 v98, v98, v110
    v_add_f32 v99, v99, v111
    v_add_f32 v96, v96, v112
    v_add_f32 v97, v97, v113
    v_add_f32 v98, v98, v114
    v_add_f32 v99, v99, v115
    v_add_f32 v96, v96, v116
    v_add_f32 v97, v97, v117
    v_add_f32 v98, v98, v118
    v_add_f32 v99, v99, v119
    v_add_f32 v96, v96, v120
    v_add_f32 v97, v97, v121
    v_add_f32 v98, v98, v122
    v_add_f32 v99, v99, v123
    v_add_f32 v96, v96, v124
    v_add_f32 v97, v97, v125
    v_add_f32 v98, v98, v126
    v_add_f32 v99, v99, v127
    v_cvt_pk_bf16_f32 v100, v96, v97
    v_cvt_pk_bf16_f32 v101, v98, v99
    buffer_store_dwordx2 v[100:101], v14, s[80:83], s36 offen offset:64
L_fin_done_g1:
L_end:
    s_endpgm
.section .rodata,"a"
.p2align 6
.amdhsa_kernel standalone__mha_block_cached__near_ridge_kernel
  .amdhsa_next_free_vgpr 256
  .amdhsa_next_free_sgpr 102
  .amdhsa_accum_offset 256
  .amdhsa_group_segment_fixed_size 0
  .amdhsa_kernarg_size 64
  .amdhsa_user_sgpr_count 2
  .amdhsa_user_sgpr_kernarg_segment_ptr 1
  .amdhsa_system_sgpr_workgroup_id_x 1
.end_amdhsa_kernel
```
